```python
import torch

def _softmax(x, axis=-1):
    return torch.softmax(x, dim=axis)
def _gelu(x):
    return torch.nn.functional.gelu(x, approximate="tanh")
def _silu(x):
    return torch.nn.functional.silu(x)
def _sigmoid(x):
    return torch.sigmoid(x)
def _layernorm(x, axis=-1, eps=1e-5):
    m = x.mean(dim=axis, keepdim=True)
    v = x.var(dim=axis, keepdim=True, unbiased=False)
    return (x - m) / torch.sqrt(v + eps)
def _scatter_add(tgt, idx, src, axis=0):
    return tgt.clone().index_add_(axis, idx, src)
def _segment_sum(src, seg, n):
    out = torch.zeros((n,) + src.shape[1:], dtype=src.dtype)
    return out.index_add_(0, seg, src)
def _pad(x, pw):
    flat = tuple(v for pair in reversed(pw) for v in pair)
    return torch.nn.functional.pad(x, flat)

kernel_name = 'gated_mix__grouped_kv_mqa__geglu_ffn__prompt'

def setup_inputs():

    _w = (lambda a: (lambda t: t.to(torch.bfloat16) if t.is_floating_point() else t)(torch.as_tensor(a)))
    def _A_setup():
        B, S, D, H = 1, 2048, 640, 32
        Dh = D // H
        return {
            "x": _w((lambda *s: torch.randn(*s, dtype=torch.bfloat16) * 0.05)(B, S, D)),
            "wq": _w((lambda *s: torch.randn(*s, dtype=torch.bfloat16) * 0.8)(D, H * Dh)),
            "wk": _w((lambda *s: torch.randn(*s, dtype=torch.bfloat16) * 0.8)(D, Dh)),
            "wv": _w((lambda *s: torch.randn(*s, dtype=torch.bfloat16) * 0.05)(D, Dh)),
            "wo": _w((lambda *s: torch.randn(*s, dtype=torch.bfloat16) * 0.05)(H * Dh, D)),
        }
    _A_in = _A_setup()

    def _B_setup():
        B, S, D, F = 1, 2048, 640, 1728
        return {
            "x": _w((lambda *s: torch.randn(*s, dtype=torch.bfloat16) * 0.05)(B, S, D)),
            "w_gate": _w((lambda *s: torch.randn(*s, dtype=torch.bfloat16) * 0.05)(D, F)),
            "w_up": _w((lambda *s: torch.randn(*s, dtype=torch.bfloat16) * 0.05)(D, F)),
            "w_down": _w((lambda *s: torch.randn(*s, dtype=torch.bfloat16) * 0.05)(F, D)),
        }
    _B_in = _B_setup()

    return {
        "A_x": _A_in["x"],
        "A_wq": _A_in["wq"],
        "A_wk": _A_in["wk"],
        "A_wv": _A_in["wv"],
        "A_wo": _A_in["wo"],
        "B_x": _B_in["x"],
        "B_w_gate": _B_in["w_gate"],
        "B_w_up": _B_in["w_up"],
        "B_w_down": _B_in["w_down"],
        "gate_w": _w((lambda *s: torch.randn(*s, dtype=torch.bfloat16) * 0.05)(640) * 16.0),
    }

def reference(A_x, A_wq, A_wk, A_wv, A_wo, B_x, B_w_gate, B_w_up, B_w_down, gate_w):
    def _A_ref(x, wq, wk, wv, wo):
        B, S, D = x.shape
        H = 32
        Dh = D // H
        q = (lambda x, *d: x.permute(*d))((x @ wq).reshape(B, S, H, Dh), 0, 2, 1, 3)
        k = x @ wk
        v = x @ wv
        scores = torch.einsum("bhqd,bkd->bhqk", q, k) * (Dh ** -0.5)
        p = _softmax(scores, axis=-1)
        o = torch.einsum("bhqk,bkd->bhqd", p, v)
        return (lambda x, *d: x.permute(*d))(o, 0, 2, 1, 3).reshape(B, S, H * Dh) @ wo

    def _B_ref(x, w_gate, w_up, w_down):
        return (_gelu(x @ w_gate) * (x @ w_up)) @ w_down

    x = A_x
    g = _sigmoid((x * gate_w).sum(-1, keepdims=True))
    a = _A_ref(x, A_wq, A_wk, A_wv, A_wo)
    b = _B_ref(x, B_w_gate, B_w_up, B_w_down)
    return g * a + (1 - g) * b
```

```asm
; @launch grid=(256,1,1) block=(512,1,1) lds=163840
.amdgcn_target "amdgcn-amd-amdhsa--gfx950"
.text
.p2align 8
.globl gated_mix__grouped_kv_mqa__geglu_ffn__prompt_kernel
.type gated_mix__grouped_kv_mqa__geglu_ffn__prompt_kernel,@function
gated_mix__grouped_kv_mqa__geglu_ffn__prompt_kernel:
  s_cmp_ge_u32 s2, 256
  s_cbranch_scc1 gated_mix__grouped_kv_mqa__geglu_ffn__prompt_kernel_end
  s_load_dwordx4 s[60:63], s[0:1], 0
  s_load_dwordx4 s[64:67], s[0:1], 16
  s_load_dwordx2 s[68:69], s[0:1], 32
  s_load_dwordx4 s[72:75], s[0:1], 48
  s_load_dwordx4 s[76:79], s[0:1], 64
  s_load_dwordx4 s[80:83], s[0:1], 80
  s_load_dwordx2 s[6:7], s[0:1], 96
  v_lshrrev_b32 v9, 6, v0
  v_and_b32 v1, 63, v0
  v_readfirstlane_b32 s3, v9
  v_lshlrev_b32 v2, 4, v1
  s_and_b32 s4, s2, 7
  s_lshr_b32 s12, s2, 5
  s_lshl_b32 s12, s12, 3
  s_add_u32 s4, s4, s12
  s_bfe_u32 s22, s2, 0x20003
  v_and_b32 v4, 31, v1
  v_lshrrev_b32 v7, 5, v1
  v_mov_b32 v92, 163712
  s_mov_b32 s28, 0x40000
  s_cmp_ge_u32 s3, 4
  s_cbranch_scc1 gated_mix__grouped_kv_mqa__geglu_ffn__prompt_kernel_G
  s_getpc_b64 s[98:99]
  s_lshr_b32 s12, s2, 3
  s_lshl_b32 s12, s12, 2
  s_add_u32 s12, s12, s3
  s_lshl_b32 s12, s12, 9
  v_lshl_add_u32 v9, v1, 7, s12
  v_min_u32 v9, CODE_MAX, v9
  s_mov_b64 exec, 15
  global_load_dword v252, v9, s[98:99]
  s_mov_b64 exec, -1
  s_lshl_b32 s5, s22, 3
  s_and_b32 s12, s3, 1
  s_lshl_b32 s12, s12, 2
  s_add_u32 s5, s5, s12
  s_lshr_b32 s23, s3, 1
  v_lshlrev_b32 v8, 4, v4
  v_add_u32 v8, 2048, v8
  v_mul_u32_u24 v5, 336, v7
  v_lshl_add_u32 v5, v4, 4, v5
  v_add_u32 v5, 2560, v5
  s_mov_b32 exec_lo, 0xffe00000
  s_mov_b32 exec_hi, 0xffe00000
  v_mov_b32 v5, 3232
  s_mov_b32 exec_lo, 0
  s_mov_b32 exec_hi, -1
  v_mov_b32 v8, 3232
  s_mov_b64 exec, -1
  v_mov_b32 v32, 0
  v_mov_b32 v33, 0
  v_mov_b32 v34, 0
  v_mov_b32 v35, 0
  v_mov_b32 v36, 0
  v_mov_b32 v37, 0
  v_mov_b32 v38, 0
  v_mov_b32 v39, 0
  v_mov_b32 v40, 0
  v_mov_b32 v41, 0
  v_mov_b32 v42, 0
  v_mov_b32 v43, 0
  v_mov_b32 v44, 0
  v_mov_b32 v45, 0
  v_mov_b32 v46, 0
  v_mov_b32 v47, 0
  v_mov_b32 v48, 0
  v_mov_b32 v49, 0
  v_mov_b32 v50, 0
  v_mov_b32 v51, 0
  v_mov_b32 v52, 0
  v_mov_b32 v53, 0
  v_mov_b32 v54, 0
  v_mov_b32 v55, 0
  v_mov_b32 v60, 0
  v_mov_b32 v61, 0
  v_mov_b32 v66, 0
  v_mov_b32 v67, 0
  s_mov_b32 exec_hi, 0
  v_mov_b32 v60, 0x3f803f80
  v_mov_b32 v66, 0x3f803f80
  s_mov_b32 exec_hi, -1
  s_lshl_b32 s13, s3, 2
  s_add_u32 s13, s13, 163776
  v_mov_b32 v93, s13
  s_mov_b32 s17, 0
  s_mul_i32 s12, s3, 6144
  s_add_u32 s12, s12, 86016
  v_add_u32 v230, s12, v2
  s_xor_b32 s13, s3, 2
  s_mul_i32 s12, s13, 6144
  s_add_u32 s12, s12, 86016
  v_add_u32 v231, s12, v2
  s_lshl_b32 s12, s3, 2
  v_add_u32 v232, s12, v92
  s_lshl_b32 s12, s13, 2
  v_add_u32 v233, s12, v92
  s_waitcnt lgkmcnt(0)
  s_mov_b32 s8, s6
  s_and_b32 s9, s7, 0xffff
  s_mov_b32 s10, 21920000
  s_mov_b32 s11, 0x20000
  s_mov_b32 s24, s6
  s_and_b32 s25, s7, 0xffff
  s_mov_b32 s26, 9869312
  s_mov_b32 s27, 0x20000
  s_lshl_b32 s90, s3, 10
  s_add_u32 s91, s90, 9709952
  v_mov_b32 v237, 1
  s_mov_b32 s40, s62
  s_and_b32 s41, s63, 0xffff
  s_mov_b32 s42, 819200
  s_mov_b32 s43, 0x20000
  s_cmp_lt_u32 s22, 2
  s_cbranch_scc1 gated_mix__grouped_kv_mqa__geglu_ffn__prompt_kernel_ntq
  s_lshr_b32 s12, s2, 5
  s_lshl_b32 s12, s12, 1
  s_add_u32 s12, s12, s22
  s_sub_u32 s12, s12, 2
  s_lshl_b32 s12, s12, 2
  s_add_u32 s12, s12, s3
  s_mul_i32 s12, s12, 1280
  v_mul_u32_u24 v9, 205, v1
  v_lshrrev_b32 v9, 11, v9
  v_mul_u32_u24 v11, 10, v9
  v_sub_u32 v11, v1, v11
  v_mul_u32_u24 v9, 81920, v9
  v_lshl_add_u32 v9, v11, 7, v9
  s_mov_b32 exec_hi, 0x3ffff
  buffer_load_dword v252, v9, s[40:43], s12 offen
  s_add_u32 s12, s12, 409600
  buffer_load_dword v252, v9, s[40:43], s12 offen
  s_mov_b32 exec_hi, -1
gated_mix__grouped_kv_mqa__geglu_ffn__prompt_kernel_ntq:
  s_and_b32 s12, s2, 7
  s_lshr_b32 s13, s2, 3
  s_and_b32 s88, s12, 1
  s_lshl_b32 s88, s88, 2
  s_and_b32 s14, s13, 3
  s_add_u32 s88, s88, s14
  s_lshr_b32 s12, s12, 1
  s_mul_i32 s89, s12, 7
  s_lshr_b32 s14, s13, 2
  s_add_u32 s89, s89, s14
  s_add_u32 s13, s88, 59
  s_cmp_eq_u32 s89, 27
  s_cselect_b32 s89, s13, s89
  s_lshl_b32 s12, s12, 3
  s_add_u32 s12, s12, s88
  s_add_u32 s12, s12, 27
  s_cmp_eq_u32 s14, 7
  s_cselect_b32 s89, s12, s89
  v_bfe_u32 v9, v1, 1, 3
  v_xor_b32 v9, v9, v7
  v_lshlrev_b32 v9, 4, v9
  v_lshl_add_u32 v9, v4, 7, v9
  v_add_u32 v182, 40960, v9
  v_xor_b32 v183, 32, v182
  v_xor_b32 v184, 64, v182
  v_xor_b32 v185, 96, v182
  v_bfe_u32 v9, v1, 2, 2
  v_lshl_add_u32 v9, v7, 3, v9
  v_mul_u32_u24 v9, 320, v9
  s_and_b32 s12, s3, 1
  s_mul_i32 s12, s12, 160
  s_add_u32 s12, s12, 81920
  v_add_u32 v9, s12, v9
  v_and_b32 v10, 3, v1
  v_bfe_u32 v11, v1, 4, 1
  v_mul_u32_u24 v12, 40, v11
  v_lshl_add_u32 v12, v10, 3, v12
  v_add_u32 v176, v9, v12
  v_add_u32 v177, 80, v176
  v_lshrrev_b32 v10, 1, v10
  v_lshl_add_u32 v10, v11, 1, v10
  v_mul_u32_u24 v10, 40, v10
  v_add_u32 v178, v9, v10
  v_add_u32 v178, 32, v178
  v_add_u32 v179, 40960, v176
  v_subrev_u32 v186, 81920, v176
  v_add_u32 v180, 40960, v177
  v_subrev_u32 v187, 81920, v177
  v_add_u32 v181, 40960, v178
  v_subrev_u32 v188, 81920, v178
  s_barrier
  s_barrier
  ds_read_b32 v12, v92 offset:52
  s_waitcnt lgkmcnt(0)
  v_readfirstlane_b32 s29, v12
  v_lshlrev_b32 v15, 2, v1
  v_lshlrev_b32 v238, 2, v4
  s_mul_i32 s15, s23, 5312
  s_add_u32 s14, s15, 9699328
  s_lshl_b32 s18, s4, 7
  s_add_u32 s18, s18, 9869568
  s_mov_b32 s13, 9869312
  v_mov_b32 v12, 0x3ea52b5c
  v_mov_b32 v13, 0x3ea52b5c
  s_mov_b32 s16, 0
  s_barrier
  ds_read_b128 v[192:195], v182 offset:0
  ds_read_b64_tr_b16 v[96:97], v176 offset:0
  ds_read_b64_tr_b16 v[98:99], v176 offset:1280
  ds_read_b64_tr_b16 v[100:101], v177 offset:0
  ds_read_b64_tr_b16 v[102:103], v177 offset:1280
  ds_read_b64_tr_b16 v[104:105], v178 offset:0
  ds_read_b64_tr_b16 v[106:107], v178 offset:1280
  ds_read_b128 v[196:199], v183 offset:0
  ds_read_b64_tr_b16 v[108:109], v176 offset:5120
  ds_read_b64_tr_b16 v[110:111], v176 offset:6400
  ds_read_b64_tr_b16 v[112:113], v177 offset:5120
  ds_read_b64_tr_b16 v[114:115], v177 offset:6400
  ds_read_b64_tr_b16 v[116:117], v178 offset:5120
  ds_read_b64_tr_b16 v[118:119], v178 offset:6400
  s_waitcnt lgkmcnt(7)
  v_mfma_f32_32x32x16_bf16 v[128:143], v[96:99], v[192:195], 0
  ds_read_b128 v[200:203], v184 offset:0
  ds_read_b64_tr_b16 v[204:205], v176 offset:10240
  ds_read_b64_tr_b16 v[206:207], v176 offset:11520
  v_mfma_f32_32x32x16_bf16 v[144:159], v[100:103], v[192:195], 0
  ds_read_b64_tr_b16 v[208:209], v177 offset:10240
  ds_read_b64_tr_b16 v[210:211], v177 offset:11520
  ds_read_b64_tr_b16 v[212:213], v178 offset:10240
  v_mfma_f32_32x32x16_bf16 v[160:175], v[104:107], v[192:195], 0
  ds_read_b64_tr_b16 v[214:215], v178 offset:11520
  s_waitcnt lgkmcnt(7)
  v_mfma_f32_32x32x16_bf16 v[128:143], v[108:111], v[196:199], v[128:143]
  ds_read_b128 v[192:195], v185 offset:0
  ds_read_b64_tr_b16 v[96:97], v176 offset:15360
  ds_read_b64_tr_b16 v[98:99], v176 offset:16640
  v_mfma_f32_32x32x16_bf16 v[144:159], v[112:115], v[196:199], v[144:159]
  ds_read_b64_tr_b16 v[100:101], v177 offset:15360
  ds_read_b64_tr_b16 v[102:103], v177 offset:16640
  ds_read_b64_tr_b16 v[104:105], v178 offset:15360
  v_mfma_f32_32x32x16_bf16 v[160:175], v[116:119], v[196:199], v[160:175]
  ds_read_b64_tr_b16 v[106:107], v178 offset:16640
  s_waitcnt lgkmcnt(0)
  s_barrier
  v_mfma_f32_32x32x16_bf16 v[128:143], v[204:207], v[200:203], v[128:143]
  ds_read_b128 v[196:199], v182 offset:4096
  ds_read_b64_tr_b16 v[108:109], v176 offset:20480
  ds_read_b64_tr_b16 v[110:111], v176 offset:21760
  v_mfma_f32_32x32x16_bf16 v[144:159], v[208:211], v[200:203], v[144:159]
  ds_read_b64_tr_b16 v[112:113], v177 offset:20480
  ds_read_b64_tr_b16 v[114:115], v177 offset:21760
  ds_read_b64_tr_b16 v[116:117], v178 offset:20480
  v_mfma_f32_32x32x16_bf16 v[160:175], v[212:215], v[200:203], v[160:175]
  ds_read_b64_tr_b16 v[118:119], v178 offset:21760
  v_mfma_f32_32x32x16_bf16 v[128:143], v[96:99], v[192:195], v[128:143]
  ds_read_b128 v[200:203], v183 offset:4096
  ds_read_b64_tr_b16 v[204:205], v176 offset:25600
  ds_read_b64_tr_b16 v[206:207], v176 offset:26880
  v_mfma_f32_32x32x16_bf16 v[144:159], v[100:103], v[192:195], v[144:159]
  ds_read_b64_tr_b16 v[208:209], v177 offset:25600
  ds_read_b64_tr_b16 v[210:211], v177 offset:26880
  ds_read_b64_tr_b16 v[212:213], v178 offset:25600
  v_mfma_f32_32x32x16_bf16 v[160:175], v[104:107], v[192:195], v[160:175]
  ds_read_b64_tr_b16 v[214:215], v178 offset:26880
  s_waitcnt lgkmcnt(7)
  v_mfma_f32_32x32x16_bf16 v[128:143], v[108:111], v[196:199], v[128:143]
  ds_read_b128 v[192:195], v184 offset:4096
  ds_read_b64_tr_b16 v[96:97], v176 offset:30720
  ds_read_b64_tr_b16 v[98:99], v176 offset:32000
  v_mfma_f32_32x32x16_bf16 v[144:159], v[112:115], v[196:199], v[144:159]
  ds_read_b64_tr_b16 v[100:101], v177 offset:30720
  ds_read_b64_tr_b16 v[102:103], v177 offset:32000
  ds_read_b64_tr_b16 v[104:105], v178 offset:30720
  v_mfma_f32_32x32x16_bf16 v[160:175], v[116:119], v[196:199], v[160:175]
  ds_read_b64_tr_b16 v[106:107], v178 offset:32000
  s_waitcnt lgkmcnt(7)
  v_mfma_f32_32x32x16_bf16 v[128:143], v[204:207], v[200:203], v[128:143]
  ds_read_b128 v[196:199], v185 offset:4096
  ds_read_b64_tr_b16 v[108:109], v176 offset:35840
  ds_read_b64_tr_b16 v[110:111], v176 offset:37120
  v_mfma_f32_32x32x16_bf16 v[144:159], v[208:211], v[200:203], v[144:159]
  ds_read_b64_tr_b16 v[112:113], v177 offset:35840
  ds_read_b64_tr_b16 v[114:115], v177 offset:37120
  ds_read_b64_tr_b16 v[116:117], v178 offset:35840
  v_mfma_f32_32x32x16_bf16 v[160:175], v[212:215], v[200:203], v[160:175]
  ds_read_b64_tr_b16 v[118:119], v178 offset:37120
  s_waitcnt lgkmcnt(0)
  s_barrier
  v_mfma_f32_32x32x16_bf16 v[128:143], v[96:99], v[192:195], v[128:143]
  ds_read_b128 v[200:203], v182 offset:8192
  ds_read_b64_tr_b16 v[204:205], v179 offset:0
  ds_read_b64_tr_b16 v[206:207], v179 offset:1280
  v_mfma_f32_32x32x16_bf16 v[144:159], v[100:103], v[192:195], v[144:159]
  ds_read_b64_tr_b16 v[208:209], v180 offset:0
  ds_read_b64_tr_b16 v[210:211], v180 offset:1280
  ds_read_b64_tr_b16 v[212:213], v181 offset:0
  v_mfma_f32_32x32x16_bf16 v[160:175], v[104:107], v[192:195], v[160:175]
  ds_read_b64_tr_b16 v[214:215], v181 offset:1280
  v_mfma_f32_32x32x16_bf16 v[128:143], v[108:111], v[196:199], v[128:143]
  ds_read_b128 v[192:195], v183 offset:8192
  ds_read_b64_tr_b16 v[96:97], v179 offset:5120
  ds_read_b64_tr_b16 v[98:99], v179 offset:6400
  v_mfma_f32_32x32x16_bf16 v[144:159], v[112:115], v[196:199], v[144:159]
  ds_read_b64_tr_b16 v[100:101], v180 offset:5120
  ds_read_b64_tr_b16 v[102:103], v180 offset:6400
  ds_read_b64_tr_b16 v[104:105], v181 offset:5120
  v_mfma_f32_32x32x16_bf16 v[160:175], v[116:119], v[196:199], v[160:175]
  ds_read_b64_tr_b16 v[106:107], v181 offset:6400
  s_waitcnt lgkmcnt(7)
  v_mfma_f32_32x32x16_bf16 v[128:143], v[204:207], v[200:203], v[128:143]
  ds_read_b128 v[196:199], v184 offset:8192
  ds_read_b64_tr_b16 v[108:109], v179 offset:10240
  ds_read_b64_tr_b16 v[110:111], v179 offset:11520
  v_mfma_f32_32x32x16_bf16 v[144:159], v[208:211], v[200:203], v[144:159]
  ds_read_b64_tr_b16 v[112:113], v180 offset:10240
  ds_read_b64_tr_b16 v[114:115], v180 offset:11520
  ds_read_b64_tr_b16 v[116:117], v181 offset:10240
  v_mfma_f32_32x32x16_bf16 v[160:175], v[212:215], v[200:203], v[160:175]
  ds_read_b64_tr_b16 v[118:119], v181 offset:11520
  s_waitcnt lgkmcnt(7)
  v_mfma_f32_32x32x16_bf16 v[128:143], v[96:99], v[192:195], v[128:143]
  ds_read_b128 v[200:203], v185 offset:8192
  ds_read_b64_tr_b16 v[204:205], v179 offset:15360
  ds_read_b64_tr_b16 v[206:207], v179 offset:16640
  v_mfma_f32_32x32x16_bf16 v[144:159], v[100:103], v[192:195], v[144:159]
  ds_read_b64_tr_b16 v[208:209], v180 offset:15360
  ds_read_b64_tr_b16 v[210:211], v180 offset:16640
  ds_read_b64_tr_b16 v[212:213], v181 offset:15360
  v_mfma_f32_32x32x16_bf16 v[160:175], v[104:107], v[192:195], v[160:175]
  ds_read_b64_tr_b16 v[214:215], v181 offset:16640
  s_waitcnt lgkmcnt(0)
  s_barrier
  v_mfma_f32_32x32x16_bf16 v[128:143], v[108:111], v[196:199], v[128:143]
  ds_read_b128 v[192:195], v182 offset:12288
  ds_read_b64_tr_b16 v[96:97], v186 offset:0
  ds_read_b64_tr_b16 v[98:99], v186 offset:1280
  v_mfma_f32_32x32x16_bf16 v[144:159], v[112:115], v[196:199], v[144:159]
  ds_read_b64_tr_b16 v[100:101], v187 offset:0
  ds_read_b64_tr_b16 v[102:103], v187 offset:1280
  ds_read_b64_tr_b16 v[104:105], v188 offset:0
  v_mfma_f32_32x32x16_bf16 v[160:175], v[116:119], v[196:199], v[160:175]
  ds_read_b64_tr_b16 v[106:107], v188 offset:1280
  v_mfma_f32_32x32x16_bf16 v[128:143], v[204:207], v[200:203], v[128:143]
  ds_read_b128 v[196:199], v183 offset:12288
  ds_read_b64_tr_b16 v[108:109], v186 offset:5120
  ds_read_b64_tr_b16 v[110:111], v186 offset:6400
  v_mfma_f32_32x32x16_bf16 v[144:159], v[208:211], v[200:203], v[144:159]
  ds_read_b64_tr_b16 v[112:113], v187 offset:5120
  ds_read_b64_tr_b16 v[114:115], v187 offset:6400
  ds_read_b64_tr_b16 v[116:117], v188 offset:5120
  v_mfma_f32_32x32x16_bf16 v[160:175], v[212:215], v[200:203], v[160:175]
  ds_read_b64_tr_b16 v[118:119], v188 offset:6400
  s_waitcnt lgkmcnt(7)
  v_mfma_f32_32x32x16_bf16 v[128:143], v[96:99], v[192:195], v[128:143]
  ds_read_b128 v[200:203], v184 offset:12288
  ds_read_b64_tr_b16 v[204:205], v186 offset:10240
  ds_read_b64_tr_b16 v[206:207], v186 offset:11520
  v_mfma_f32_32x32x16_bf16 v[144:159], v[100:103], v[192:195], v[144:159]
  ds_read_b64_tr_b16 v[208:209], v187 offset:10240
  ds_read_b64_tr_b16 v[210:211], v187 offset:11520
  ds_read_b64_tr_b16 v[212:213], v188 offset:10240
  v_mfma_f32_32x32x16_bf16 v[160:175], v[104:107], v[192:195], v[160:175]
  ds_read_b64_tr_b16 v[214:215], v188 offset:11520
  s_waitcnt lgkmcnt(7)
  v_mfma_f32_32x32x16_bf16 v[128:143], v[108:111], v[196:199], v[128:143]
  ds_read_b128 v[192:195], v185 offset:12288
  ds_read_b64_tr_b16 v[96:97], v186 offset:15360
  ds_read_b64_tr_b16 v[98:99], v186 offset:16640
  v_mfma_f32_32x32x16_bf16 v[144:159], v[112:115], v[196:199], v[144:159]
  ds_read_b64_tr_b16 v[100:101], v187 offset:15360
  ds_read_b64_tr_b16 v[102:103], v187 offset:16640
  ds_read_b64_tr_b16 v[104:105], v188 offset:15360
  v_mfma_f32_32x32x16_bf16 v[160:175], v[116:119], v[196:199], v[160:175]
  ds_read_b64_tr_b16 v[106:107], v188 offset:16640
  s_waitcnt lgkmcnt(0)
  s_barrier
  v_mfma_f32_32x32x16_bf16 v[128:143], v[204:207], v[200:203], v[128:143]
  ds_read_b128 v[196:199], v182 offset:16384
  ds_read_b64_tr_b16 v[108:109], v186 offset:20480
  ds_read_b64_tr_b16 v[110:111], v186 offset:21760
  v_mfma_f32_32x32x16_bf16 v[144:159], v[208:211], v[200:203], v[144:159]
  ds_read_b64_tr_b16 v[112:113], v187 offset:20480
  ds_read_b64_tr_b16 v[114:115], v187 offset:21760
  ds_read_b64_tr_b16 v[116:117], v188 offset:20480
  v_mfma_f32_32x32x16_bf16 v[160:175], v[212:215], v[200:203], v[160:175]
  ds_read_b64_tr_b16 v[118:119], v188 offset:21760
  v_mfma_f32_32x32x16_bf16 v[128:143], v[96:99], v[192:195], v[128:143]
  ds_read_b128 v[200:203], v183 offset:16384
  ds_read_b64_tr_b16 v[204:205], v186 offset:25600
  ds_read_b64_tr_b16 v[206:207], v186 offset:26880
  v_mfma_f32_32x32x16_bf16 v[144:159], v[100:103], v[192:195], v[144:159]
  ds_read_b64_tr_b16 v[208:209], v187 offset:25600
  ds_read_b64_tr_b16 v[210:211], v187 offset:26880
  ds_read_b64_tr_b16 v[212:213], v188 offset:25600
  v_mfma_f32_32x32x16_bf16 v[160:175], v[104:107], v[192:195], v[160:175]
  ds_read_b64_tr_b16 v[214:215], v188 offset:26880
  s_waitcnt lgkmcnt(7)
  v_mfma_f32_32x32x16_bf16 v[128:143], v[108:111], v[196:199], v[128:143]
  ds_read_b128 v[192:195], v184 offset:16384
  ds_read_b64_tr_b16 v[96:97], v186 offset:30720
  ds_read_b64_tr_b16 v[98:99], v186 offset:32000
  v_mfma_f32_32x32x16_bf16 v[144:159], v[112:115], v[196:199], v[144:159]
  ds_read_b64_tr_b16 v[100:101], v187 offset:30720
  ds_read_b64_tr_b16 v[102:103], v187 offset:32000
  ds_read_b64_tr_b16 v[104:105], v188 offset:30720
  v_mfma_f32_32x32x16_bf16 v[160:175], v[116:119], v[196:199], v[160:175]
  ds_read_b64_tr_b16 v[106:107], v188 offset:32000
  s_waitcnt lgkmcnt(7)
  v_mfma_f32_32x32x16_bf16 v[128:143], v[204:207], v[200:203], v[128:143]
  ds_read_b128 v[196:199], v185 offset:16384
  ds_read_b64_tr_b16 v[108:109], v186 offset:35840
  ds_read_b64_tr_b16 v[110:111], v186 offset:37120
  v_mfma_f32_32x32x16_bf16 v[144:159], v[208:211], v[200:203], v[144:159]
  ds_read_b64_tr_b16 v[112:113], v187 offset:35840
  ds_read_b64_tr_b16 v[114:115], v187 offset:37120
  ds_read_b64_tr_b16 v[116:117], v188 offset:35840
  v_mfma_f32_32x32x16_bf16 v[160:175], v[212:215], v[200:203], v[160:175]
  ds_read_b64_tr_b16 v[118:119], v188 offset:37120
  s_waitcnt lgkmcnt(0)
  s_barrier
  v_mfma_f32_32x32x16_bf16 v[128:143], v[96:99], v[192:195], v[128:143]
  ds_read_b128 v[200:203], v182 offset:20480
  ds_read_b64_tr_b16 v[204:205], v176 offset:0
  ds_read_b64_tr_b16 v[206:207], v176 offset:1280
  v_mfma_f32_32x32x16_bf16 v[144:159], v[100:103], v[192:195], v[144:159]
  ds_read_b64_tr_b16 v[208:209], v177 offset:0
  ds_read_b64_tr_b16 v[210:211], v177 offset:1280
  ds_read_b64_tr_b16 v[212:213], v178 offset:0
  v_mfma_f32_32x32x16_bf16 v[160:175], v[104:107], v[192:195], v[160:175]
  ds_read_b64_tr_b16 v[214:215], v178 offset:1280
  v_mfma_f32_32x32x16_bf16 v[128:143], v[108:111], v[196:199], v[128:143]
  ds_read_b128 v[192:195], v183 offset:20480
  ds_read_b64_tr_b16 v[96:97], v176 offset:5120
  ds_read_b64_tr_b16 v[98:99], v176 offset:6400
  v_mfma_f32_32x32x16_bf16 v[144:159], v[112:115], v[196:199], v[144:159]
  ds_read_b64_tr_b16 v[100:101], v177 offset:5120
  ds_read_b64_tr_b16 v[102:103], v177 offset:6400
  ds_read_b64_tr_b16 v[104:105], v178 offset:5120
  v_mfma_f32_32x32x16_bf16 v[160:175], v[116:119], v[196:199], v[160:175]
  ds_read_b64_tr_b16 v[106:107], v178 offset:6400
  s_waitcnt lgkmcnt(7)
  v_mfma_f32_32x32x16_bf16 v[128:143], v[204:207], v[200:203], v[128:143]
  ds_read_b128 v[196:199], v184 offset:20480
  ds_read_b64_tr_b16 v[108:109], v176 offset:10240
  ds_read_b64_tr_b16 v[110:111], v176 offset:11520
  v_mfma_f32_32x32x16_bf16 v[144:159], v[208:211], v[200:203], v[144:159]
  ds_read_b64_tr_b16 v[112:113], v177 offset:10240
  ds_read_b64_tr_b16 v[114:115], v177 offset:11520
  ds_read_b64_tr_b16 v[116:117], v178 offset:10240
  v_mfma_f32_32x32x16_bf16 v[160:175], v[212:215], v[200:203], v[160:175]
  ds_read_b64_tr_b16 v[118:119], v178 offset:11520
  s_waitcnt lgkmcnt(7)
  v_mfma_f32_32x32x16_bf16 v[128:143], v[96:99], v[192:195], v[128:143]
  ds_read_b128 v[200:203], v185 offset:20480
  ds_read_b64_tr_b16 v[204:205], v176 offset:15360
  ds_read_b64_tr_b16 v[206:207], v176 offset:16640
  v_mfma_f32_32x32x16_bf16 v[144:159], v[100:103], v[192:195], v[144:159]
  ds_read_b64_tr_b16 v[208:209], v177 offset:15360
  ds_read_b64_tr_b16 v[210:211], v177 offset:16640
  ds_read_b64_tr_b16 v[212:213], v178 offset:15360
  v_mfma_f32_32x32x16_bf16 v[160:175], v[104:107], v[192:195], v[160:175]
  ds_read_b64_tr_b16 v[214:215], v178 offset:16640
  s_waitcnt lgkmcnt(0)
  s_barrier
  v_mfma_f32_32x32x16_bf16 v[128:143], v[108:111], v[196:199], v[128:143]
  ds_read_b128 v[192:195], v182 offset:24576
  ds_read_b64_tr_b16 v[96:97], v176 offset:20480
  ds_read_b64_tr_b16 v[98:99], v176 offset:21760
  v_mfma_f32_32x32x16_bf16 v[144:159], v[112:115], v[196:199], v[144:159]
  ds_read_b64_tr_b16 v[100:101], v177 offset:20480
  ds_read_b64_tr_b16 v[102:103], v177 offset:21760
  ds_read_b64_tr_b16 v[104:105], v178 offset:20480
  v_mfma_f32_32x32x16_bf16 v[160:175], v[116:119], v[196:199], v[160:175]
  ds_read_b64_tr_b16 v[106:107], v178 offset:21760
  v_mfma_f32_32x32x16_bf16 v[128:143], v[204:207], v[200:203], v[128:143]
  ds_read_b128 v[196:199], v183 offset:24576
  ds_read_b64_tr_b16 v[108:109], v176 offset:25600
  ds_read_b64_tr_b16 v[110:111], v176 offset:26880
  v_mfma_f32_32x32x16_bf16 v[144:159], v[208:211], v[200:203], v[144:159]
  ds_read_b64_tr_b16 v[112:113], v177 offset:25600
  ds_read_b64_tr_b16 v[114:115], v177 offset:26880
  ds_read_b64_tr_b16 v[116:117], v178 offset:25600
  v_mfma_f32_32x32x16_bf16 v[160:175], v[212:215], v[200:203], v[160:175]
  ds_read_b64_tr_b16 v[118:119], v178 offset:26880
  s_waitcnt lgkmcnt(7)
  v_mfma_f32_32x32x16_bf16 v[128:143], v[96:99], v[192:195], v[128:143]
  ds_read_b128 v[200:203], v184 offset:24576
  ds_read_b64_tr_b16 v[204:205], v176 offset:30720
  ds_read_b64_tr_b16 v[206:207], v176 offset:32000
  v_mfma_f32_32x32x16_bf16 v[144:159], v[100:103], v[192:195], v[144:159]
  ds_read_b64_tr_b16 v[208:209], v177 offset:30720
  ds_read_b64_tr_b16 v[210:211], v177 offset:32000
  ds_read_b64_tr_b16 v[212:213], v178 offset:30720
  v_mfma_f32_32x32x16_bf16 v[160:175], v[104:107], v[192:195], v[160:175]
  ds_read_b64_tr_b16 v[214:215], v178 offset:32000
  s_waitcnt lgkmcnt(7)
  v_mfma_f32_32x32x16_bf16 v[128:143], v[108:111], v[196:199], v[128:143]
  ds_read_b128 v[192:195], v185 offset:24576
  ds_read_b64_tr_b16 v[96:97], v176 offset:35840
  ds_read_b64_tr_b16 v[98:99], v176 offset:37120
  v_mfma_f32_32x32x16_bf16 v[144:159], v[112:115], v[196:199], v[144:159]
  ds_read_b64_tr_b16 v[100:101], v177 offset:35840
  ds_read_b64_tr_b16 v[102:103], v177 offset:37120
  ds_read_b64_tr_b16 v[104:105], v178 offset:35840
  v_mfma_f32_32x32x16_bf16 v[160:175], v[116:119], v[196:199], v[160:175]
  ds_read_b64_tr_b16 v[106:107], v178 offset:37120
  s_waitcnt lgkmcnt(0)
  s_barrier
  v_mfma_f32_32x32x16_bf16 v[128:143], v[204:207], v[200:203], v[128:143]
  ds_read_b128 v[196:199], v182 offset:28672
  ds_read_b64_tr_b16 v[108:109], v179 offset:0
  ds_read_b64_tr_b16 v[110:111], v179 offset:1280
  v_mfma_f32_32x32x16_bf16 v[144:159], v[208:211], v[200:203], v[144:159]
  ds_read_b64_tr_b16 v[112:113], v180 offset:0
  ds_read_b64_tr_b16 v[114:115], v180 offset:1280
  ds_read_b64_tr_b16 v[116:117], v181 offset:0
  v_mfma_f32_32x32x16_bf16 v[160:175], v[212:215], v[200:203], v[160:175]
  ds_read_b64_tr_b16 v[118:119], v181 offset:1280
  v_mfma_f32_32x32x16_bf16 v[128:143], v[96:99], v[192:195], v[128:143]
  ds_read_b128 v[200:203], v183 offset:28672
  ds_read_b64_tr_b16 v[204:205], v179 offset:5120
  ds_read_b64_tr_b16 v[206:207], v179 offset:6400
  v_mfma_f32_32x32x16_bf16 v[144:159], v[100:103], v[192:195], v[144:159]
  ds_read_b64_tr_b16 v[208:209], v180 offset:5120
  ds_read_b64_tr_b16 v[210:211], v180 offset:6400
  ds_read_b64_tr_b16 v[212:213], v181 offset:5120
  v_mfma_f32_32x32x16_bf16 v[160:175], v[104:107], v[192:195], v[160:175]
  ds_read_b64_tr_b16 v[214:215], v181 offset:6400
  s_waitcnt lgkmcnt(7)
  v_mfma_f32_32x32x16_bf16 v[128:143], v[108:111], v[196:199], v[128:143]
  ds_read_b128 v[192:195], v184 offset:28672
  ds_read_b64_tr_b16 v[96:97], v179 offset:10240
  ds_read_b64_tr_b16 v[98:99], v179 offset:11520
  v_mfma_f32_32x32x16_bf16 v[144:159], v[112:115], v[196:199], v[144:159]
  ds_read_b64_tr_b16 v[100:101], v180 offset:10240
  ds_read_b64_tr_b16 v[102:103], v180 offset:11520
  ds_read_b64_tr_b16 v[104:105], v181 offset:10240
  v_mfma_f32_32x32x16_bf16 v[160:175], v[116:119], v[196:199], v[160:175]
  ds_read_b64_tr_b16 v[106:107], v181 offset:11520
  s_waitcnt lgkmcnt(7)
  v_mfma_f32_32x32x16_bf16 v[128:143], v[204:207], v[200:203], v[128:143]
  ds_read_b128 v[196:199], v185 offset:28672
  ds_read_b64_tr_b16 v[108:109], v179 offset:15360
  ds_read_b64_tr_b16 v[110:111], v179 offset:16640
  v_mfma_f32_32x32x16_bf16 v[144:159], v[208:211], v[200:203], v[144:159]
  ds_read_b64_tr_b16 v[112:113], v180 offset:15360
  ds_read_b64_tr_b16 v[114:115], v180 offset:16640
  ds_read_b64_tr_b16 v[116:117], v181 offset:15360
  v_mfma_f32_32x32x16_bf16 v[160:175], v[212:215], v[200:203], v[160:175]
  ds_read_b64_tr_b16 v[118:119], v181 offset:16640
  s_waitcnt lgkmcnt(0)
  s_barrier
  v_mfma_f32_32x32x16_bf16 v[128:143], v[96:99], v[192:195], v[128:143]
  ds_read_b128 v[200:203], v182 offset:32768
  ds_read_b64_tr_b16 v[204:205], v186 offset:0
  ds_read_b64_tr_b16 v[206:207], v186 offset:1280
  v_mfma_f32_32x32x16_bf16 v[144:159], v[100:103], v[192:195], v[144:159]
  ds_read_b64_tr_b16 v[208:209], v187 offset:0
  ds_read_b64_tr_b16 v[210:211], v187 offset:1280
  ds_read_b64_tr_b16 v[212:213], v188 offset:0
  v_mfma_f32_32x32x16_bf16 v[160:175], v[104:107], v[192:195], v[160:175]
  ds_read_b64_tr_b16 v[214:215], v188 offset:1280
  v_mfma_f32_32x32x16_bf16 v[128:143], v[108:111], v[196:199], v[128:143]
  ds_read_b128 v[192:195], v183 offset:32768
  ds_read_b64_tr_b16 v[96:97], v186 offset:5120
  ds_read_b64_tr_b16 v[98:99], v186 offset:6400
  v_mfma_f32_32x32x16_bf16 v[144:159], v[112:115], v[196:199], v[144:159]
  ds_read_b64_tr_b16 v[100:101], v187 offset:5120
  ds_read_b64_tr_b16 v[102:103], v187 offset:6400
  ds_read_b64_tr_b16 v[104:105], v188 offset:5120
  v_mfma_f32_32x32x16_bf16 v[160:175], v[116:119], v[196:199], v[160:175]
  ds_read_b64_tr_b16 v[106:107], v188 offset:6400
  s_waitcnt lgkmcnt(7)
  v_mfma_f32_32x32x16_bf16 v[128:143], v[204:207], v[200:203], v[128:143]
  ds_read_b128 v[196:199], v184 offset:32768
  ds_read_b64_tr_b16 v[108:109], v186 offset:10240
  ds_read_b64_tr_b16 v[110:111], v186 offset:11520
  v_mfma_f32_32x32x16_bf16 v[144:159], v[208:211], v[200:203], v[144:159]
  ds_read_b64_tr_b16 v[112:113], v187 offset:10240
  ds_read_b64_tr_b16 v[114:115], v187 offset:11520
  ds_read_b64_tr_b16 v[116:117], v188 offset:10240
  v_mfma_f32_32x32x16_bf16 v[160:175], v[212:215], v[200:203], v[160:175]
  ds_read_b64_tr_b16 v[118:119], v188 offset:11520
  s_waitcnt lgkmcnt(7)
  v_mfma_f32_32x32x16_bf16 v[128:143], v[96:99], v[192:195], v[128:143]
  ds_read_b128 v[200:203], v185 offset:32768
  ds_read_b64_tr_b16 v[204:205], v186 offset:15360
  ds_read_b64_tr_b16 v[206:207], v186 offset:16640
  v_mfma_f32_32x32x16_bf16 v[144:159], v[100:103], v[192:195], v[144:159]
  ds_read_b64_tr_b16 v[208:209], v187 offset:15360
  ds_read_b64_tr_b16 v[210:211], v187 offset:16640
  ds_read_b64_tr_b16 v[212:213], v188 offset:15360
  v_mfma_f32_32x32x16_bf16 v[160:175], v[104:107], v[192:195], v[160:175]
  ds_read_b64_tr_b16 v[214:215], v188 offset:16640
  ds_read_b32 v228, v92 offset:48
  s_waitcnt lgkmcnt(0)
  s_barrier
  v_mfma_f32_32x32x16_bf16 v[128:143], v[108:111], v[196:199], v[128:143]
  ds_read_b128 v[192:195], v182 offset:36864
  ds_read_b64_tr_b16 v[96:97], v186 offset:20480
  ds_read_b64_tr_b16 v[98:99], v186 offset:21760
  v_mfma_f32_32x32x16_bf16 v[144:159], v[112:115], v[196:199], v[144:159]
  ds_read_b64_tr_b16 v[100:101], v187 offset:20480
  ds_read_b64_tr_b16 v[102:103], v187 offset:21760
  ds_read_b64_tr_b16 v[104:105], v188 offset:20480
  v_mfma_f32_32x32x16_bf16 v[160:175], v[116:119], v[196:199], v[160:175]
  ds_read_b64_tr_b16 v[106:107], v188 offset:21760
  v_readfirstlane_b32 s16, v228
  s_nop 0
  s_cmp_eq_u32 s16, 0
  s_cbranch_scc1 gated_mix__grouped_kv_mqa__geglu_ffn__prompt_kernel_e0
  buffer_load_dword v239, v15, s[8:11], s13 offen sc1
  buffer_load_dwordx4 v[56:59], v2, s[8:11], s14 offen sc1
  buffer_load_dwordx4 v[62:65], v8, s[8:11], s14 offen sc1
  buffer_load_dwordx4 v[68:71], v5, s[8:11], s14 offen offset:0 sc1
  buffer_load_dwordx4 v[72:75], v5, s[8:11], s14 offen offset:688 sc1
  buffer_load_dwordx4 v[240:243], v2, s[8:11], s14 offen offset:1024 sc1
  buffer_load_dwordx4 v[244:247], v5, s[8:11], s14 offen offset:1376 sc1
  buffer_load_dwordx4 v[248:251], v5, s[8:11], s14 offen offset:2064 sc1
  buffer_load_dword v6, v238, s[8:11], s18 offen sc1
gated_mix__grouped_kv_mqa__geglu_ffn__prompt_kernel_e0:
  v_mfma_f32_32x32x16_bf16 v[128:143], v[204:207], v[200:203], v[128:143]
  ds_read_b128 v[196:199], v183 offset:36864
  ds_read_b64_tr_b16 v[108:109], v186 offset:25600
  ds_read_b64_tr_b16 v[110:111], v186 offset:26880
  v_mfma_f32_32x32x16_bf16 v[144:159], v[208:211], v[200:203], v[144:159]
  ds_read_b64_tr_b16 v[112:113], v187 offset:25600
  ds_read_b64_tr_b16 v[114:115], v187 offset:26880
  ds_read_b64_tr_b16 v[116:117], v188 offset:25600
  v_mfma_f32_32x32x16_bf16 v[160:175], v[212:215], v[200:203], v[160:175]
  ds_read_b64_tr_b16 v[118:119], v188 offset:26880
  s_waitcnt lgkmcnt(7)
  v_mfma_f32_32x32x16_bf16 v[128:143], v[96:99], v[192:195], v[128:143]
  ds_read_b128 v[200:203], v184 offset:36864
  ds_read_b64_tr_b16 v[204:205], v186 offset:30720
  ds_read_b64_tr_b16 v[206:207], v186 offset:32000
  v_mfma_f32_32x32x16_bf16 v[144:159], v[100:103], v[192:195], v[144:159]
  ds_read_b64_tr_b16 v[208:209], v187 offset:30720
  ds_read_b64_tr_b16 v[210:211], v187 offset:32000
  ds_read_b64_tr_b16 v[212:213], v188 offset:30720
  v_mfma_f32_32x32x16_bf16 v[160:175], v[104:107], v[192:195], v[160:175]
  ds_read_b64_tr_b16 v[214:215], v188 offset:32000
  s_waitcnt lgkmcnt(7)
  v_mfma_f32_32x32x16_bf16 v[128:143], v[108:111], v[196:199], v[128:143]
  ds_read_b128 v[192:195], v185 offset:36864
  ds_read_b64_tr_b16 v[96:97], v186 offset:35840
  ds_read_b64_tr_b16 v[98:99], v186 offset:37120
  v_mfma_f32_32x32x16_bf16 v[144:159], v[112:115], v[196:199], v[144:159]
  ds_read_b64_tr_b16 v[100:101], v187 offset:35840
  ds_read_b64_tr_b16 v[102:103], v187 offset:37120
  ds_read_b64_tr_b16 v[104:105], v188 offset:35840
  v_mfma_f32_32x32x16_bf16 v[160:175], v[116:119], v[196:199], v[160:175]
  ds_read_b64_tr_b16 v[106:107], v188 offset:37120
  s_waitcnt lgkmcnt(0)
  s_barrier
  v_mfma_f32_32x32x16_bf16 v[128:143], v[204:207], v[200:203], v[128:143]
  v_mfma_f32_32x32x16_bf16 v[144:159], v[208:211], v[200:203], v[144:159]
  v_mfma_f32_32x32x16_bf16 v[160:175], v[212:215], v[200:203], v[160:175]
  v_mfma_f32_32x32x16_bf16 v[128:143], v[96:99], v[192:195], v[128:143]
  v_mfma_f32_32x32x16_bf16 v[144:159], v[100:103], v[192:195], v[144:159]
  v_mfma_f32_32x32x16_bf16 v[160:175], v[104:107], v[192:195], v[160:175]
  s_nop 9
  v_pk_mul_f32 v[128:129], v[128:129], v[12:13]
  v_pk_mul_f32 v[130:131], v[130:131], v[12:13]
  v_pk_mul_f32 v[132:133], v[132:133], v[12:13]
  v_pk_mul_f32 v[134:135], v[134:135], v[12:13]
  v_pk_mul_f32 v[136:137], v[136:137], v[12:13]
  v_pk_mul_f32 v[138:139], v[138:139], v[12:13]
  v_pk_mul_f32 v[140:141], v[140:141], v[12:13]
  v_pk_mul_f32 v[142:143], v[142:143], v[12:13]
  v_pk_mul_f32 v[144:145], v[144:145], v[12:13]
  v_pk_mul_f32 v[146:147], v[146:147], v[12:13]
  v_pk_mul_f32 v[148:149], v[148:149], v[12:13]
  v_pk_mul_f32 v[150:151], v[150:151], v[12:13]
  v_pk_mul_f32 v[152:153], v[152:153], v[12:13]
  v_pk_mul_f32 v[154:155], v[154:155], v[12:13]
  v_pk_mul_f32 v[156:157], v[156:157], v[12:13]
  v_pk_mul_f32 v[158:159], v[158:159], v[12:13]
  v_pk_mul_f32 v[160:161], v[160:161], v[12:13]
  v_pk_mul_f32 v[162:163], v[162:163], v[12:13]
  v_pk_mul_f32 v[164:165], v[164:165], v[12:13]
  v_pk_mul_f32 v[166:167], v[166:167], v[12:13]
  v_pk_mul_f32 v[168:169], v[168:169], v[12:13]
  v_pk_mul_f32 v[170:171], v[170:171], v[12:13]
  v_pk_mul_f32 v[172:173], v[172:173], v[12:13]
  v_pk_mul_f32 v[174:175], v[174:175], v[12:13]
  v_cvt_pk_bf16_f32 v16, v128, v129
  v_cvt_pk_bf16_f32 v17, v130, v131
  v_cvt_pk_bf16_f32 v18, v132, v133
  v_cvt_pk_bf16_f32 v19, v134, v135
  v_cvt_pk_bf16_f32 v20, v136, v137
  v_cvt_pk_bf16_f32 v21, v138, v139
  v_cvt_pk_bf16_f32 v22, v140, v141
  v_cvt_pk_bf16_f32 v23, v142, v143
  v_cvt_pk_bf16_f32 v24, v144, v145
  v_cvt_pk_bf16_f32 v25, v146, v147
  v_cvt_pk_bf16_f32 v26, v148, v149
  v_cvt_pk_bf16_f32 v27, v150, v151
  v_cvt_pk_bf16_f32 v28, v152, v153
  v_cvt_pk_bf16_f32 v29, v154, v155
  v_cvt_pk_bf16_f32 v30, v156, v157
  v_cvt_pk_bf16_f32 v31, v158, v159
  s_mov_b32 exec_hi, 0
  v_cvt_pk_bf16_f32 v34, v160, v161
  v_cvt_pk_bf16_f32 v35, v162, v163
  v_cvt_pk_bf16_f32 v40, v164, v165
  v_cvt_pk_bf16_f32 v41, v166, v167
  v_cvt_pk_bf16_f32 v46, v168, v169
  v_cvt_pk_bf16_f32 v47, v170, v171
  v_cvt_pk_bf16_f32 v52, v172, v173
  v_cvt_pk_bf16_f32 v53, v174, v175
  s_mov_b32 exec_hi, -1
  v_mov_b32 v9, 0
  v_mov_b32 v10, 0
  v_mov_b32 v13, 0
  v_mov_b32 v14, 0
  v_dot2c_f32_bf16 v9, v16, v16
  v_dot2c_f32_bf16 v10, v20, v20
  v_dot2c_f32_bf16 v13, v24, v24
  v_dot2c_f32_bf16 v14, v28, v28
  v_dot2c_f32_bf16 v9, v17, v17
  v_dot2c_f32_bf16 v10, v21, v21
  v_dot2c_f32_bf16 v13, v25, v25
  v_dot2c_f32_bf16 v14, v29, v29
  v_dot2c_f32_bf16 v9, v18, v18
  v_dot2c_f32_bf16 v10, v22, v22
  v_dot2c_f32_bf16 v13, v26, v26
  v_dot2c_f32_bf16 v14, v30, v30
  v_dot2c_f32_bf16 v9, v19, v19
  v_dot2c_f32_bf16 v10, v23, v23
  v_dot2c_f32_bf16 v13, v27, v27
  v_dot2c_f32_bf16 v14, v31, v31
  v_dot2c_f32_bf16 v9, v34, v34
  v_dot2c_f32_bf16 v10, v40, v40
  v_dot2c_f32_bf16 v13, v46, v46
  v_dot2c_f32_bf16 v14, v52, v52
  v_dot2c_f32_bf16 v9, v35, v35
  v_dot2c_f32_bf16 v10, v41, v41
  v_dot2c_f32_bf16 v13, v47, v47
  v_dot2c_f32_bf16 v14, v53, v53
  v_mov_b32 v204, v9
  v_mov_b32 v205, v10
  v_mov_b32 v206, v13
  v_mov_b32 v207, v14
  v_permlane32_swap_b32 v204, v9
  v_permlane32_swap_b32 v205, v10
  v_permlane32_swap_b32 v206, v13
  v_permlane32_swap_b32 v207, v14
  v_add_f32 v9, v9, v204
  v_add_f32 v10, v10, v205
  v_add_f32 v13, v13, v206
  v_add_f32 v14, v14, v207
  s_cmp_lg_u32 s16, 0
  s_cbranch_scc1 gated_mix__grouped_kv_mqa__geglu_ffn__prompt_kernel_e2
gated_mix__grouped_kv_mqa__geglu_ffn__prompt_kernel_sp_1:
  ds_read_b32 v12, v92 offset:48
  s_waitcnt lgkmcnt(0)
  v_readfirstlane_b32 s12, v12
  s_nop 0
  s_cmp_ge_u32 s12, 1
  s_cbranch_scc1 gated_mix__grouped_kv_mqa__geglu_ffn__prompt_kernel_sp_1_d
  s_sub_u32 s28, s28, 1
  s_cbranch_scc0 gated_mix__grouped_kv_mqa__geglu_ffn__prompt_kernel_sp_1
gated_mix__grouped_kv_mqa__geglu_ffn__prompt_kernel_sp_1_d:
  buffer_load_dword v239, v15, s[8:11], s13 offen sc1
  buffer_load_dwordx4 v[56:59], v2, s[8:11], s14 offen sc1
  buffer_load_dwordx4 v[62:65], v8, s[8:11], s14 offen sc1
  buffer_load_dwordx4 v[68:71], v5, s[8:11], s14 offen offset:0 sc1
  buffer_load_dwordx4 v[72:75], v5, s[8:11], s14 offen offset:688 sc1
  buffer_load_dwordx4 v[240:243], v2, s[8:11], s14 offen offset:1024 sc1
  buffer_load_dwordx4 v[244:247], v5, s[8:11], s14 offen offset:1376 sc1
  buffer_load_dwordx4 v[248:251], v5, s[8:11], s14 offen offset:2064 sc1
  buffer_load_dword v6, v238, s[8:11], s18 offen sc1
gated_mix__grouped_kv_mqa__geglu_ffn__prompt_kernel_e2:
  v_add_u32 v3, s15, v2
  v_add_u32 v8, s15, v8
  v_add_u32 v5, s15, v5
  s_waitcnt vmcnt(8)
  v_max_f32_dpp v239, v239, v239 row_shr:1 row_mask:0xf bank_mask:0xf
  s_nop 1
  v_max_f32_dpp v239, v239, v239 row_shr:2 row_mask:0xf bank_mask:0xf
  s_nop 1
  v_max_f32_dpp v239, v239, v239 row_shr:4 row_mask:0xf bank_mask:0xf
  s_nop 1
  v_max_f32_dpp v239, v239, v239 row_shr:8 row_mask:0xf bank_mask:0xf
  s_nop 0
  v_readlane_b32 s12, v239, 15
  v_readlane_b32 s13, v239, 31
  v_readlane_b32 s14, v239, 47
  v_readlane_b32 s15, v239, 63
  s_max_u32 s12, s12, s13
  s_max_u32 s14, s14, s15
  s_max_u32 s12, s12, s14
  v_mul_f32 v9, s12, v9
  v_mul_f32 v10, s12, v10
  v_mul_f32 v13, s12, v13
  v_mul_f32 v14, s12, v14
  v_mul_f32 v9, 0x3f828f5c, v9
  v_mul_f32 v10, 0x3f828f5c, v10
  v_mul_f32 v13, 0x3f828f5c, v13
  v_mul_f32 v14, 0x3f828f5c, v14
  v_sqrt_f32 v9, v9
  v_sqrt_f32 v10, v10
  v_sqrt_f32 v13, v13
  v_sqrt_f32 v14, v14
  s_mov_b32 exec_hi, 0
  v_cvt_pk_bf16_f32 v32, -v9, 0
  v_cvt_pk_bf16_f32 v38, -v10, 0
  v_cvt_pk_bf16_f32 v44, -v13, 0
  v_cvt_pk_bf16_f32 v50, -v14, 0
  v_mov_b32 v36, v32
  v_mov_b32 v42, v38
  v_mov_b32 v48, v44
  v_mov_b32 v54, v50
  s_mov_b32 exec_hi, -1
  s_waitcnt vmcnt(6)
  v_mfma_f32_32x32x16_bf16 v[96:111], v[56:59], v[16:19], 0
  v_mfma_f32_32x32x16_bf16 v[96:111], v[60:63], v[32:35], v[96:111]
  v_mfma_f32_32x32x16_bf16 v[112:127], v[56:59], v[20:23], 0
  s_nop 10
  v_exp_f32 v96, v96
  v_exp_f32 v97, v97
  v_exp_f32 v98, v98
  v_exp_f32 v99, v99
  v_mfma_f32_32x32x16_bf16 v[112:127], v[60:63], v[38:41], v[112:127]
  v_exp_f32 v100, v100
  v_exp_f32 v101, v101
  v_cvt_pk_bf16_f32 v76, v96, v97
  v_cvt_pk_bf16_f32 v77, v98, v99
  v_exp_f32 v102, v102
  v_exp_f32 v103, v103
  v_cvt_pk_bf16_f32 v78, v100, v101
  v_exp_f32 v104, v104
  v_cvt_pk_bf16_f32 v79, v102, v103
  v_exp_f32 v105, v105
  v_exp_f32 v106, v106
  v_exp_f32 v107, v107
  v_cvt_pk_bf16_f32 v80, v104, v105
  v_exp_f32 v108, v108
  v_cvt_pk_bf16_f32 v81, v106, v107
  v_exp_f32 v109, v109
  v_exp_f32 v110, v110
  v_exp_f32 v111, v111
  v_cvt_pk_bf16_f32 v82, v108, v109
  v_cvt_pk_bf16_f32 v83, v110, v111
  v_mfma_f32_32x32x16_bf16 v[96:111], v[56:59], v[24:27], 0
  v_exp_f32 v112, v112
  v_exp_f32 v113, v113
  v_exp_f32 v114, v114
  v_exp_f32 v115, v115
  v_mfma_f32_32x32x16_bf16 v[96:111], v[60:63], v[44:47], v[96:111]
  v_exp_f32 v116, v116
  v_exp_f32 v117, v117
  v_cvt_pk_bf16_f32 v84, v112, v113
  v_cvt_pk_bf16_f32 v85, v114, v115
  v_exp_f32 v118, v118
  v_exp_f32 v119, v119
  s_waitcnt vmcnt(4)
  v_mfma_f32_32x32x16_bf16 v[128:143], v[68:71], v[76:79], 0
  v_cvt_pk_bf16_f32 v86, v116, v117
  v_exp_f32 v120, v120
  v_cvt_pk_bf16_f32 v87, v118, v119
  v_exp_f32 v121, v121
  v_exp_f32 v122, v122
  v_exp_f32 v123, v123
  v_mfma_f32_32x32x16_bf16 v[128:143], v[72:75], v[80:83], v[128:143]
  v_cvt_pk_bf16_f32 v88, v120, v121
  v_exp_f32 v124, v124
  v_cvt_pk_bf16_f32 v89, v122, v123
  v_exp_f32 v125, v125
  v_exp_f32 v126, v126
  v_exp_f32 v127, v127
  v_cvt_pk_bf16_f32 v90, v124, v125
  v_cvt_pk_bf16_f32 v91, v126, v127
  v_mfma_f32_32x32x16_bf16 v[112:127], v[56:59], v[28:31], 0
  v_exp_f32 v96, v96
  v_exp_f32 v97, v97
  v_exp_f32 v98, v98
  v_exp_f32 v99, v99
  v_mfma_f32_32x32x16_bf16 v[112:127], v[60:63], v[50:53], v[112:127]
  v_exp_f32 v100, v100
  v_exp_f32 v101, v101
  v_cvt_pk_bf16_f32 v76, v96, v97
  v_cvt_pk_bf16_f32 v77, v98, v99
  v_exp_f32 v102, v102
  v_exp_f32 v103, v103
  v_mfma_f32_32x32x16_bf16 v[144:159], v[68:71], v[84:87], 0
  v_cvt_pk_bf16_f32 v78, v100, v101
  v_exp_f32 v104, v104
  v_cvt_pk_bf16_f32 v79, v102, v103
  v_exp_f32 v105, v105
  v_exp_f32 v106, v106
  v_exp_f32 v107, v107
  v_mfma_f32_32x32x16_bf16 v[144:159], v[72:75], v[88:91], v[144:159]
  v_cvt_pk_bf16_f32 v80, v104, v105
  v_exp_f32 v108, v108
  v_cvt_pk_bf16_f32 v81, v106, v107
  v_exp_f32 v109, v109
  v_exp_f32 v110, v110
  v_exp_f32 v111, v111
  v_cvt_pk_bf16_f32 v82, v108, v109
  v_cvt_pk_bf16_f32 v83, v110, v111
  s_waitcnt vmcnt(3)
  v_mfma_f32_32x32x16_bf16 v[96:111], v[240:243], v[16:19], 0
  v_exp_f32 v112, v112
  v_exp_f32 v113, v113
  v_exp_f32 v114, v114
  v_exp_f32 v115, v115
  v_mfma_f32_32x32x16_bf16 v[96:111], v[64:67], v[34:37], v[96:111]
  v_exp_f32 v116, v116
  v_exp_f32 v117, v117
  v_cvt_pk_bf16_f32 v84, v112, v113
  v_cvt_pk_bf16_f32 v85, v114, v115
  v_exp_f32 v118, v118
  v_exp_f32 v119, v119
  v_mfma_f32_32x32x16_bf16 v[160:175], v[68:71], v[76:79], 0
  v_cvt_pk_bf16_f32 v86, v116, v117
  v_exp_f32 v120, v120
  v_cvt_pk_bf16_f32 v87, v118, v119
  v_exp_f32 v121, v121
  v_exp_f32 v122, v122
  v_exp_f32 v123, v123
  v_mfma_f32_32x32x16_bf16 v[160:175], v[72:75], v[80:83], v[160:175]
  v_cvt_pk_bf16_f32 v88, v120, v121
  v_exp_f32 v124, v124
  v_cvt_pk_bf16_f32 v89, v122, v123
  v_exp_f32 v125, v125
  v_exp_f32 v126, v126
  v_exp_f32 v127, v127
  v_cvt_pk_bf16_f32 v90, v124, v125
  v_cvt_pk_bf16_f32 v91, v126, v127
  v_mfma_f32_32x32x16_bf16 v[112:127], v[240:243], v[20:23], 0
  v_exp_f32 v96, v96
  v_exp_f32 v97, v97
  v_exp_f32 v98, v98
  v_exp_f32 v99, v99
  v_mfma_f32_32x32x16_bf16 v[112:127], v[64:67], v[40:43], v[112:127]
  v_exp_f32 v100, v100
  v_exp_f32 v101, v101
  v_cvt_pk_bf16_f32 v76, v96, v97
  v_cvt_pk_bf16_f32 v77, v98, v99
  v_exp_f32 v102, v102
  v_exp_f32 v103, v103
  v_mfma_f32_32x32x16_bf16 v[176:191], v[68:71], v[84:87], 0
  v_cvt_pk_bf16_f32 v78, v100, v101
  v_exp_f32 v104, v104
  v_cvt_pk_bf16_f32 v79, v102, v103
  v_exp_f32 v105, v105
  v_exp_f32 v106, v106
  v_exp_f32 v107, v107
  v_mfma_f32_32x32x16_bf16 v[176:191], v[72:75], v[88:91], v[176:191]
  v_cvt_pk_bf16_f32 v80, v104, v105
  v_exp_f32 v108, v108
  v_cvt_pk_bf16_f32 v81, v106, v107
  v_exp_f32 v109, v109
  v_exp_f32 v110, v110
  v_exp_f32 v111, v111
  v_cvt_pk_bf16_f32 v82, v108, v109
  v_cvt_pk_bf16_f32 v83, v110, v111
  v_mfma_f32_32x32x16_bf16 v[96:111], v[240:243], v[24:27], 0
  v_exp_f32 v112, v112
  v_exp_f32 v113, v113
  v_exp_f32 v114, v114
  v_exp_f32 v115, v115
  v_mfma_f32_32x32x16_bf16 v[96:111], v[64:67], v[46:49], v[96:111]
  v_exp_f32 v116, v116
  v_exp_f32 v117, v117
  v_cvt_pk_bf16_f32 v84, v112, v113
  v_cvt_pk_bf16_f32 v85, v114, v115
  v_exp_f32 v118, v118
  v_exp_f32 v119, v119
  s_waitcnt vmcnt(1)
  v_mfma_f32_32x32x16_bf16 v[128:143], v[244:247], v[76:79], v[128:143]
  v_cvt_pk_bf16_f32 v86, v116, v117
  v_exp_f32 v120, v120
  v_cvt_pk_bf16_f32 v87, v118, v119
  v_exp_f32 v121, v121
  v_exp_f32 v122, v122
  v_exp_f32 v123, v123
  v_mfma_f32_32x32x16_bf16 v[128:143], v[248:251], v[80:83], v[128:143]
  v_cvt_pk_bf16_f32 v88, v120, v121
  v_exp_f32 v124, v124
  v_cvt_pk_bf16_f32 v89, v122, v123
  v_exp_f32 v125, v125
  v_exp_f32 v126, v126
  v_exp_f32 v127, v127
  v_cvt_pk_bf16_f32 v90, v124, v125
  v_cvt_pk_bf16_f32 v91, v126, v127
gated_mix__grouped_kv_mqa__geglu_ffn__prompt_kernel_sp_2:
  ds_read_b32 v9, v92 offset:0
  s_waitcnt lgkmcnt(0)
  v_readfirstlane_b32 s12, v9
  s_nop 0
  s_cmp_ge_u32 s12, 4
  s_cbranch_scc1 gated_mix__grouped_kv_mqa__geglu_ffn__prompt_kernel_sp_2_d
  s_sub_u32 s28, s28, 1
  s_cbranch_scc0 gated_mix__grouped_kv_mqa__geglu_ffn__prompt_kernel_sp_2
gated_mix__grouped_kv_mqa__geglu_ffn__prompt_kernel_sp_2_d:
  v_mfma_f32_32x32x16_bf16 v[112:127], v[240:243], v[28:31], 0
  ds_read_b128 v[56:59], v3 offset:0
  v_exp_f32 v96, v96
  v_exp_f32 v97, v97
  v_exp_f32 v98, v98
  v_exp_f32 v99, v99
  v_mfma_f32_32x32x16_bf16 v[112:127], v[64:67], v[52:55], v[112:127]
  ds_read_b128 v[62:65], v8 offset:0
  v_exp_f32 v100, v100
  v_exp_f32 v101, v101
  v_cvt_pk_bf16_f32 v76, v96, v97
  v_cvt_pk_bf16_f32 v77, v98, v99
  v_exp_f32 v102, v102
  v_exp_f32 v103, v103
  v_mfma_f32_32x32x16_bf16 v[144:159], v[244:247], v[84:87], v[144:159]
  v_cvt_pk_bf16_f32 v78, v100, v101
  v_exp_f32 v104, v104
  v_cvt_pk_bf16_f32 v79, v102, v103
  v_exp_f32 v105, v105
  v_exp_f32 v106, v106
  v_exp_f32 v107, v107
  v_mfma_f32_32x32x16_bf16 v[144:159], v[248:251], v[88:91], v[144:159]
  v_cvt_pk_bf16_f32 v80, v104, v105
  v_exp_f32 v108, v108
  v_cvt_pk_bf16_f32 v81, v106, v107
  v_exp_f32 v109, v109
  v_exp_f32 v110, v110
  v_exp_f32 v111, v111
  v_cvt_pk_bf16_f32 v82, v108, v109
  v_cvt_pk_bf16_f32 v83, v110, v111
  s_waitcnt lgkmcnt(0)
  v_mfma_f32_32x32x16_bf16 v[96:111], v[56:59], v[16:19], 0
  v_exp_f32 v112, v112
  v_exp_f32 v113, v113
  v_exp_f32 v114, v114
  v_exp_f32 v115, v115
  v_mfma_f32_32x32x16_bf16 v[96:111], v[60:63], v[32:35], v[96:111]
  v_exp_f32 v116, v116
  v_exp_f32 v117, v117
  v_cvt_pk_bf16_f32 v84, v112, v113
  v_cvt_pk_bf16_f32 v85, v114, v115
  v_exp_f32 v118, v118
  v_exp_f32 v119, v119
  v_mfma_f32_32x32x16_bf16 v[160:175], v[244:247], v[76:79], v[160:175]
  v_cvt_pk_bf16_f32 v86, v116, v117
  v_exp_f32 v120, v120
  v_cvt_pk_bf16_f32 v87, v118, v119
  v_exp_f32 v121, v121
  v_exp_f32 v122, v122
  v_exp_f32 v123, v123
  v_mfma_f32_32x32x16_bf16 v[160:175], v[248:251], v[80:83], v[160:175]
  v_cvt_pk_bf16_f32 v88, v120, v121
  v_exp_f32 v124, v124
  v_cvt_pk_bf16_f32 v89, v122, v123
  v_exp_f32 v125, v125
  v_exp_f32 v126, v126
  v_exp_f32 v127, v127
  v_cvt_pk_bf16_f32 v90, v124, v125
  v_cvt_pk_bf16_f32 v91, v126, v127
  v_mfma_f32_32x32x16_bf16 v[112:127], v[56:59], v[20:23], 0
  v_exp_f32 v96, v96
  v_exp_f32 v97, v97
  v_exp_f32 v98, v98
  v_exp_f32 v99, v99
  v_mfma_f32_32x32x16_bf16 v[112:127], v[60:63], v[38:41], v[112:127]
  v_exp_f32 v100, v100
  v_exp_f32 v101, v101
  v_cvt_pk_bf16_f32 v76, v96, v97
  v_cvt_pk_bf16_f32 v77, v98, v99
  v_exp_f32 v102, v102
  v_exp_f32 v103, v103
  v_mfma_f32_32x32x16_bf16 v[176:191], v[244:247], v[84:87], v[176:191]
  ds_read_b128 v[68:71], v5 offset:0
  v_cvt_pk_bf16_f32 v78, v100, v101
  v_exp_f32 v104, v104
  v_cvt_pk_bf16_f32 v79, v102, v103
  v_exp_f32 v105, v105
  v_exp_f32 v106, v106
  v_exp_f32 v107, v107
  v_mfma_f32_32x32x16_bf16 v[176:191], v[248:251], v[88:91], v[176:191]
  ds_read_b128 v[72:75], v5 offset:688
  v_cvt_pk_bf16_f32 v80, v104, v105
  v_exp_f32 v108, v108
  v_cvt_pk_bf16_f32 v81, v106, v107
  v_exp_f32 v109, v109
  v_exp_f32 v110, v110
  v_exp_f32 v111, v111
  v_cvt_pk_bf16_f32 v82, v108, v109
  v_cvt_pk_bf16_f32 v83, v110, v111
gated_mix__grouped_kv_mqa__geglu_ffn__prompt_kernel_sp_3:
  ds_read_b32 v9, v92 offset:4
  s_waitcnt lgkmcnt(0)
  v_readfirstlane_b32 s12, v9
  s_nop 0
  s_cmp_ge_u32 s12, 4
  s_cbranch_scc1 gated_mix__grouped_kv_mqa__geglu_ffn__prompt_kernel_sp_3_d
  s_sub_u32 s28, s28, 1
  s_cbranch_scc0 gated_mix__grouped_kv_mqa__geglu_ffn__prompt_kernel_sp_3
gated_mix__grouped_kv_mqa__geglu_ffn__prompt_kernel_sp_3_d:
  s_mov_b32 s16, 7
gated_mix__grouped_kv_mqa__geglu_ffn__prompt_kernel_loop:
  v_mfma_f32_32x32x16_bf16 v[96:111], v[56:59], v[24:27], 0
  v_exp_f32 v112, v112
  v_exp_f32 v113, v113
  v_exp_f32 v114, v114
  v_exp_f32 v115, v115
  v_mfma_f32_32x32x16_bf16 v[96:111], v[60:63], v[44:47], v[96:111]
  v_exp_f32 v116, v116
  v_exp_f32 v117, v117
  v_cvt_pk_bf16_f32 v84, v112, v113
  v_cvt_pk_bf16_f32 v85, v114, v115
  v_exp_f32 v118, v118
  v_exp_f32 v119, v119
  s_waitcnt lgkmcnt(0)
  v_mfma_f32_32x32x16_bf16 v[128:143], v[68:71], v[76:79], v[128:143]
  v_cvt_pk_bf16_f32 v86, v116, v117
  v_exp_f32 v120, v120
  v_cvt_pk_bf16_f32 v87, v118, v119
  v_exp_f32 v121, v121
  v_exp_f32 v122, v122
  v_exp_f32 v123, v123
  v_mfma_f32_32x32x16_bf16 v[128:143], v[72:75], v[80:83], v[128:143]
  v_cvt_pk_bf16_f32 v88, v120, v121
  v_exp_f32 v124, v124
  v_cvt_pk_bf16_f32 v89, v122, v123
  v_exp_f32 v125, v125
  v_exp_f32 v126, v126
  v_exp_f32 v127, v127
  v_cvt_pk_bf16_f32 v90, v124, v125
  v_cvt_pk_bf16_f32 v91, v126, v127
  v_mfma_f32_32x32x16_bf16 v[112:127], v[56:59], v[28:31], 0
  ds_read_b128 v[56:59], v3 offset:1024
  v_exp_f32 v96, v96
  v_exp_f32 v97, v97
  v_exp_f32 v98, v98
  v_exp_f32 v99, v99
  v_mfma_f32_32x32x16_bf16 v[112:127], v[60:63], v[50:53], v[112:127]
  v_exp_f32 v100, v100
  v_exp_f32 v101, v101
  v_cvt_pk_bf16_f32 v76, v96, v97
  v_cvt_pk_bf16_f32 v77, v98, v99
  v_exp_f32 v102, v102
  v_exp_f32 v103, v103
  v_mfma_f32_32x32x16_bf16 v[144:159], v[68:71], v[84:87], v[144:159]
  v_cvt_pk_bf16_f32 v78, v100, v101
  v_exp_f32 v104, v104
  v_cvt_pk_bf16_f32 v79, v102, v103
  v_exp_f32 v105, v105
  v_exp_f32 v106, v106
  v_exp_f32 v107, v107
  v_mfma_f32_32x32x16_bf16 v[144:159], v[72:75], v[88:91], v[144:159]
  v_cvt_pk_bf16_f32 v80, v104, v105
  v_exp_f32 v108, v108
  v_cvt_pk_bf16_f32 v81, v106, v107
  v_exp_f32 v109, v109
  v_exp_f32 v110, v110
  v_exp_f32 v111, v111
  v_cvt_pk_bf16_f32 v82, v108, v109
  v_cvt_pk_bf16_f32 v83, v110, v111
  s_waitcnt lgkmcnt(0)
  v_mfma_f32_32x32x16_bf16 v[96:111], v[56:59], v[16:19], 0
  v_exp_f32 v112, v112
  v_exp_f32 v113, v113
  v_exp_f32 v114, v114
  v_exp_f32 v115, v115
  v_mfma_f32_32x32x16_bf16 v[96:111], v[64:67], v[34:37], v[96:111]
  v_exp_f32 v116, v116
  v_exp_f32 v117, v117
  v_cvt_pk_bf16_f32 v84, v112, v113
  v_cvt_pk_bf16_f32 v85, v114, v115
  v_exp_f32 v118, v118
  v_exp_f32 v119, v119
  v_mfma_f32_32x32x16_bf16 v[160:175], v[68:71], v[76:79], v[160:175]
  v_cvt_pk_bf16_f32 v86, v116, v117
  v_exp_f32 v120, v120
  v_cvt_pk_bf16_f32 v87, v118, v119
  v_exp_f32 v121, v121
  v_exp_f32 v122, v122
  v_exp_f32 v123, v123
  v_mfma_f32_32x32x16_bf16 v[160:175], v[72:75], v[80:83], v[160:175]
  v_cvt_pk_bf16_f32 v88, v120, v121
  v_exp_f32 v124, v124
  v_cvt_pk_bf16_f32 v89, v122, v123
  v_exp_f32 v125, v125
  v_exp_f32 v126, v126
  v_exp_f32 v127, v127
  v_cvt_pk_bf16_f32 v90, v124, v125
  v_cvt_pk_bf16_f32 v91, v126, v127
  v_mfma_f32_32x32x16_bf16 v[112:127], v[56:59], v[20:23], 0
  v_exp_f32 v96, v96
  v_exp_f32 v97, v97
  v_exp_f32 v98, v98
  v_exp_f32 v99, v99
  v_mfma_f32_32x32x16_bf16 v[112:127], v[64:67], v[40:43], v[112:127]
  v_exp_f32 v100, v100
  v_exp_f32 v101, v101
  v_cvt_pk_bf16_f32 v76, v96, v97
  v_cvt_pk_bf16_f32 v77, v98, v99
  v_exp_f32 v102, v102
  v_exp_f32 v103, v103
  v_mfma_f32_32x32x16_bf16 v[176:191], v[68:71], v[84:87], v[176:191]
  ds_read_b128 v[68:71], v5 offset:1376
  v_cvt_pk_bf16_f32 v78, v100, v101
  v_exp_f32 v104, v104
  v_cvt_pk_bf16_f32 v79, v102, v103
  v_exp_f32 v105, v105
  v_exp_f32 v106, v106
  v_exp_f32 v107, v107
  v_mfma_f32_32x32x16_bf16 v[176:191], v[72:75], v[88:91], v[176:191]
  ds_read_b128 v[72:75], v5 offset:2064
  v_cvt_pk_bf16_f32 v80, v104, v105
  v_exp_f32 v108, v108
  v_cvt_pk_bf16_f32 v81, v106, v107
  v_exp_f32 v109, v109
  v_exp_f32 v110, v110
  v_exp_f32 v111, v111
  v_cvt_pk_bf16_f32 v82, v108, v109
  v_cvt_pk_bf16_f32 v83, v110, v111
  v_mfma_f32_32x32x16_bf16 v[96:111], v[56:59], v[24:27], 0
  v_exp_f32 v112, v112
  v_exp_f32 v113, v113
  v_exp_f32 v114, v114
  v_exp_f32 v115, v115
  v_mfma_f32_32x32x16_bf16 v[96:111], v[64:67], v[46:49], v[96:111]
  v_exp_f32 v116, v116
  v_exp_f32 v117, v117
  v_cvt_pk_bf16_f32 v84, v112, v113
  v_cvt_pk_bf16_f32 v85, v114, v115
  v_exp_f32 v118, v118
  v_exp_f32 v119, v119
  s_waitcnt lgkmcnt(0)
  v_mfma_f32_32x32x16_bf16 v[128:143], v[68:71], v[76:79], v[128:143]
  v_cvt_pk_bf16_f32 v86, v116, v117
  v_exp_f32 v120, v120
  v_cvt_pk_bf16_f32 v87, v118, v119
  v_exp_f32 v121, v121
  v_exp_f32 v122, v122
  v_exp_f32 v123, v123
  v_mfma_f32_32x32x16_bf16 v[128:143], v[72:75], v[80:83], v[128:143]
  v_cvt_pk_bf16_f32 v88, v120, v121
  v_exp_f32 v124, v124
  v_cvt_pk_bf16_f32 v89, v122, v123
  v_exp_f32 v125, v125
  v_exp_f32 v126, v126
  v_exp_f32 v127, v127
  v_cvt_pk_bf16_f32 v90, v124, v125
  v_cvt_pk_bf16_f32 v91, v126, v127
  v_mfma_f32_32x32x16_bf16 v[112:127], v[56:59], v[28:31], 0
  ds_read_b128 v[56:59], v3 offset:10624
  v_exp_f32 v96, v96
  v_exp_f32 v97, v97
  v_exp_f32 v98, v98
  v_exp_f32 v99, v99
  v_mfma_f32_32x32x16_bf16 v[112:127], v[64:67], v[52:55], v[112:127]
  ds_read_b128 v[62:65], v8 offset:10624
  v_exp_f32 v100, v100
  v_exp_f32 v101, v101
  v_cvt_pk_bf16_f32 v76, v96, v97
  v_cvt_pk_bf16_f32 v77, v98, v99
  v_exp_f32 v102, v102
  v_exp_f32 v103, v103
  v_mfma_f32_32x32x16_bf16 v[144:159], v[68:71], v[84:87], v[144:159]
  v_cvt_pk_bf16_f32 v78, v100, v101
  v_exp_f32 v104, v104
  v_cvt_pk_bf16_f32 v79, v102, v103
  v_exp_f32 v105, v105
  v_exp_f32 v106, v106
  v_exp_f32 v107, v107
  v_mfma_f32_32x32x16_bf16 v[144:159], v[72:75], v[88:91], v[144:159]
  v_cvt_pk_bf16_f32 v80, v104, v105
  v_exp_f32 v108, v108
  v_cvt_pk_bf16_f32 v81, v106, v107
  v_exp_f32 v109, v109
  v_exp_f32 v110, v110
  v_exp_f32 v111, v111
  v_cvt_pk_bf16_f32 v82, v108, v109
  v_cvt_pk_bf16_f32 v83, v110, v111
  s_waitcnt lgkmcnt(0)
  v_mfma_f32_32x32x16_bf16 v[96:111], v[56:59], v[16:19], 0
  v_exp_f32 v112, v112
  v_exp_f32 v113, v113
  v_exp_f32 v114, v114
  v_exp_f32 v115, v115
  v_mfma_f32_32x32x16_bf16 v[96:111], v[60:63], v[32:35], v[96:111]
  v_exp_f32 v116, v116
  v_exp_f32 v117, v117
  v_cvt_pk_bf16_f32 v84, v112, v113
  v_cvt_pk_bf16_f32 v85, v114, v115
  v_exp_f32 v118, v118
  v_exp_f32 v119, v119
  v_mfma_f32_32x32x16_bf16 v[160:175], v[68:71], v[76:79], v[160:175]
  v_cvt_pk_bf16_f32 v86, v116, v117
  v_exp_f32 v120, v120
  v_cvt_pk_bf16_f32 v87, v118, v119
  v_exp_f32 v121, v121
  v_exp_f32 v122, v122
  v_exp_f32 v123, v123
  v_mfma_f32_32x32x16_bf16 v[160:175], v[72:75], v[80:83], v[160:175]
  v_cvt_pk_bf16_f32 v88, v120, v121
  v_exp_f32 v124, v124
  v_cvt_pk_bf16_f32 v89, v122, v123
  v_exp_f32 v125, v125
  v_exp_f32 v126, v126
  v_exp_f32 v127, v127
  v_cvt_pk_bf16_f32 v90, v124, v125
  v_cvt_pk_bf16_f32 v91, v126, v127
  v_mfma_f32_32x32x16_bf16 v[112:127], v[56:59], v[20:23], 0
  v_exp_f32 v96, v96
  v_exp_f32 v97, v97
  v_exp_f32 v98, v98
  v_exp_f32 v99, v99
  v_mfma_f32_32x32x16_bf16 v[112:127], v[60:63], v[38:41], v[112:127]
  v_exp_f32 v100, v100
  v_exp_f32 v101, v101
  v_cvt_pk_bf16_f32 v76, v96, v97
  v_cvt_pk_bf16_f32 v77, v98, v99
  v_exp_f32 v102, v102
  v_exp_f32 v103, v103
  v_mfma_f32_32x32x16_bf16 v[176:191], v[68:71], v[84:87], v[176:191]
  ds_read_b128 v[68:71], v5 offset:10624
  v_cvt_pk_bf16_f32 v78, v100, v101
  v_exp_f32 v104, v104
  v_cvt_pk_bf16_f32 v79, v102, v103
  v_exp_f32 v105, v105
  v_exp_f32 v106, v106
  v_exp_f32 v107, v107
  v_mfma_f32_32x32x16_bf16 v[176:191], v[72:75], v[88:91], v[176:191]
  ds_read_b128 v[72:75], v5 offset:11312
  v_cvt_pk_bf16_f32 v80, v104, v105
  v_exp_f32 v108, v108
  v_cvt_pk_bf16_f32 v81, v106, v107
  v_exp_f32 v109, v109
  v_exp_f32 v110, v110
  v_exp_f32 v111, v111
  v_cvt_pk_bf16_f32 v82, v108, v109
  v_cvt_pk_bf16_f32 v83, v110, v111
  v_mfma_f32_32x32x16_bf16 v[96:111], v[56:59], v[24:27], 0
  v_exp_f32 v112, v112
  v_exp_f32 v113, v113
  v_exp_f32 v114, v114
  v_exp_f32 v115, v115
  v_mfma_f32_32x32x16_bf16 v[96:111], v[60:63], v[44:47], v[96:111]
  v_exp_f32 v116, v116
  v_exp_f32 v117, v117
  v_cvt_pk_bf16_f32 v84, v112, v113
  v_cvt_pk_bf16_f32 v85, v114, v115
  v_exp_f32 v118, v118
  v_exp_f32 v119, v119
  s_waitcnt lgkmcnt(0)
  v_mfma_f32_32x32x16_bf16 v[128:143], v[68:71], v[76:79], v[128:143]
  v_cvt_pk_bf16_f32 v86, v116, v117
  v_exp_f32 v120, v120
  v_cvt_pk_bf16_f32 v87, v118, v119
  v_exp_f32 v121, v121
  v_exp_f32 v122, v122
  v_exp_f32 v123, v123
  v_mfma_f32_32x32x16_bf16 v[128:143], v[72:75], v[80:83], v[128:143]
  v_cvt_pk_bf16_f32 v88, v120, v121
  v_exp_f32 v124, v124
  v_cvt_pk_bf16_f32 v89, v122, v123
  v_exp_f32 v125, v125
  v_exp_f32 v126, v126
  v_exp_f32 v127, v127
  v_cvt_pk_bf16_f32 v90, v124, v125
  v_cvt_pk_bf16_f32 v91, v126, v127
  v_mfma_f32_32x32x16_bf16 v[112:127], v[56:59], v[28:31], 0
  ds_read_b128 v[56:59], v3 offset:11648
  v_exp_f32 v96, v96
  v_exp_f32 v97, v97
  v_exp_f32 v98, v98
  v_exp_f32 v99, v99
  v_mfma_f32_32x32x16_bf16 v[112:127], v[60:63], v[50:53], v[112:127]
  v_exp_f32 v100, v100
  v_exp_f32 v101, v101
  v_cvt_pk_bf16_f32 v76, v96, v97
  v_cvt_pk_bf16_f32 v77, v98, v99
  v_exp_f32 v102, v102
  v_exp_f32 v103, v103
  v_mfma_f32_32x32x16_bf16 v[144:159], v[68:71], v[84:87], v[144:159]
  v_cvt_pk_bf16_f32 v78, v100, v101
  v_exp_f32 v104, v104
  v_cvt_pk_bf16_f32 v79, v102, v103
  v_exp_f32 v105, v105
  v_exp_f32 v106, v106
  v_exp_f32 v107, v107
  v_mfma_f32_32x32x16_bf16 v[144:159], v[72:75], v[88:91], v[144:159]
  v_cvt_pk_bf16_f32 v80, v104, v105
  v_exp_f32 v108, v108
  v_cvt_pk_bf16_f32 v81, v106, v107
  v_exp_f32 v109, v109
  v_exp_f32 v110, v110
  v_exp_f32 v111, v111
  v_cvt_pk_bf16_f32 v82, v108, v109
  v_cvt_pk_bf16_f32 v83, v110, v111
  s_waitcnt lgkmcnt(0)
  v_mfma_f32_32x32x16_bf16 v[96:111], v[56:59], v[16:19], 0
  v_exp_f32 v112, v112
  v_exp_f32 v113, v113
  v_exp_f32 v114, v114
  v_exp_f32 v115, v115
  v_mfma_f32_32x32x16_bf16 v[96:111], v[64:67], v[34:37], v[96:111]
  v_exp_f32 v116, v116
  v_exp_f32 v117, v117
  v_cvt_pk_bf16_f32 v84, v112, v113
  v_cvt_pk_bf16_f32 v85, v114, v115
  v_exp_f32 v118, v118
  v_exp_f32 v119, v119
  v_mfma_f32_32x32x16_bf16 v[160:175], v[68:71], v[76:79], v[160:175]
  v_cvt_pk_bf16_f32 v86, v116, v117
  v_exp_f32 v120, v120
  v_cvt_pk_bf16_f32 v87, v118, v119
  v_exp_f32 v121, v121
  v_exp_f32 v122, v122
  v_exp_f32 v123, v123
  v_mfma_f32_32x32x16_bf16 v[160:175], v[72:75], v[80:83], v[160:175]
  v_cvt_pk_bf16_f32 v88, v120, v121
  v_exp_f32 v124, v124
  v_cvt_pk_bf16_f32 v89, v122, v123
  v_exp_f32 v125, v125
  v_exp_f32 v126, v126
  v_exp_f32 v127, v127
  v_cvt_pk_bf16_f32 v90, v124, v125
  v_cvt_pk_bf16_f32 v91, v126, v127
  v_mfma_f32_32x32x16_bf16 v[112:127], v[56:59], v[20:23], 0
  v_exp_f32 v96, v96
  v_exp_f32 v97, v97
  v_exp_f32 v98, v98
  v_exp_f32 v99, v99
  v_mfma_f32_32x32x16_bf16 v[112:127], v[64:67], v[40:43], v[112:127]
  v_exp_f32 v100, v100
  v_exp_f32 v101, v101
  v_cvt_pk_bf16_f32 v76, v96, v97
  v_cvt_pk_bf16_f32 v77, v98, v99
  v_exp_f32 v102, v102
  v_exp_f32 v103, v103
  v_mfma_f32_32x32x16_bf16 v[176:191], v[68:71], v[84:87], v[176:191]
  ds_read_b128 v[68:71], v5 offset:12000
  v_cvt_pk_bf16_f32 v78, v100, v101
  v_exp_f32 v104, v104
  v_cvt_pk_bf16_f32 v79, v102, v103
  v_exp_f32 v105, v105
  v_exp_f32 v106, v106
  v_exp_f32 v107, v107
  v_mfma_f32_32x32x16_bf16 v[176:191], v[72:75], v[88:91], v[176:191]
  ds_read_b128 v[72:75], v5 offset:12688
  v_cvt_pk_bf16_f32 v80, v104, v105
  v_exp_f32 v108, v108
  v_cvt_pk_bf16_f32 v81, v106, v107
  v_exp_f32 v109, v109
  v_exp_f32 v110, v110
  v_exp_f32 v111, v111
  v_cvt_pk_bf16_f32 v82, v108, v109
  v_cvt_pk_bf16_f32 v83, v110, v111
  v_mfma_f32_32x32x16_bf16 v[96:111], v[56:59], v[24:27], 0
  v_exp_f32 v112, v112
  v_exp_f32 v113, v113
  v_exp_f32 v114, v114
  v_exp_f32 v115, v115
  v_mfma_f32_32x32x16_bf16 v[96:111], v[64:67], v[46:49], v[96:111]
  v_exp_f32 v116, v116
  v_exp_f32 v117, v117
  v_cvt_pk_bf16_f32 v84, v112, v113
  v_cvt_pk_bf16_f32 v85, v114, v115
  v_exp_f32 v118, v118
  v_exp_f32 v119, v119
  s_waitcnt lgkmcnt(0)
  v_mfma_f32_32x32x16_bf16 v[128:143], v[68:71], v[76:79], v[128:143]
  v_cvt_pk_bf16_f32 v86, v116, v117
  v_exp_f32 v120, v120
  v_cvt_pk_bf16_f32 v87, v118, v119
  v_exp_f32 v121, v121
  v_exp_f32 v122, v122
  v_exp_f32 v123, v123
  v_mfma_f32_32x32x16_bf16 v[128:143], v[72:75], v[80:83], v[128:143]
  v_cvt_pk_bf16_f32 v88, v120, v121
  v_exp_f32 v124, v124
  v_cvt_pk_bf16_f32 v89, v122, v123
  v_exp_f32 v125, v125
  v_exp_f32 v126, v126
  v_exp_f32 v127, v127
  v_cvt_pk_bf16_f32 v90, v124, v125
  v_cvt_pk_bf16_f32 v91, v126, v127
  v_mfma_f32_32x32x16_bf16 v[112:127], v[56:59], v[28:31], 0
  ds_read_b128 v[56:59], v3 offset:21248
  v_exp_f32 v96, v96
  v_exp_f32 v97, v97
  v_exp_f32 v98, v98
  v_exp_f32 v99, v99
  v_mfma_f32_32x32x16_bf16 v[112:127], v[64:67], v[52:55], v[112:127]
  ds_read_b128 v[62:65], v8 offset:21248
  v_exp_f32 v100, v100
  v_exp_f32 v101, v101
  v_cvt_pk_bf16_f32 v76, v96, v97
  v_cvt_pk_bf16_f32 v77, v98, v99
  v_exp_f32 v102, v102
  v_exp_f32 v103, v103
  v_mfma_f32_32x32x16_bf16 v[144:159], v[68:71], v[84:87], v[144:159]
  v_cvt_pk_bf16_f32 v78, v100, v101
  v_exp_f32 v104, v104
  v_cvt_pk_bf16_f32 v79, v102, v103
  v_exp_f32 v105, v105
  v_exp_f32 v106, v106
  v_exp_f32 v107, v107
  v_mfma_f32_32x32x16_bf16 v[144:159], v[72:75], v[88:91], v[144:159]
  v_cvt_pk_bf16_f32 v80, v104, v105
  v_exp_f32 v108, v108
  v_cvt_pk_bf16_f32 v81, v106, v107
  v_exp_f32 v109, v109
  v_exp_f32 v110, v110
  v_exp_f32 v111, v111
  v_cvt_pk_bf16_f32 v82, v108, v109
  v_cvt_pk_bf16_f32 v83, v110, v111
  s_waitcnt lgkmcnt(0)
  v_mfma_f32_32x32x16_bf16 v[96:111], v[56:59], v[16:19], 0
  v_exp_f32 v112, v112
  v_exp_f32 v113, v113
  v_exp_f32 v114, v114
  v_exp_f32 v115, v115
  v_mfma_f32_32x32x16_bf16 v[96:111], v[60:63], v[32:35], v[96:111]
  v_exp_f32 v116, v116
  v_exp_f32 v117, v117
  v_cvt_pk_bf16_f32 v84, v112, v113
  v_cvt_pk_bf16_f32 v85, v114, v115
  v_exp_f32 v118, v118
  v_exp_f32 v119, v119
  v_mfma_f32_32x32x16_bf16 v[160:175], v[68:71], v[76:79], v[160:175]
  v_cvt_pk_bf16_f32 v86, v116, v117
  v_exp_f32 v120, v120
  v_cvt_pk_bf16_f32 v87, v118, v119
  v_exp_f32 v121, v121
  v_exp_f32 v122, v122
  v_exp_f32 v123, v123
  v_mfma_f32_32x32x16_bf16 v[160:175], v[72:75], v[80:83], v[160:175]
  v_cvt_pk_bf16_f32 v88, v120, v121
  v_exp_f32 v124, v124
  v_cvt_pk_bf16_f32 v89, v122, v123
  v_exp_f32 v125, v125
  v_exp_f32 v126, v126
  v_exp_f32 v127, v127
  v_cvt_pk_bf16_f32 v90, v124, v125
  v_cvt_pk_bf16_f32 v91, v126, v127
  v_mfma_f32_32x32x16_bf16 v[112:127], v[56:59], v[20:23], 0
  v_exp_f32 v96, v96
  v_exp_f32 v97, v97
  v_exp_f32 v98, v98
  v_exp_f32 v99, v99
  v_mfma_f32_32x32x16_bf16 v[112:127], v[60:63], v[38:41], v[112:127]
  v_exp_f32 v100, v100
  v_exp_f32 v101, v101
  v_cvt_pk_bf16_f32 v76, v96, v97
  v_cvt_pk_bf16_f32 v77, v98, v99
  v_exp_f32 v102, v102
  v_exp_f32 v103, v103
  v_mfma_f32_32x32x16_bf16 v[176:191], v[68:71], v[84:87], v[176:191]
  ds_read_b128 v[68:71], v5 offset:21248
  v_cvt_pk_bf16_f32 v78, v100, v101
  v_exp_f32 v104, v104
  v_cvt_pk_bf16_f32 v79, v102, v103
  v_exp_f32 v105, v105
  v_exp_f32 v106, v106
  v_exp_f32 v107, v107
  v_mfma_f32_32x32x16_bf16 v[176:191], v[72:75], v[88:91], v[176:191]
  ds_read_b128 v[72:75], v5 offset:21936
  v_cvt_pk_bf16_f32 v80, v104, v105
  v_exp_f32 v108, v108
  v_cvt_pk_bf16_f32 v81, v106, v107
  v_exp_f32 v109, v109
  v_exp_f32 v110, v110
  v_exp_f32 v111, v111
  v_cvt_pk_bf16_f32 v82, v108, v109
  v_cvt_pk_bf16_f32 v83, v110, v111
  v_add_u32 v3, 21248, v3
  ds_write_b32 v93, v3
  v_add_u32 v8, 21248, v8
  v_add_u32 v5, 21248, v5
  s_cmp_ge_u32 s16, 4
  s_cbranch_scc1 gated_mix__grouped_kv_mqa__geglu_ffn__prompt_kernel_w3
gated_mix__grouped_kv_mqa__geglu_ffn__prompt_kernel_w3r:
  s_sub_u32 s16, s16, 1
  s_cmp_lg_u32 s16, 0
  s_cbranch_scc1 gated_mix__grouped_kv_mqa__geglu_ffn__prompt_kernel_loop
  v_mfma_f32_32x32x16_bf16 v[96:111], v[56:59], v[24:27], 0
  v_exp_f32 v112, v112
  v_exp_f32 v113, v113
  v_exp_f32 v114, v114
  v_exp_f32 v115, v115
  v_mfma_f32_32x32x16_bf16 v[96:111], v[60:63], v[44:47], v[96:111]
  v_exp_f32 v116, v116
  v_exp_f32 v117, v117
  v_cvt_pk_bf16_f32 v84, v112, v113
  v_cvt_pk_bf16_f32 v85, v114, v115
  v_exp_f32 v118, v118
  v_exp_f32 v119, v119
  s_waitcnt lgkmcnt(0)
  v_mfma_f32_32x32x16_bf16 v[128:143], v[68:71], v[76:79], v[128:143]
  v_cvt_pk_bf16_f32 v86, v116, v117
  v_exp_f32 v120, v120
  v_cvt_pk_bf16_f32 v87, v118, v119
  v_exp_f32 v121, v121
  v_exp_f32 v122, v122
  v_exp_f32 v123, v123
  v_mfma_f32_32x32x16_bf16 v[128:143], v[72:75], v[80:83], v[128:143]
  v_cvt_pk_bf16_f32 v88, v120, v121
  v_exp_f32 v124, v124
  v_cvt_pk_bf16_f32 v89, v122, v123
  v_exp_f32 v125, v125
  v_exp_f32 v126, v126
  v_exp_f32 v127, v127
  v_cvt_pk_bf16_f32 v90, v124, v125
  v_cvt_pk_bf16_f32 v91, v126, v127
  v_mfma_f32_32x32x16_bf16 v[112:127], v[56:59], v[28:31], 0
  ds_read_b128 v[56:59], v3 offset:1024
  v_exp_f32 v96, v96
  v_exp_f32 v97, v97
  v_exp_f32 v98, v98
  v_exp_f32 v99, v99
  v_mfma_f32_32x32x16_bf16 v[112:127], v[60:63], v[50:53], v[112:127]
  v_exp_f32 v100, v100
  v_exp_f32 v101, v101
  v_cvt_pk_bf16_f32 v76, v96, v97
  v_cvt_pk_bf16_f32 v77, v98, v99
  v_exp_f32 v102, v102
  v_exp_f32 v103, v103
  v_mfma_f32_32x32x16_bf16 v[144:159], v[68:71], v[84:87], v[144:159]
  v_cvt_pk_bf16_f32 v78, v100, v101
  v_exp_f32 v104, v104
  v_cvt_pk_bf16_f32 v79, v102, v103
  v_exp_f32 v105, v105
  v_exp_f32 v106, v106
  v_exp_f32 v107, v107
  v_mfma_f32_32x32x16_bf16 v[144:159], v[72:75], v[88:91], v[144:159]
  v_cvt_pk_bf16_f32 v80, v104, v105
  v_exp_f32 v108, v108
  v_cvt_pk_bf16_f32 v81, v106, v107
  v_exp_f32 v109, v109
  v_exp_f32 v110, v110
  v_exp_f32 v111, v111
  v_cvt_pk_bf16_f32 v82, v108, v109
  v_cvt_pk_bf16_f32 v83, v110, v111
  s_waitcnt lgkmcnt(0)
  v_mfma_f32_32x32x16_bf16 v[96:111], v[56:59], v[16:19], 0
  v_exp_f32 v112, v112
  v_exp_f32 v113, v113
  v_exp_f32 v114, v114
  v_exp_f32 v115, v115
  v_mfma_f32_32x32x16_bf16 v[96:111], v[64:67], v[34:37], v[96:111]
  v_exp_f32 v116, v116
  v_exp_f32 v117, v117
  v_cvt_pk_bf16_f32 v84, v112, v113
  v_cvt_pk_bf16_f32 v85, v114, v115
  v_exp_f32 v118, v118
  v_exp_f32 v119, v119
  v_mfma_f32_32x32x16_bf16 v[160:175], v[68:71], v[76:79], v[160:175]
  v_cvt_pk_bf16_f32 v86, v116, v117
  v_exp_f32 v120, v120
  v_cvt_pk_bf16_f32 v87, v118, v119
  v_exp_f32 v121, v121
  v_exp_f32 v122, v122
  v_exp_f32 v123, v123
  v_mfma_f32_32x32x16_bf16 v[160:175], v[72:75], v[80:83], v[160:175]
  v_cvt_pk_bf16_f32 v88, v120, v121
  v_exp_f32 v124, v124
  v_cvt_pk_bf16_f32 v89, v122, v123
  v_exp_f32 v125, v125
  v_exp_f32 v126, v126
  v_exp_f32 v127, v127
  v_cvt_pk_bf16_f32 v90, v124, v125
  v_cvt_pk_bf16_f32 v91, v126, v127
  v_mfma_f32_32x32x16_bf16 v[112:127], v[56:59], v[20:23], 0
  v_exp_f32 v96, v96
  v_exp_f32 v97, v97
  v_exp_f32 v98, v98
  v_exp_f32 v99, v99
  v_mfma_f32_32x32x16_bf16 v[112:127], v[64:67], v[40:43], v[112:127]
  v_exp_f32 v100, v100
  v_exp_f32 v101, v101
  v_cvt_pk_bf16_f32 v76, v96, v97
  v_cvt_pk_bf16_f32 v77, v98, v99
  v_exp_f32 v102, v102
  v_exp_f32 v103, v103
  v_mfma_f32_32x32x16_bf16 v[176:191], v[68:71], v[84:87], v[176:191]
  ds_read_b128 v[68:71], v5 offset:1376
  v_cvt_pk_bf16_f32 v78, v100, v101
  v_exp_f32 v104, v104
  v_cvt_pk_bf16_f32 v79, v102, v103
  v_exp_f32 v105, v105
  v_exp_f32 v106, v106
  v_exp_f32 v107, v107
  v_mfma_f32_32x32x16_bf16 v[176:191], v[72:75], v[88:91], v[176:191]
  ds_read_b128 v[72:75], v5 offset:2064
  v_cvt_pk_bf16_f32 v80, v104, v105
  v_exp_f32 v108, v108
  v_cvt_pk_bf16_f32 v81, v106, v107
  v_exp_f32 v109, v109
  v_exp_f32 v110, v110
  v_exp_f32 v111, v111
  v_cvt_pk_bf16_f32 v82, v108, v109
  v_cvt_pk_bf16_f32 v83, v110, v111
  v_mfma_f32_32x32x16_bf16 v[96:111], v[56:59], v[24:27], 0
  v_exp_f32 v112, v112
  v_exp_f32 v113, v113
  v_exp_f32 v114, v114
  v_exp_f32 v115, v115
  v_mfma_f32_32x32x16_bf16 v[96:111], v[64:67], v[46:49], v[96:111]
  v_exp_f32 v116, v116
  v_exp_f32 v117, v117
  v_cvt_pk_bf16_f32 v84, v112, v113
  v_cvt_pk_bf16_f32 v85, v114, v115
  v_exp_f32 v118, v118
  v_exp_f32 v119, v119
  s_waitcnt lgkmcnt(0)
  v_mfma_f32_32x32x16_bf16 v[128:143], v[68:71], v[76:79], v[128:143]
  v_cvt_pk_bf16_f32 v86, v116, v117
  v_exp_f32 v120, v120
  v_cvt_pk_bf16_f32 v87, v118, v119
  v_exp_f32 v121, v121
  v_exp_f32 v122, v122
  v_exp_f32 v123, v123
  v_mfma_f32_32x32x16_bf16 v[128:143], v[72:75], v[80:83], v[128:143]
  v_cvt_pk_bf16_f32 v88, v120, v121
  v_exp_f32 v124, v124
  v_cvt_pk_bf16_f32 v89, v122, v123
  v_exp_f32 v125, v125
  v_exp_f32 v126, v126
  v_exp_f32 v127, v127
  v_cvt_pk_bf16_f32 v90, v124, v125
  v_cvt_pk_bf16_f32 v91, v126, v127
  v_mfma_f32_32x32x16_bf16 v[112:127], v[56:59], v[28:31], 0
  v_exp_f32 v96, v96
  v_exp_f32 v97, v97
  v_exp_f32 v98, v98
  v_exp_f32 v99, v99
  v_mfma_f32_32x32x16_bf16 v[112:127], v[64:67], v[52:55], v[112:127]
  v_exp_f32 v100, v100
  v_exp_f32 v101, v101
  v_cvt_pk_bf16_f32 v76, v96, v97
  v_cvt_pk_bf16_f32 v77, v98, v99
  v_exp_f32 v102, v102
  v_exp_f32 v103, v103
  v_mfma_f32_32x32x16_bf16 v[144:159], v[68:71], v[84:87], v[144:159]
  v_cvt_pk_bf16_f32 v78, v100, v101
  v_exp_f32 v104, v104
  v_cvt_pk_bf16_f32 v79, v102, v103
  v_exp_f32 v105, v105
  v_exp_f32 v106, v106
  v_exp_f32 v107, v107
  v_mfma_f32_32x32x16_bf16 v[144:159], v[72:75], v[88:91], v[144:159]
  v_cvt_pk_bf16_f32 v80, v104, v105
  v_exp_f32 v108, v108
  v_cvt_pk_bf16_f32 v81, v106, v107
  v_exp_f32 v109, v109
  v_exp_f32 v110, v110
  v_exp_f32 v111, v111
  v_cvt_pk_bf16_f32 v82, v108, v109
  v_cvt_pk_bf16_f32 v83, v110, v111
  v_exp_f32 v112, v112
  v_exp_f32 v113, v113
  v_exp_f32 v114, v114
  v_exp_f32 v115, v115
  v_exp_f32 v116, v116
  v_exp_f32 v117, v117
  v_cvt_pk_bf16_f32 v84, v112, v113
  v_cvt_pk_bf16_f32 v85, v114, v115
  v_exp_f32 v118, v118
  v_exp_f32 v119, v119
  v_mfma_f32_32x32x16_bf16 v[160:175], v[68:71], v[76:79], v[160:175]
  v_cvt_pk_bf16_f32 v86, v116, v117
  v_exp_f32 v120, v120
  v_cvt_pk_bf16_f32 v87, v118, v119
  v_exp_f32 v121, v121
  v_exp_f32 v122, v122
  v_exp_f32 v123, v123
  v_mfma_f32_32x32x16_bf16 v[160:175], v[72:75], v[80:83], v[160:175]
  v_cvt_pk_bf16_f32 v88, v120, v121
  v_exp_f32 v124, v124
  v_cvt_pk_bf16_f32 v89, v122, v123
  v_exp_f32 v125, v125
  v_exp_f32 v126, v126
  v_exp_f32 v127, v127
  v_cvt_pk_bf16_f32 v90, v124, v125
  v_cvt_pk_bf16_f32 v91, v126, v127
  v_mfma_f32_32x32x16_bf16 v[176:191], v[68:71], v[84:87], v[176:191]
  s_nop 0
  v_mfma_f32_32x32x16_bf16 v[176:191], v[72:75], v[88:91], v[176:191]
  v_and_b32 v12, 3, v1
  v_lshlrev_b32 v12, 2, v12
  v_add_u32 v12, 163776, v12
  v_mov_b32 v14, 127488
gated_mix__grouped_kv_mqa__geglu_ffn__prompt_kernel_pw_4:
  ds_read_b32 v13, v12
  s_waitcnt lgkmcnt(0)
  v_cmp_lt_u32 vcc, v13, v14
  s_nop 4
  s_cbranch_vccz gated_mix__grouped_kv_mqa__geglu_ffn__prompt_kernel_pw_4_d
  s_sub_u32 s28, s28, 1
  s_cbranch_scc0 gated_mix__grouped_kv_mqa__geglu_ffn__prompt_kernel_pw_4
gated_mix__grouped_kv_mqa__geglu_ffn__prompt_kernel_pw_4_d:
  v_mov_b32 v14, 1
  s_cmp_eq_u32 s23, 0
  s_cbranch_scc1 gated_mix__grouped_kv_mqa__geglu_ffn__prompt_kernel_x1
  ds_write_b128 v230, v[128:131] offset:0
  ds_write_b128 v230, v[132:135] offset:1024
  ds_write_b128 v230, v[136:139] offset:2048
  ds_write_b128 v230, v[144:147] offset:3072
  ds_write_b128 v230, v[148:151] offset:4096
  ds_write_b128 v230, v[152:155] offset:5120
  v_pk_mul_f32 v[128:129], v[160:161], 1.0 op_sel_hi:[1,0]
  v_pk_mul_f32 v[130:131], v[162:163], 1.0 op_sel_hi:[1,0]
  v_pk_mul_f32 v[132:133], v[164:165], 1.0 op_sel_hi:[1,0]
  v_pk_mul_f32 v[134:135], v[166:167], 1.0 op_sel_hi:[1,0]
  v_pk_mul_f32 v[136:137], v[168:169], 1.0 op_sel_hi:[1,0]
  v_pk_mul_f32 v[138:139], v[170:171], 1.0 op_sel_hi:[1,0]
  v_pk_mul_f32 v[144:145], v[176:177], 1.0 op_sel_hi:[1,0]
  v_pk_mul_f32 v[146:147], v[178:179], 1.0 op_sel_hi:[1,0]
  v_pk_mul_f32 v[148:149], v[180:181], 1.0 op_sel_hi:[1,0]
  v_pk_mul_f32 v[150:151], v[182:183], 1.0 op_sel_hi:[1,0]
  v_pk_mul_f32 v[152:153], v[184:185], 1.0 op_sel_hi:[1,0]
  v_pk_mul_f32 v[154:155], v[186:187], 1.0 op_sel_hi:[1,0]
  s_branch gated_mix__grouped_kv_mqa__geglu_ffn__prompt_kernel_x2
gated_mix__grouped_kv_mqa__geglu_ffn__prompt_kernel_x1:
  ds_write_b128 v230, v[160:163] offset:0
  ds_write_b128 v230, v[164:167] offset:1024
  ds_write_b128 v230, v[168:171] offset:2048
  ds_write_b128 v230, v[176:179] offset:3072
  ds_write_b128 v230, v[180:183] offset:4096
  ds_write_b128 v230, v[184:187] offset:5120
gated_mix__grouped_kv_mqa__geglu_ffn__prompt_kernel_x2:
  s_waitcnt lgkmcnt(0)
  ds_write_b32 v232, v14 offset:16
gated_mix__grouped_kv_mqa__geglu_ffn__prompt_kernel_x3:
  ds_read_b32 v9, v233 offset:16
  s_waitcnt lgkmcnt(0)
  v_readfirstlane_b32 s12, v9
  s_nop 0
  s_cmp_lg_u32 s12, 0
  s_cbranch_scc1 gated_mix__grouped_kv_mqa__geglu_ffn__prompt_kernel_x3d
  s_sub_u32 s28, s28, 1
  s_cbranch_scc0 gated_mix__grouped_kv_mqa__geglu_ffn__prompt_kernel_x3
gated_mix__grouped_kv_mqa__geglu_ffn__prompt_kernel_x3d:
  ds_read_b128 v[160:163], v231 offset:0
  ds_read_b128 v[164:167], v231 offset:1024
  ds_read_b128 v[168:171], v231 offset:2048
  ds_read_b128 v[176:179], v231 offset:3072
  ds_read_b128 v[180:183], v231 offset:4096
  ds_read_b128 v[184:187], v231 offset:5120
  s_waitcnt vmcnt(0) lgkmcnt(0)
  v_pk_add_f32 v[128:129], v[128:129], v[160:161]
  v_pk_add_f32 v[130:131], v[130:131], v[162:163]
  v_pk_add_f32 v[132:133], v[132:133], v[164:165]
  v_pk_add_f32 v[134:135], v[134:135], v[166:167]
  v_pk_add_f32 v[136:137], v[136:137], v[168:169]
  v_pk_add_f32 v[138:139], v[138:139], v[170:171]
  v_pk_add_f32 v[144:145], v[144:145], v[176:177]
  v_pk_add_f32 v[146:147], v[146:147], v[178:179]
  v_pk_add_f32 v[148:149], v[148:149], v[180:181]
  v_pk_add_f32 v[150:151], v[150:151], v[182:183]
  v_pk_add_f32 v[152:153], v[152:153], v[184:185]
  v_pk_add_f32 v[154:155], v[154:155], v[186:187]
gated_mix__grouped_kv_mqa__geglu_ffn__prompt_kernel_fin2:
  v_mov_b32 v9, v136
  v_mov_b32 v11, v136
  v_mov_b32 v10, v152
  v_mov_b32 v12, v152
  v_permlane32_swap_b32 v11, v9
  s_nop 0
  v_permlane32_swap_b32 v12, v10
  v_min_f32 v11, v9, v10
  v_mov_b32 v12, 0x33800000
  v_cmp_ngt_f32 vcc, v11, v12
  v_max_f32 v11, v9, v10
  v_mov_b32 v12, 0x71800000
  v_cmp_nlt_f32 s[92:93], v11, v12
  v_cmp_u_f32 s[90:91], v9, v10
  s_nop 1
  s_or_b64 vcc, vcc, s[92:93]
  s_or_b64 vcc, vcc, s[90:91]
  s_cmp_lg_u32 s17, 0
  s_cbranch_scc1 gated_mix__grouped_kv_mqa__geglu_ffn__prompt_kernel_st
  s_cbranch_vccnz gated_mix__grouped_kv_mqa__geglu_ffn__prompt_kernel_slow
gated_mix__grouped_kv_mqa__geglu_ffn__prompt_kernel_st:
  v_rcp_f32 v9, v9
  v_rcp_f32 v10, v10
  v_mul_f32 v9, v9, v6
  v_mul_f32 v10, v10, v6
  s_lshl_b32 s12, s22, 1
  s_and_b32 s13, s3, 1
  s_add_u32 s12, s12, s13
  s_mul_i32 s12, s12, 5
  s_mul_i32 s13, s4, 40
  s_add_u32 s12, s12, s13
  s_lshl_b32 s12, s12, 10
  s_add_u32 s12, s12, 9877760
  s_lshl_b32 s13, s23, 9
  s_add_u32 s14, s12, s13
  s_add_u32 s14, s14, 4096
  s_lshl_b32 s13, s23, 11
  s_add_u32 s12, s12, s13
  v_mul_f32 v128, v128, v9
  v_mul_f32 v129, v129, v9
  v_mul_f32 v130, v130, v9
  v_mul_f32 v131, v131, v9
  v_mul_f32 v132, v132, v9
  v_mul_f32 v133, v133, v9
  v_mul_f32 v134, v134, v9
  v_mul_f32 v135, v135, v9
  v_cvt_pk_bf16_f32 v76, v128, v129
  v_cvt_pk_bf16_f32 v77, v130, v131
  v_cvt_pk_bf16_f32 v78, v132, v133
  v_cvt_pk_bf16_f32 v79, v134, v135
  buffer_store_dwordx4 v[76:79], v2, s[8:11], s12 offen offset:0 sc1
  v_mul_f32 v144, v144, v10
  v_mul_f32 v145, v145, v10
  v_mul_f32 v146, v146, v10
  v_mul_f32 v147, v147, v10
  v_mul_f32 v148, v148, v10
  v_mul_f32 v149, v149, v10
  v_mul_f32 v150, v150, v10
  v_mul_f32 v151, v151, v10
  v_cvt_pk_bf16_f32 v80, v144, v145
  v_cvt_pk_bf16_f32 v81, v146, v147
  v_cvt_pk_bf16_f32 v82, v148, v149
  v_cvt_pk_bf16_f32 v83, v150, v151
  buffer_store_dwordx4 v[80:83], v2, s[8:11], s12 offen offset:1024 sc1
  v_mul_f32 v136, v136, v9
  v_mul_f32 v137, v137, v9
  v_mul_f32 v138, v138, v9
  v_mul_f32 v139, v139, v9
  v_cvt_pk_bf16_f32 v84, v136, v137
  v_cvt_pk_bf16_f32 v85, v138, v139
  v_mul_f32 v152, v152, v10
  v_mul_f32 v153, v153, v10
  v_mul_f32 v154, v154, v10
  v_mul_f32 v155, v155, v10
  v_cvt_pk_bf16_f32 v86, v152, v153
  v_cvt_pk_bf16_f32 v87, v154, v155
  s_mov_b32 exec_hi, 0
  buffer_store_dwordx4 v[84:87], v2, s[8:11], s14 offen sc1
  s_lshl_b32 s12, s2, 7
  s_lshl_b32 s13, s3, 2
  s_add_u32 s12, s12, s13
  s_add_u32 s12, s12, 20773120
  v_mov_b32 v10, 0
  v_mov_b32 v12, s29
  s_mov_b64 exec, 1
  s_waitcnt vmcnt(0)
  buffer_store_dword v12, v10, s[8:11], s12 offen sc1
  s_mov_b64 exec, -1
gated_mix__grouped_kv_mqa__geglu_ffn__prompt_kernel_adone:
  s_endpgm
gated_mix__grouped_kv_mqa__geglu_ffn__prompt_kernel_w3:
  s_cmp_eq_u32 s16, 6
  s_cbranch_scc1 gated_mix__grouped_kv_mqa__geglu_ffn__prompt_kernel_w3r
  s_cmp_eq_u32 s16, 7
  s_cbranch_scc1 gated_mix__grouped_kv_mqa__geglu_ffn__prompt_kernel_w3a
  s_cmp_eq_u32 s16, 4
  s_cbranch_scc1 gated_mix__grouped_kv_mqa__geglu_ffn__prompt_kernel_w3b
gated_mix__grouped_kv_mqa__geglu_ffn__prompt_kernel_sp_5:
  ds_read_b32 v9, v92 offset:12
  s_waitcnt lgkmcnt(0)
  v_readfirstlane_b32 s12, v9
  s_nop 0
  s_cmp_ge_u32 s12, 4
  s_cbranch_scc1 gated_mix__grouped_kv_mqa__geglu_ffn__prompt_kernel_sp_5_d
  s_sleep 2
  s_sub_u32 s28, s28, 1
  s_cbranch_scc0 gated_mix__grouped_kv_mqa__geglu_ffn__prompt_kernel_sp_5
gated_mix__grouped_kv_mqa__geglu_ffn__prompt_kernel_sp_5_d:
  s_branch gated_mix__grouped_kv_mqa__geglu_ffn__prompt_kernel_w3r
gated_mix__grouped_kv_mqa__geglu_ffn__prompt_kernel_w3b:
gated_mix__grouped_kv_mqa__geglu_ffn__prompt_kernel_sp_6:
  ds_read_b32 v9, v92 offset:60
  s_waitcnt lgkmcnt(0)
  v_readfirstlane_b32 s12, v9
  s_nop 0
  s_cmp_ge_u32 s12, 4
  s_cbranch_scc1 gated_mix__grouped_kv_mqa__geglu_ffn__prompt_kernel_sp_6_d
  s_sleep 2
  s_sub_u32 s28, s28, 1
  s_cbranch_scc0 gated_mix__grouped_kv_mqa__geglu_ffn__prompt_kernel_sp_6
gated_mix__grouped_kv_mqa__geglu_ffn__prompt_kernel_sp_6_d:
  s_branch gated_mix__grouped_kv_mqa__geglu_ffn__prompt_kernel_w3r
gated_mix__grouped_kv_mqa__geglu_ffn__prompt_kernel_w3a:
gated_mix__grouped_kv_mqa__geglu_ffn__prompt_kernel_sp_7:
  ds_read_b32 v9, v92 offset:8
  s_waitcnt lgkmcnt(0)
  v_readfirstlane_b32 s12, v9
  s_nop 0
  s_cmp_ge_u32 s12, 4
  s_cbranch_scc1 gated_mix__grouped_kv_mqa__geglu_ffn__prompt_kernel_sp_7_d
  s_sub_u32 s28, s28, 1
  s_cbranch_scc0 gated_mix__grouped_kv_mqa__geglu_ffn__prompt_kernel_sp_7
gated_mix__grouped_kv_mqa__geglu_ffn__prompt_kernel_sp_7_d:
  s_branch gated_mix__grouped_kv_mqa__geglu_ffn__prompt_kernel_w3r
gated_mix__grouped_kv_mqa__geglu_ffn__prompt_kernel_slow:
  s_mov_b32 s17, 1
  s_cmp_eq_u32 s23, 0
  s_cbranch_scc1 gated_mix__grouped_kv_mqa__geglu_ffn__prompt_kernel_sl0
  v_mov_b32 v16, v24
  v_mov_b32 v17, v25
  v_mov_b32 v18, v26
  v_mov_b32 v19, v27
  v_mov_b32 v32, v44
  v_mov_b32 v33, v45
  v_mov_b32 v34, v46
  v_mov_b32 v35, v47
  v_mov_b32 v36, v48
  v_mov_b32 v37, v49
  v_mov_b32 v20, v28
  v_mov_b32 v21, v29
  v_mov_b32 v22, v30
  v_mov_b32 v23, v31
  v_mov_b32 v38, v50
  v_mov_b32 v39, v51
  v_mov_b32 v40, v52
  v_mov_b32 v41, v53
  v_mov_b32 v42, v54
  v_mov_b32 v43, v55
gated_mix__grouped_kv_mqa__geglu_ffn__prompt_kernel_sl0:
  s_mul_i32 s14, s23, 5312
  s_add_u32 s14, s14, 148736
  v_subrev_u32 v8, s14, v8
  v_subrev_u32 v5, s14, v5
  v_mov_b32 v13, 0xff7fffff
  v_mov_b32 v32, 0
  v_mov_b32 v36, 0
  v_mov_b32 v14, 0xff7fffff
  v_mov_b32 v38, 0
  v_mov_b32 v42, 0
  s_mov_b32 s18, 9699328
  s_mov_b32 s16, 32
gated_mix__grouped_kv_mqa__geglu_ffn__prompt_kernel_sl1:
  buffer_load_dwordx4 v[56:59], v2, s[8:11], s18 offen sc1
  buffer_load_dwordx4 v[240:243], v2, s[8:11], s18 offen offset:1024 sc1
  buffer_load_dwordx4 v[62:65], v8, s[8:11], s18 offen sc1
  s_waitcnt vmcnt(0)
  v_mfma_f32_32x32x16_bf16 v[96:111], v[56:59], v[16:19], 0
  v_mfma_f32_32x32x16_bf16 v[96:111], v[60:63], v[32:35], v[96:111]
  v_mfma_f32_32x32x16_bf16 v[112:127], v[56:59], v[20:23], 0
  v_mfma_f32_32x32x16_bf16 v[112:127], v[60:63], v[38:41], v[112:127]
  s_nop 9
  v_max3_f32 v13, v96, v97, v13
  v_max3_f32 v13, v98, v99, v13
  v_max3_f32 v13, v100, v101, v13
  v_max3_f32 v13, v102, v103, v13
  v_max3_f32 v13, v104, v105, v13
  v_max3_f32 v13, v106, v107, v13
  v_max3_f32 v13, v108, v109, v13
  v_max3_f32 v13, v110, v111, v13
  v_max3_f32 v14, v112, v113, v14
  v_max3_f32 v14, v114, v115, v14
  v_max3_f32 v14, v116, v117, v14
  v_max3_f32 v14, v118, v119, v14
  v_max3_f32 v14, v120, v121, v14
  v_max3_f32 v14, v122, v123, v14
  v_max3_f32 v14, v124, v125, v14
  v_max3_f32 v14, v126, v127, v14
  v_mfma_f32_32x32x16_bf16 v[96:111], v[240:243], v[16:19], 0
  v_mfma_f32_32x32x16_bf16 v[96:111], v[64:67], v[34:37], v[96:111]
  v_mfma_f32_32x32x16_bf16 v[112:127], v[240:243], v[20:23], 0
  v_mfma_f32_32x32x16_bf16 v[112:127], v[64:67], v[40:43], v[112:127]
  s_nop 9
  v_max3_f32 v13, v96, v97, v13
  v_max3_f32 v13, v98, v99, v13
  v_max3_f32 v13, v100, v101, v13
  v_max3_f32 v13, v102, v103, v13
  v_max3_f32 v13, v104, v105, v13
  v_max3_f32 v13, v106, v107, v13
  v_max3_f32 v13, v108, v109, v13
  v_max3_f32 v13, v110, v111, v13
  v_max3_f32 v14, v112, v113, v14
  v_max3_f32 v14, v114, v115, v14
  v_max3_f32 v14, v116, v117, v14
  v_max3_f32 v14, v118, v119, v14
  v_max3_f32 v14, v120, v121, v14
  v_max3_f32 v14, v122, v123, v14
  v_max3_f32 v14, v124, v125, v14
  v_max3_f32 v14, v126, v127, v14
  s_add_u32 s18, s18, 5312
  s_sub_u32 s16, s16, 1
  s_cmp_lg_u32 s16, 0
  s_cbranch_scc1 gated_mix__grouped_kv_mqa__geglu_ffn__prompt_kernel_sl1
  v_mov_b32 v9, v13
  v_mov_b32 v10, v14
  s_nop 0
  v_permlane32_swap_b32 v9, v13
  v_permlane32_swap_b32 v10, v14
  v_max_f32 v13, v13, v9
  v_max_f32 v14, v14, v10
  v_cvt_pk_bf16_f32 v9, -v13, 0
  v_lshlrev_b32 v9, 16, v9
  v_sub_f32 v11, -v13, v9
  v_cvt_pk_bf16_f32 v10, -v14, 0
  v_lshlrev_b32 v10, 16, v10
  v_sub_f32 v12, -v14, v10
  s_mov_b32 exec_hi, 0
  v_cvt_pk_bf16_f32 v32, v9, v11
  v_mov_b32 v36, v32
  v_cvt_pk_bf16_f32 v38, v10, v12
  v_mov_b32 v42, v38
  s_mov_b32 exec_hi, -1
  v_mov_b32 v128, 0
  v_mov_b32 v129, 0
  v_mov_b32 v130, 0
  v_mov_b32 v131, 0
  v_mov_b32 v132, 0
  v_mov_b32 v133, 0
  v_mov_b32 v134, 0
  v_mov_b32 v135, 0
  v_mov_b32 v136, 0
  v_mov_b32 v137, 0
  v_mov_b32 v138, 0
  v_mov_b32 v139, 0
  v_mov_b32 v140, 0
  v_mov_b32 v141, 0
  v_mov_b32 v142, 0
  v_mov_b32 v143, 0
  v_mov_b32 v144, 0
  v_mov_b32 v145, 0
  v_mov_b32 v146, 0
  v_mov_b32 v147, 0
  v_mov_b32 v148, 0
  v_mov_b32 v149, 0
  v_mov_b32 v150, 0
  v_mov_b32 v151, 0
  v_mov_b32 v152, 0
  v_mov_b32 v153, 0
  v_mov_b32 v154, 0
  v_mov_b32 v155, 0
  v_mov_b32 v156, 0
  v_mov_b32 v157, 0
  v_mov_b32 v158, 0
  v_mov_b32 v159, 0
  s_mov_b32 s18, 9699328
  s_mov_b32 s16, 32
gated_mix__grouped_kv_mqa__geglu_ffn__prompt_kernel_sl2:
  buffer_load_dwordx4 v[56:59], v2, s[8:11], s18 offen sc1
  buffer_load_dwordx4 v[240:243], v2, s[8:11], s18 offen offset:1024 sc1
  buffer_load_dwordx4 v[62:65], v8, s[8:11], s18 offen sc1
  buffer_load_dwordx4 v[68:71], v5, s[8:11], s18 offen offset:0 sc1
  buffer_load_dwordx4 v[72:75], v5, s[8:11], s18 offen offset:688 sc1
  buffer_load_dwordx4 v[244:247], v5, s[8:11], s18 offen offset:1376 sc1
  buffer_load_dwordx4 v[248:251], v5, s[8:11], s18 offen offset:2064 sc1
  s_waitcnt vmcnt(0)
  v_mfma_f32_32x32x16_bf16 v[96:111], v[56:59], v[16:19], 0
  v_mfma_f32_32x32x16_bf16 v[96:111], v[60:63], v[32:35], v[96:111]
  v_mfma_f32_32x32x16_bf16 v[112:127], v[56:59], v[20:23], 0
  v_mfma_f32_32x32x16_bf16 v[112:127], v[60:63], v[38:41], v[112:127]
  s_nop 9
  v_exp_f32 v96, v96
  v_exp_f32 v97, v97
  v_exp_f32 v98, v98
  v_exp_f32 v99, v99
  v_exp_f32 v100, v100
  v_exp_f32 v101, v101
  v_exp_f32 v102, v102
  v_exp_f32 v103, v103
  v_exp_f32 v104, v104
  v_exp_f32 v105, v105
  v_exp_f32 v106, v106
  v_exp_f32 v107, v107
  v_exp_f32 v108, v108
  v_exp_f32 v109, v109
  v_exp_f32 v110, v110
  v_exp_f32 v111, v111
  v_cvt_pk_bf16_f32 v76, v96, v97
  v_cvt_pk_bf16_f32 v77, v98, v99
  v_cvt_pk_bf16_f32 v78, v100, v101
  v_cvt_pk_bf16_f32 v79, v102, v103
  v_cvt_pk_bf16_f32 v80, v104, v105
  v_cvt_pk_bf16_f32 v81, v106, v107
  v_cvt_pk_bf16_f32 v82, v108, v109
  v_cvt_pk_bf16_f32 v83, v110, v111
  v_mfma_f32_32x32x16_bf16 v[128:143], v[68:71], v[76:79], v[128:143]
  s_nop 0
  v_mfma_f32_32x32x16_bf16 v[128:143], v[72:75], v[80:83], v[128:143]
  v_exp_f32 v112, v112
  v_exp_f32 v113, v113
  v_exp_f32 v114, v114
  v_exp_f32 v115, v115
  v_exp_f32 v116, v116
  v_exp_f32 v117, v117
  v_exp_f32 v118, v118
  v_exp_f32 v119, v119
  v_exp_f32 v120, v120
  v_exp_f32 v121, v121
  v_exp_f32 v122, v122
  v_exp_f32 v123, v123
  v_exp_f32 v124, v124
  v_exp_f32 v125, v125
  v_exp_f32 v126, v126
  v_exp_f32 v127, v127
  v_cvt_pk_bf16_f32 v84, v112, v113
  v_cvt_pk_bf16_f32 v85, v114, v115
  v_cvt_pk_bf16_f32 v86, v116, v117
  v_cvt_pk_bf16_f32 v87, v118, v119
  v_cvt_pk_bf16_f32 v88, v120, v121
  v_cvt_pk_bf16_f32 v89, v122, v123
  v_cvt_pk_bf16_f32 v90, v124, v125
  v_cvt_pk_bf16_f32 v91, v126, v127
  v_mfma_f32_32x32x16_bf16 v[144:159], v[68:71], v[84:87], v[144:159]
  s_nop 0
  v_mfma_f32_32x32x16_bf16 v[144:159], v[72:75], v[88:91], v[144:159]
  v_mfma_f32_32x32x16_bf16 v[96:111], v[240:243], v[16:19], 0
  v_mfma_f32_32x32x16_bf16 v[96:111], v[64:67], v[34:37], v[96:111]
  v_mfma_f32_32x32x16_bf16 v[112:127], v[240:243], v[20:23], 0
  v_mfma_f32_32x32x16_bf16 v[112:127], v[64:67], v[40:43], v[112:127]
  s_nop 9
  v_exp_f32 v96, v96
  v_exp_f32 v97, v97
  v_exp_f32 v98, v98
  v_exp_f32 v99, v99
  v_exp_f32 v100, v100
  v_exp_f32 v101, v101
  v_exp_f32 v102, v102
  v_exp_f32 v103, v103
  v_exp_f32 v104, v104
  v_exp_f32 v105, v105
  v_exp_f32 v106, v106
  v_exp_f32 v107, v107
  v_exp_f32 v108, v108
  v_exp_f32 v109, v109
  v_exp_f32 v110, v110
  v_exp_f32 v111, v111
  v_cvt_pk_bf16_f32 v76, v96, v97
  v_cvt_pk_bf16_f32 v77, v98, v99
  v_cvt_pk_bf16_f32 v78, v100, v101
  v_cvt_pk_bf16_f32 v79, v102, v103
  v_cvt_pk_bf16_f32 v80, v104, v105
  v_cvt_pk_bf16_f32 v81, v106, v107
  v_cvt_pk_bf16_f32 v82, v108, v109
  v_cvt_pk_bf16_f32 v83, v110, v111
  v_mfma_f32_32x32x16_bf16 v[128:143], v[244:247], v[76:79], v[128:143]
  s_nop 0
  v_mfma_f32_32x32x16_bf16 v[128:143], v[248:251], v[80:83], v[128:143]
  v_exp_f32 v112, v112
  v_exp_f32 v113, v113
  v_exp_f32 v114, v114
  v_exp_f32 v115, v115
  v_exp_f32 v116, v116
  v_exp_f32 v117, v117
  v_exp_f32 v118, v118
  v_exp_f32 v119, v119
  v_exp_f32 v120, v120
  v_exp_f32 v121, v121
  v_exp_f32 v122, v122
  v_exp_f32 v123, v123
  v_exp_f32 v124, v124
  v_exp_f32 v125, v125
  v_exp_f32 v126, v126
  v_exp_f32 v127, v127
  v_cvt_pk_bf16_f32 v84, v112, v113
  v_cvt_pk_bf16_f32 v85, v114, v115
  v_cvt_pk_bf16_f32 v86, v116, v117
  v_cvt_pk_bf16_f32 v87, v118, v119
  v_cvt_pk_bf16_f32 v88, v120, v121
  v_cvt_pk_bf16_f32 v89, v122, v123
  v_cvt_pk_bf16_f32 v90, v124, v125
  v_cvt_pk_bf16_f32 v91, v126, v127
  v_mfma_f32_32x32x16_bf16 v[144:159], v[244:247], v[84:87], v[144:159]
  s_nop 0
  v_mfma_f32_32x32x16_bf16 v[144:159], v[248:251], v[88:91], v[144:159]
  s_add_u32 s18, s18, 5312
  s_sub_u32 s16, s16, 1
  s_cmp_lg_u32 s16, 0
  s_cbranch_scc1 gated_mix__grouped_kv_mqa__geglu_ffn__prompt_kernel_sl2
  s_nop 15
  s_branch gated_mix__grouped_kv_mqa__geglu_ffn__prompt_kernel_fin2
gated_mix__grouped_kv_mqa__geglu_ffn__prompt_kernel_G:
  s_sub_u32 s19, s3, 4
  v_lshrrev_b32 v224, 3, v1
  v_and_b32 v225, 7, v1
  s_lshl_b32 s12, s19, 3
  v_add_u32 v9, s12, v224
  v_bfe_u32 v11, v9, 1, 3
  v_xor_b32 v11, v11, v225
  v_mul_u32_u24 v9, 1280, v9
  v_lshl_add_u32 v16, v11, 4, v9
  v_mov_b32 v230, 0
  s_mul_i32 s13, s4, 40960
  s_lshl_b32 s14, s19, 10
  s_mul_i32 s15, s22, 5
  s_lshr_b32 s12, s22, 1
  s_lshl_b32 s12, s12, 3
  s_sub_u32 s15, s15, s12
  s_waitcnt lgkmcnt(0)
  s_mov_b32 s36, s60
  s_and_b32 s37, s61, 0xffff
  s_mov_b32 s38, 2621440
  s_mov_b32 s39, 0x20000
  s_mov_b32 s84, s82
  s_and_b32 s85, s83, 0xffff
  s_mov_b32 s86, 256
  s_mov_b32 s87, 0x20000
  s_cmp_lg_u32 s2, 0
  s_cbranch_scc1 gated_mix__grouped_kv_mqa__geglu_ffn__prompt_kernel_n0
  s_cmp_lg_u32 s19, 3
  s_cbranch_scc1 gated_mix__grouped_kv_mqa__geglu_ffn__prompt_kernel_n0
  s_memrealtime s[92:93]
  s_waitcnt lgkmcnt(0)
  s_or_b32 s92, s92, 1
  v_mov_b32 v229, s92
  s_mov_b64 exec, 1
  buffer_store_dword v229, v230, s[84:87], 0 offen sc1
  s_mov_b64 exec, -1
gated_mix__grouped_kv_mqa__geglu_ffn__prompt_kernel_n0:
  s_cmp_eq_u32 s22, 0
  s_cselect_b32 s48, s64, s66
  s_cselect_b32 s49, s65, s67
  s_and_b32 s49, s49, 0xffff
  s_mov_b32 s50, 25600
  s_mov_b32 s51, 0x20000
  s_lshr_b32 s20, s2, 5
  s_cmp_ge_u32 s20, 6
  s_cselect_b32 s12, 6, 0
  s_sub_u32 s20, s20, s12
  s_cmp_ge_u32 s22, 2
  s_cbranch_scc1 gated_mix__grouped_kv_mqa__geglu_ffn__prompt_kernel_nokv0
  s_lshl_b32 s12, s20, 12
  s_add_u32 s12, s12, s14
  s_add_u32 m0, s12, 0
  s_add_u32 s20, s20, 1
  buffer_load_dwordx4 v2, s[48:51], s12 offen lds
  s_cmp_eq_u32 s20, 6
  s_cselect_b32 s20, 0, s20
  s_lshl_b32 s12, s20, 12
  s_add_u32 s12, s12, s14
  s_add_u32 m0, s12, 0
  s_add_u32 s20, s20, 1
  buffer_load_dwordx4 v2, s[48:51], s12 offen lds
  s_cmp_eq_u32 s20, 6
  s_cselect_b32 s20, 0, s20
gated_mix__grouped_kv_mqa__geglu_ffn__prompt_kernel_nokv0:
  s_lshl_b32 s12, s15, 12
  s_add_u32 s12, s12, s14
  s_add_u32 m0, s12, 40960
  s_lshl_b32 s12, s15, 7
  s_add_u32 s12, s12, s13
  buffer_load_dwordx4 v16, s[36:39], s12 offen lds
  s_add_u32 s15, s15, 1
  s_cmp_eq_u32 s15, 10
  s_cselect_b32 s15, 0, s15
  s_lshl_b32 s12, s15, 12
  s_add_u32 s12, s12, s14
  s_add_u32 m0, s12, 40960
  s_lshl_b32 s12, s15, 7
  s_add_u32 s12, s12, s13
  buffer_load_dwordx4 v16, s[36:39], s12 offen lds
  s_add_u32 s15, s15, 1
  s_cmp_eq_u32 s15, 10
  s_cselect_b32 s15, 0, s15
  s_lshl_b32 s12, s15, 12
  s_add_u32 s12, s12, s14
  s_add_u32 m0, s12, 40960
  s_lshl_b32 s12, s15, 7
  s_add_u32 s12, s12, s13
  buffer_load_dwordx4 v16, s[36:39], s12 offen lds
  s_add_u32 s15, s15, 1
  s_cmp_eq_u32 s15, 10
  s_cselect_b32 s15, 0, s15
  s_lshl_b32 s12, s15, 12
  s_add_u32 s12, s12, s14
  s_add_u32 m0, s12, 40960
  s_lshl_b32 s12, s15, 7
  s_add_u32 s12, s12, s13
  buffer_load_dwordx4 v16, s[36:39], s12 offen lds
  s_add_u32 s15, s15, 1
  s_cmp_eq_u32 s15, 10
  s_cselect_b32 s15, 0, s15
  s_lshl_b32 s12, s15, 12
  s_add_u32 s12, s12, s14
  s_add_u32 m0, s12, 40960
  s_lshl_b32 s12, s15, 7
  s_add_u32 s12, s12, s13
  buffer_load_dwordx4 v16, s[36:39], s12 offen lds
  s_add_u32 s15, s15, 1
  s_cmp_eq_u32 s15, 10
  s_cselect_b32 s15, 0, s15
  s_lshl_b32 s12, s15, 12
  s_add_u32 s12, s12, s14
  s_add_u32 m0, s12, 40960
  s_lshl_b32 s12, s15, 7
  s_add_u32 s12, s12, s13
  buffer_load_dwordx4 v16, s[36:39], s12 offen lds
  s_add_u32 s15, s15, 1
  s_cmp_eq_u32 s15, 10
  s_cselect_b32 s15, 0, s15
  s_lshl_b32 s12, s15, 12
  s_add_u32 s12, s12, s14
  s_add_u32 m0, s12, 40960
  s_lshl_b32 s12, s15, 7
  s_add_u32 s12, s12, s13
  buffer_load_dwordx4 v16, s[36:39], s12 offen lds
  s_add_u32 s15, s15, 1
  s_cmp_eq_u32 s15, 10
  s_cselect_b32 s15, 0, s15
  s_lshl_b32 s12, s15, 12
  s_add_u32 s12, s12, s14
  s_add_u32 m0, s12, 40960
  s_lshl_b32 s12, s15, 7
  s_add_u32 s12, s12, s13
  buffer_load_dwordx4 v16, s[36:39], s12 offen lds
  s_add_u32 s15, s15, 1
  s_cmp_eq_u32 s15, 10
  s_cselect_b32 s15, 0, s15
  s_lshl_b32 s12, s15, 12
  s_add_u32 s12, s12, s14
  s_add_u32 m0, s12, 40960
  s_lshl_b32 s12, s15, 7
  s_add_u32 s12, s12, s13
  buffer_load_dwordx4 v16, s[36:39], s12 offen lds
  s_add_u32 s15, s15, 1
  s_cmp_eq_u32 s15, 10
  s_cselect_b32 s15, 0, s15
  s_lshl_b32 s12, s15, 12
  s_add_u32 s12, s12, s14
  s_add_u32 m0, s12, 40960
  s_lshl_b32 s12, s15, 7
  s_add_u32 s12, s12, s13
  buffer_load_dwordx4 v16, s[36:39], s12 offen lds
  s_add_u32 s15, s15, 1
  s_cmp_eq_u32 s15, 10
  s_cselect_b32 s15, 0, s15
  s_mov_b32 s40, s62
  s_and_b32 s41, s63, 0xffff
  s_mov_b32 s42, 819200
  s_mov_b32 s43, 0x20000
  s_cmp_ge_u32 s22, 2
  s_cbranch_scc1 gated_mix__grouped_kv_mqa__geglu_ffn__prompt_kernel_nokv
  s_lshl_b32 s12, s20, 12
  s_add_u32 s12, s12, s14
  s_add_u32 m0, s12, 0
  s_add_u32 s20, s20, 1
  buffer_load_dwordx4 v2, s[48:51], s12 offen lds
  s_cmp_eq_u32 s20, 6
  s_cselect_b32 s20, 0, s20
  s_lshl_b32 s12, s20, 12
  s_add_u32 s12, s12, s14
  s_add_u32 m0, s12, 0
  s_add_u32 s20, s20, 1
  buffer_load_dwordx4 v2, s[48:51], s12 offen lds
  s_cmp_eq_u32 s20, 6
  s_cselect_b32 s20, 0, s20
  s_lshl_b32 s12, s20, 12
  s_add_u32 s12, s12, s14
  s_add_u32 m0, s12, 0
  s_add_u32 s20, s20, 1
  buffer_load_dwordx4 v2, s[48:51], s12 offen lds
  s_cmp_eq_u32 s20, 6
  s_cselect_b32 s20, 0, s20
  s_lshl_b32 s12, s20, 12
  s_add_u32 s12, s12, s14
  s_add_u32 m0, s12, 0
  s_add_u32 s20, s20, 1
  buffer_load_dwordx4 v2, s[48:51], s12 offen lds
  s_cmp_eq_u32 s20, 6
  s_cselect_b32 s20, 0, s20
  s_cmp_lg_u32 s19, 0
  s_cbranch_scc1 gated_mix__grouped_kv_mqa__geglu_ffn__prompt_kernel_kv1
  s_mov_b32 m0, 24576
  s_mov_b32 s12, 24576
  buffer_load_dwordx4 v2, s[48:51], s12 offen lds
gated_mix__grouped_kv_mqa__geglu_ffn__prompt_kernel_kv1:
  s_cmp_lg_u32 s19, 1
  s_cbranch_scc1 gated_mix__grouped_kv_mqa__geglu_ffn__prompt_kernel_nokv
  s_mov_b32 s56, s78
  s_and_b32 s57, s79, 0xffff
  s_mov_b32 s58, 1280
  s_mov_b32 s59, 0x20000
  s_mov_b32 m0, 25600
  s_mov_b32 s12, 0
  buffer_load_dwordx4 v2, s[56:59], s12 offen lds
  s_mov_b32 m0, 26624
  s_mov_b32 s12, 1024
  buffer_load_dwordx4 v2, s[56:59], s12 offen lds
gated_mix__grouped_kv_mqa__geglu_ffn__prompt_kernel_nokv:
  s_cmp_lg_u32 s19, 3
  s_cbranch_scc1 gated_mix__grouped_kv_mqa__geglu_ffn__prompt_kernel_n1
  buffer_load_dword v229, v230, s[84:87], 0 offen sc1
gated_mix__grouped_kv_mqa__geglu_ffn__prompt_kernel_n1:
  s_mov_b32 s8, s6
  s_and_b32 s9, s7, 0xffff
  s_mov_b32 s10, 21920000
  s_mov_b32 s11, 0x20000
  s_mov_b32 s32, s80
  s_and_b32 s33, s81, 0xffff
  s_mov_b32 s34, 2621440
  s_mov_b32 s35, 0x20000
  s_mov_b32 s24, s6
  s_and_b32 s25, s7, 0xffff
  s_mov_b32 s26, 9869312
  s_mov_b32 s27, 0x20000
  s_and_b32 s12, s2, 7
  s_lshr_b32 s13, s2, 3
  s_and_b32 s88, s12, 1
  s_lshl_b32 s88, s88, 2
  s_and_b32 s14, s13, 3
  s_add_u32 s88, s88, s14
  s_lshr_b32 s12, s12, 1
  s_mul_i32 s89, s12, 7
  s_lshr_b32 s14, s13, 2
  s_add_u32 s89, s89, s14
  s_add_u32 s13, s88, 59
  s_cmp_eq_u32 s89, 27
  s_cselect_b32 s89, s13, s89
  s_lshl_b32 s12, s12, 3
  s_add_u32 s12, s12, s88
  s_add_u32 s12, s12, 27
  s_cmp_eq_u32 s14, 7
  s_cselect_b32 s89, s12, s89
  v_and_b32 v10, 31, v1
  v_lshl_add_u32 v10, v10, 2, v92
  v_mov_b32 v11, 0
  ds_write_b32 v10, v11
  v_mov_b32 v90, 1
  v_bfe_u32 v226, v1, 2, 2
  v_and_b32 v14, 3, v1
  v_bfe_u32 v15, v1, 4, 1
  v_lshlrev_b32 v14, 3, v14
  v_lshl_add_u32 v227, v15, 5, v14
  v_mul_u32_u24 v95, 4352, v1
  s_and_b32 s12, s2, 7
  s_mul_i32 s5, s12, 4352
  v_add_u32 v9, 0, v1
  v_mul_u32_u24 v11, 3277, v9
  v_lshrrev_b32 v11, 16, v11
  v_mul_u32_u24 v14, 20, v11
  v_sub_u32 v14, v9, v14
  v_mul_u32_u24 v11, 1280, v11
  v_lshl_add_u32 v17, v14, 4, v11
  v_add_u32 v9, 64, v1
  v_mul_u32_u24 v11, 3277, v9
  v_lshrrev_b32 v11, 16, v11
  v_mul_u32_u24 v14, 20, v11
  v_sub_u32 v14, v9, v14
  v_mul_u32_u24 v11, 1280, v11
  v_lshl_add_u32 v18, v14, 4, v11
  v_add_u32 v9, 128, v1
  v_mul_u32_u24 v11, 3277, v9
  v_lshrrev_b32 v11, 16, v11
  v_mul_u32_u24 v14, 20, v11
  v_sub_u32 v14, v9, v14
  v_mul_u32_u24 v11, 1280, v11
  v_lshl_add_u32 v19, v14, 4, v11
  v_add_u32 v9, 192, v1
  v_mul_u32_u24 v11, 3277, v9
  v_lshrrev_b32 v11, 16, v11
  v_mul_u32_u24 v14, 20, v11
  v_sub_u32 v14, v9, v14
  v_mul_u32_u24 v11, 1280, v11
  v_lshl_add_u32 v20, v14, 4, v11
  v_add_u32 v9, 256, v1
  v_mul_u32_u24 v11, 3277, v9
  v_lshrrev_b32 v11, 16, v11
  v_mul_u32_u24 v14, 20, v11
  v_sub_u32 v14, v9, v14
  v_mul_u32_u24 v11, 1280, v11
  v_lshl_add_u32 v21, v14, 4, v11
  s_mul_i32 s20, s19, 20480
  s_mul_i32 s12, s22, 320
  s_add_u32 s20, s20, s12
  s_mul_i32 s21, s19, 5120
  v_lshrrev_b32 v11, 1, v224
  v_xor_b32 v12, v225, v11
  v_mul_u32_u24 v13, 1280, v224
  v_lshl_add_u32 v245, v12, 4, v13
  v_xor_b32 v12, 4, v12
  v_lshl_add_u32 v246, v12, 4, v13
  v_add_u32 v246, 10240, v246
  v_and_b32 v12, 1, v11
  v_lshlrev_b32 v12, 2, v12
  v_xor_b32 v12, v12, v225
  v_lshl_add_u32 v248, v12, 4, v13
  v_mul_u32_u24 v13, 3456, v224
  v_lshl_add_u32 v247, v12, 4, v13
  v_bfe_u32 v12, v1, 1, 3
  v_xor_b32 v12, v12, v7
  v_lshlrev_b32 v12, 4, v12
  v_lshl_add_u32 v12, v4, 7, v12
  s_lshl_b32 s12, s19, 5
  v_xor_b32 v22, s12, v12
  v_add_u32 v22, 40960, v22
  s_lshr_b32 s12, s19, 1
  s_lshl_b32 s12, s12, 14
  s_add_u32 s12, s12, 73088
  v_add_u32 v240, s12, v12
  v_xor_b32 v241, 32, v240
  v_xor_b32 v242, 64, v240
  v_xor_b32 v243, 96, v240
  v_lshrrev_b32 v13, 1, v226
  s_and_b32 s12, s19, 1
  v_xor_b32 v14, s12, v13
  v_lshl_add_u32 v14, v14, 6, v227
  v_lshl_add_u32 v15, v7, 3, v226
  v_lshl_add_u32 v244, v226, 7, v14
  v_lshl_add_u32 v244, v7, 11, v244
  v_add_u32 v244, 138624, v244
  s_lshl_b32 s12, s19, 4
  v_add_u32 v15, s12, v15
  v_mul_u32_u24 v23, 40, v15
  v_add_u32 v23, v23, v227
  v_add_u32 v23, 0, v23
  s_lshl_b32 s12, s19, 5
  s_add_u32 s12, s12, 25600
  v_lshl_add_u32 v228, v7, 4, s12
  v_lshl_add_u32 v15, v7, 2, v226
  v_lshl_add_u32 v14, v13, 6, v227
  v_lshl_add_u32 v249, v15, 7, v14
  s_mul_i32 s12, s19, 20480
  s_add_u32 s12, s12, 73088
  v_add_u32 v249, s12, v249
  v_xor_b32 v250, 64, v249
  v_lshrrev_b32 v14, 2, v224
  v_mul_u32_u24 v14, 46080, v14
  v_add_u32 v251, v248, v14
  s_lshl_b32 s12, s88, 8
  s_lshl_b32 s13, s19, 6
  s_add_u32 s12, s12, s13
  s_mul_i32 s90, s12, 1280
  s_lshl_b32 s98, s19, 13
  s_add_u32 s98, s98, 73088
  s_lshl_b32 s99, s19, 11
  s_add_u32 s99, s99, 138624
  s_mul_i32 s91, s19, 27648
  s_lshl_b32 s12, s89, 7
  s_add_u32 s91, s91, s12
  s_add_u32 m0, s21, 81920
  s_add_u32 s15, s20, 0
  buffer_load_dwordx4 v17, s[40:43], s15 offen lds
  s_add_u32 m0, s21, 82944
  s_nop 0
  buffer_load_dwordx4 v18, s[40:43], s15 offen lds
  s_add_u32 m0, s21, 83968
  s_nop 0
  buffer_load_dwordx4 v19, s[40:43], s15 offen lds
  s_add_u32 m0, s21, 84992
  s_nop 0
  buffer_load_dwordx4 v20, s[40:43], s15 offen lds
  s_add_u32 m0, s21, 86016
  s_nop 0
  buffer_load_dwordx4 v21, s[40:43], s15 offen lds
  s_waitcnt vmcnt(5)
  s_waitcnt lgkmcnt(0)
  s_barrier
  s_cmp_lg_u32 s19, 3
  s_cbranch_scc1 gated_mix__grouped_kv_mqa__geglu_ffn__prompt_kernel_tg1
gated_mix__grouped_kv_mqa__geglu_ffn__prompt_kernel_tg0:
  v_readfirstlane_b32 s12, v229
  s_nop 0
  s_cmp_lg_u32 s12, 0
  s_cbranch_scc1 gated_mix__grouped_kv_mqa__geglu_ffn__prompt_kernel_tgd
  s_sleep 4
  buffer_load_dword v229, v230, s[84:87], 0 offen sc1
  s_waitcnt vmcnt(0)
  s_sub_u32 s28, s28, 1
  s_cbranch_scc0 gated_mix__grouped_kv_mqa__geglu_ffn__prompt_kernel_tg0
gated_mix__grouped_kv_mqa__geglu_ffn__prompt_kernel_tgd:
  ds_write_b32 v92, v229 offset:52
gated_mix__grouped_kv_mqa__geglu_ffn__prompt_kernel_tg1:
  s_add_u32 m0, s21, 102400
  s_add_u32 s15, s20, 81920
  buffer_load_dwordx4 v17, s[40:43], s15 offen lds
  s_add_u32 m0, s21, 103424
  s_nop 0
  buffer_load_dwordx4 v18, s[40:43], s15 offen lds
  s_add_u32 m0, s21, 104448
  s_nop 0
  buffer_load_dwordx4 v19, s[40:43], s15 offen lds
  s_add_u32 m0, s21, 105472
  s_nop 0
  buffer_load_dwordx4 v20, s[40:43], s15 offen lds
  s_add_u32 m0, s21, 106496
  s_nop 0
  buffer_load_dwordx4 v21, s[40:43], s15 offen lds
  s_cmp_ge_u32 s22, 2
  s_cbranch_scc1 gated_mix__grouped_kv_mqa__geglu_ffn__prompt_kernel_j9
  s_cmp_eq_u32 s22, 1
  s_cbranch_scc1 gated_mix__grouped_kv_mqa__geglu_ffn__prompt_kernel_jV
  ds_read_b128 v[112:115], v22 offset:0
  ds_read_b64_tr_b16 v[116:117], v23 offset:0
  ds_read_b64_tr_b16 v[118:119], v23 offset:160
  s_mov_b32 exec_lo, 1048576
  s_mov_b32 exec_hi, 1048576
  ds_read_b128 v[116:119], v228 offset:0
  s_mov_b64 exec, -1
  ds_read_b128 v[120:123], v22 offset:4096
  ds_read_b64_tr_b16 v[124:125], v23 offset:2560
  ds_read_b64_tr_b16 v[126:127], v23 offset:2720
  s_mov_b32 exec_lo, 1048576
  s_mov_b32 exec_hi, 1048576
  ds_read_b128 v[124:127], v228 offset:128
  s_mov_b64 exec, -1
  ds_read_b128 v[128:131], v22 offset:8192
  ds_read_b64_tr_b16 v[132:133], v23 offset:5120
  ds_read_b64_tr_b16 v[134:135], v23 offset:5280
  s_mov_b32 exec_lo, 1048576
  s_mov_b32 exec_hi, 1048576
  ds_read_b128 v[132:135], v228 offset:256
  s_mov_b64 exec, -1
  s_waitcnt lgkmcnt(8)
  v_mfma_f32_32x32x16_bf16 v[96:111], v[116:119], v[112:115], 0
  ds_read_b128 v[136:139], v22 offset:12288
  ds_read_b64_tr_b16 v[140:141], v23 offset:7680
  ds_read_b64_tr_b16 v[142:143], v23 offset:7840
  s_mov_b32 exec_lo, 1048576
  s_mov_b32 exec_hi, 1048576
  ds_read_b128 v[140:143], v228 offset:384
  s_mov_b64 exec, -1
  s_waitcnt lgkmcnt(8)
  v_mfma_f32_32x32x16_bf16 v[96:111], v[124:127], v[120:123], v[96:111]
  ds_read_b128 v[144:147], v22 offset:16384
  ds_read_b64_tr_b16 v[148:149], v23 offset:10240
  ds_read_b64_tr_b16 v[150:151], v23 offset:10400
  s_mov_b32 exec_lo, 1048576
  s_mov_b32 exec_hi, 1048576
  ds_read_b128 v[148:151], v228 offset:512
  s_mov_b64 exec, -1
  s_waitcnt lgkmcnt(8)
  v_mfma_f32_32x32x16_bf16 v[96:111], v[132:135], v[128:131], v[96:111]
  ds_read_b128 v[152:155], v22 offset:20480
  ds_read_b64_tr_b16 v[156:157], v23 offset:12800
  ds_read_b64_tr_b16 v[158:159], v23 offset:12960
  s_mov_b32 exec_lo, 1048576
  s_mov_b32 exec_hi, 1048576
  ds_read_b128 v[156:159], v228 offset:640
  s_mov_b64 exec, -1
  s_waitcnt lgkmcnt(8)
  v_mfma_f32_32x32x16_bf16 v[96:111], v[140:143], v[136:139], v[96:111]
  ds_read_b128 v[160:163], v22 offset:24576
  ds_read_b64_tr_b16 v[164:165], v23 offset:15360
  ds_read_b64_tr_b16 v[166:167], v23 offset:15520
  s_mov_b32 exec_lo, 1048576
  s_mov_b32 exec_hi, 1048576
  ds_read_b128 v[164:167], v228 offset:768
  s_mov_b64 exec, -1
  s_waitcnt lgkmcnt(8)
  v_mfma_f32_32x32x16_bf16 v[96:111], v[148:151], v[144:147], v[96:111]
  ds_read_b128 v[168:171], v22 offset:28672
  ds_read_b64_tr_b16 v[172:173], v23 offset:17920
  ds_read_b64_tr_b16 v[174:175], v23 offset:18080
  s_mov_b32 exec_lo, 1048576
  s_mov_b32 exec_hi, 1048576
  ds_read_b128 v[172:175], v228 offset:896
  s_mov_b64 exec, -1
  s_waitcnt lgkmcnt(8)
  v_mfma_f32_32x32x16_bf16 v[96:111], v[156:159], v[152:155], v[96:111]
  ds_read_b128 v[176:179], v22 offset:32768
  ds_read_b64_tr_b16 v[180:181], v23 offset:20480
  ds_read_b64_tr_b16 v[182:183], v23 offset:20640
  s_mov_b32 exec_lo, 1048576
  s_mov_b32 exec_hi, 1048576
  ds_read_b128 v[180:183], v228 offset:1024
  s_mov_b64 exec, -1
  s_waitcnt lgkmcnt(8)
  v_mfma_f32_32x32x16_bf16 v[96:111], v[164:167], v[160:163], v[96:111]
  ds_read_b128 v[184:187], v22 offset:36864
  ds_read_b64_tr_b16 v[188:189], v23 offset:23040
  ds_read_b64_tr_b16 v[190:191], v23 offset:23200
  s_mov_b32 exec_lo, 1048576
  s_mov_b32 exec_hi, 1048576
  ds_read_b128 v[188:191], v228 offset:1152
  s_mov_b64 exec, -1
  s_waitcnt lgkmcnt(8)
  v_mfma_f32_32x32x16_bf16 v[96:111], v[172:175], v[168:171], v[96:111]
  s_waitcnt lgkmcnt(4)
  v_mfma_f32_32x32x16_bf16 v[96:111], v[180:183], v[176:179], v[96:111]
  s_waitcnt lgkmcnt(0)
  v_mfma_f32_32x32x16_bf16 v[96:111], v[188:191], v[184:187], v[96:111]
  s_branch gated_mix__grouped_kv_mqa__geglu_ffn__prompt_kernel_j8
gated_mix__grouped_kv_mqa__geglu_ffn__prompt_kernel_jV:
  ds_read_b128 v[112:115], v22 offset:0
  ds_read_b64_tr_b16 v[116:117], v23 offset:0
  ds_read_b64_tr_b16 v[118:119], v23 offset:160
  ds_read_b128 v[120:123], v22 offset:4096
  ds_read_b64_tr_b16 v[124:125], v23 offset:2560
  ds_read_b64_tr_b16 v[126:127], v23 offset:2720
  ds_read_b128 v[128:131], v22 offset:8192
  ds_read_b64_tr_b16 v[132:133], v23 offset:5120
  ds_read_b64_tr_b16 v[134:135], v23 offset:5280
  s_waitcnt lgkmcnt(6)
  v_mfma_f32_32x32x16_bf16 v[96:111], v[112:115], v[116:119], 0
  ds_read_b128 v[136:139], v22 offset:12288
  ds_read_b64_tr_b16 v[140:141], v23 offset:7680
  ds_read_b64_tr_b16 v[142:143], v23 offset:7840
  s_waitcnt lgkmcnt(6)
  v_mfma_f32_32x32x16_bf16 v[96:111], v[120:123], v[124:127], v[96:111]
  ds_read_b128 v[144:147], v22 offset:16384
  ds_read_b64_tr_b16 v[148:149], v23 offset:10240
  ds_read_b64_tr_b16 v[150:151], v23 offset:10400
  s_waitcnt lgkmcnt(6)
  v_mfma_f32_32x32x16_bf16 v[96:111], v[128:131], v[132:135], v[96:111]
  ds_read_b128 v[152:155], v22 offset:20480
  ds_read_b64_tr_b16 v[156:157], v23 offset:12800
  ds_read_b64_tr_b16 v[158:159], v23 offset:12960
  s_waitcnt lgkmcnt(6)
  v_mfma_f32_32x32x16_bf16 v[96:111], v[136:139], v[140:143], v[96:111]
  ds_read_b128 v[160:163], v22 offset:24576
  ds_read_b64_tr_b16 v[164:165], v23 offset:15360
  ds_read_b64_tr_b16 v[166:167], v23 offset:15520
  s_waitcnt lgkmcnt(6)
  v_mfma_f32_32x32x16_bf16 v[96:111], v[144:147], v[148:151], v[96:111]
  ds_read_b128 v[168:171], v22 offset:28672
  ds_read_b64_tr_b16 v[172:173], v23 offset:17920
  ds_read_b64_tr_b16 v[174:175], v23 offset:18080
  s_waitcnt lgkmcnt(6)
  v_mfma_f32_32x32x16_bf16 v[96:111], v[152:155], v[156:159], v[96:111]
  ds_read_b128 v[176:179], v22 offset:32768
  ds_read_b64_tr_b16 v[180:181], v23 offset:20480
  ds_read_b64_tr_b16 v[182:183], v23 offset:20640
  s_waitcnt lgkmcnt(6)
  v_mfma_f32_32x32x16_bf16 v[96:111], v[160:163], v[164:167], v[96:111]
  ds_read_b128 v[184:187], v22 offset:36864
  ds_read_b64_tr_b16 v[188:189], v23 offset:23040
  ds_read_b64_tr_b16 v[190:191], v23 offset:23200
  s_waitcnt lgkmcnt(6)
  v_mfma_f32_32x32x16_bf16 v[96:111], v[168:171], v[172:175], v[96:111]
  s_waitcnt lgkmcnt(3)
  v_mfma_f32_32x32x16_bf16 v[96:111], v[176:179], v[180:183], v[96:111]
  s_waitcnt lgkmcnt(0)
  v_mfma_f32_32x32x16_bf16 v[96:111], v[184:187], v[188:191], v[96:111]
gated_mix__grouped_kv_mqa__geglu_ffn__prompt_kernel_j8:
  s_nop 7
  s_cmp_eq_u32 s19, 0
  s_cbranch_scc1 gated_mix__grouped_kv_mqa__geglu_ffn__prompt_kernel_j9
  s_lshl_b32 s12, s19, 12
  s_add_u32 s12, s12, 23552
  v_add_u32 v9, s12, v2
  ds_write_b128 v9, v[96:99] offset:0
  ds_write_b128 v9, v[100:103] offset:1024
  ds_write_b128 v9, v[104:107] offset:2048
  ds_write_b128 v9, v[108:111] offset:3072
gated_mix__grouped_kv_mqa__geglu_ffn__prompt_kernel_j9:
  s_waitcnt lgkmcnt(0)
  s_barrier
  ds_read_b32 v9, v92 offset:52
  s_waitcnt lgkmcnt(0)
  v_readfirstlane_b32 s29, v9
  s_cmp_lg_u32 s19, 0
  s_cbranch_scc1 gated_mix__grouped_kv_mqa__geglu_ffn__prompt_kernel_pb9
  s_cmp_ge_u32 s22, 2
  s_cbranch_scc1 gated_mix__grouped_kv_mqa__geglu_ffn__prompt_kernel_pb9
  v_add_u32 v9, 27648, v2
  ds_read_b128 v[112:115], v9 offset:0
  ds_read_b128 v[116:119], v9 offset:1024
  ds_read_b128 v[120:123], v9 offset:2048
  ds_read_b128 v[124:127], v9 offset:3072
  ds_read_b128 v[128:131], v9 offset:4096
  ds_read_b128 v[132:135], v9 offset:5120
  ds_read_b128 v[136:139], v9 offset:6144
  ds_read_b128 v[140:143], v9 offset:7168
  ds_read_b128 v[144:147], v9 offset:8192
  ds_read_b128 v[148:151], v9 offset:9216
  ds_read_b128 v[152:155], v9 offset:10240
  ds_read_b128 v[156:159], v9 offset:11264
  s_lshr_b32 s14, s4, 1
  s_mul_i32 s14, s14, 5312
  s_add_u32 s14, s14, 9699328
  s_and_b32 s16, s4, 1
  s_waitcnt lgkmcnt(0)
  v_pk_add_f32 v[96:97], v[96:97], v[112:113]
  v_pk_add_f32 v[98:99], v[98:99], v[114:115]
  v_pk_add_f32 v[100:101], v[100:101], v[116:117]
  v_pk_add_f32 v[102:103], v[102:103], v[118:119]
  v_pk_add_f32 v[104:105], v[104:105], v[120:121]
  v_pk_add_f32 v[106:107], v[106:107], v[122:123]
  v_pk_add_f32 v[108:109], v[108:109], v[124:125]
  v_pk_add_f32 v[110:111], v[110:111], v[126:127]
  v_pk_add_f32 v[128:129], v[128:129], v[144:145]
  v_pk_add_f32 v[130:131], v[130:131], v[146:147]
  v_pk_add_f32 v[132:133], v[132:133], v[148:149]
  v_pk_add_f32 v[134:135], v[134:135], v[150:151]
  v_pk_add_f32 v[136:137], v[136:137], v[152:153]
  v_pk_add_f32 v[138:139], v[138:139], v[154:155]
  v_pk_add_f32 v[140:141], v[140:141], v[156:157]
  v_pk_add_f32 v[142:143], v[142:143], v[158:159]
  v_pk_add_f32 v[96:97], v[96:97], v[128:129]
  v_pk_add_f32 v[98:99], v[98:99], v[130:131]
  v_pk_add_f32 v[100:101], v[100:101], v[132:133]
  v_pk_add_f32 v[102:103], v[102:103], v[134:135]
  v_pk_add_f32 v[104:105], v[104:105], v[136:137]
  v_pk_add_f32 v[106:107], v[106:107], v[138:139]
  v_pk_add_f32 v[108:109], v[108:109], v[140:141]
  v_pk_add_f32 v[110:111], v[110:111], v[142:143]
  s_cmp_eq_u32 s22, 1
  s_cbranch_scc1 gated_mix__grouped_kv_mqa__geglu_ffn__prompt_kernel_pbV
  v_cvt_pk_bf16_f32 v160, v96, v97
  v_cvt_pk_bf16_f32 v161, v98, v99
  v_cvt_pk_bf16_f32 v162, v100, v101
  v_cvt_pk_bf16_f32 v163, v102, v103
  v_cvt_pk_bf16_f32 v164, v104, v105
  v_cvt_pk_bf16_f32 v165, v106, v107
  s_lshl_b32 s12, s16, 10
  s_add_u32 s12, s12, s14
  buffer_store_dwordx4 v[160:163], v2, s[8:11], s12 offen sc1
  s_lshl_b32 s12, s16, 3
  s_add_u32 s12, s12, s14
  s_add_u32 s12, s12, 2048
  v_mov_b32 v168, 0
  v_mov_b32 v169, 0
  v_mul_f32 v170, 0xbfb8aa3b, v104
  v_dot2c_f32_bf16 v168, v160, v160
  v_dot2c_f32_bf16 v168, v161, v161
  v_dot2c_f32_bf16 v168, v162, v162
  v_dot2c_f32_bf16 v168, v163, v163
  v_exp_f32 v170, v170
  s_mov_b32 exec_hi, 0
  buffer_store_dwordx2 v[164:165], v2, s[8:11], s12 offen sc1
  v_dot2c_f32_bf16 v169, v164, v164
  v_dot2c_f32_bf16 v169, v165, v165
  s_mov_b64 exec, -1
  v_add_f32 v170, 1.0, v170
  v_rcp_f32 v170, v170
  v_lshlrev_b32 v171, 2, v4
  s_lshl_b32 s12, s4, 7
  s_add_u32 s12, s12, 9869568
  v_add_f32 v168, v168, v169
  s_mov_b32 exec_lo, 0
  buffer_store_dword v170, v171, s[8:11], s12 offen sc1
  s_mov_b64 exec, -1
  v_mov_b32 v169, v168
  s_nop 1
  v_permlane32_swap_b32 v168, v169
  v_add_f32 v168, v168, v169
  s_nop 1
  v_max_f32_dpp v168, v168, v168 row_shr:1 row_mask:0xf bank_mask:0xf
  s_nop 1
  v_max_f32_dpp v168, v168, v168 row_shr:2 row_mask:0xf bank_mask:0xf
  s_nop 1
  v_max_f32_dpp v168, v168, v168 row_shr:4 row_mask:0xf bank_mask:0xf
  s_nop 1
  v_max_f32_dpp v168, v168, v168 row_shr:8 row_mask:0xf bank_mask:0xf
  s_nop 0
  v_readlane_b32 s12, v168, 15
  v_readlane_b32 s13, v168, 31
  s_nop 0
  s_max_u32 s12, s12, s13
  v_mov_b32 v168, s12
  s_lshl_b32 s13, s4, 2
  s_add_u32 s13, s13, 9869312
  s_mov_b64 exec, 1
  buffer_store_dword v168, v230, s[8:11], s13 offen sc1
  s_mov_b64 exec, -1
  s_branch gated_mix__grouped_kv_mqa__geglu_ffn__prompt_kernel_pbF
gated_mix__grouped_kv_mqa__geglu_ffn__prompt_kernel_pbV:
  v_cvt_pk_bf16_f32 v160, v96, v97
  v_cvt_pk_bf16_f32 v161, v98, v99
  v_cvt_pk_bf16_f32 v162, v100, v101
  v_cvt_pk_bf16_f32 v163, v102, v103
  v_cvt_pk_bf16_f32 v164, v104, v105
  v_cvt_pk_bf16_f32 v165, v106, v107
  v_cvt_pk_bf16_f32 v166, v108, v109
  v_cvt_pk_bf16_f32 v167, v110, v111
  s_mov_b32 exec_lo, 1048576
  s_mov_b32 exec_hi, 1048576
  v_mov_b32 v160, 0x3f803f80
  v_mov_b32 v161, 0x3f803f80
  v_mov_b32 v162, 0x3f803f80
  v_mov_b32 v163, 0x3f803f80
  v_mov_b32 v164, 0x3f803f80
  v_mov_b32 v165, 0x3f803f80
  v_mov_b32 v166, 0x3f803f80
  v_mov_b32 v167, 0x3f803f80
  s_mov_b32 exec_lo, 0
  s_mov_b32 exec_hi, 2097152
  v_mov_b32 v160, 0
  v_mov_b32 v161, 0
  v_mov_b32 v162, 0
  v_mov_b32 v163, 0
  v_mov_b32 v164, 0
  v_mov_b32 v165, 0
  v_mov_b32 v166, 0
  v_mov_b32 v167, 0
  s_mov_b32 exec_lo, 2097151
  s_mov_b32 exec_hi, 4194303
  v_mul_u32_u24 v168, 336, v7
  v_lshl_add_u32 v168, v4, 4, v168
  s_mul_i32 s12, s16, 1376
  s_add_u32 s12, s12, s14
  s_add_u32 s12, s12, 2560
  buffer_store_dwordx4 v[160:163], v168, s[8:11], s12 offen sc1
  buffer_store_dwordx4 v[164:167], v168, s[8:11], s12 offen offset:688 sc1
  s_mov_b64 exec, -1
gated_mix__grouped_kv_mqa__geglu_ffn__prompt_kernel_pbF:
gated_mix__grouped_kv_mqa__geglu_ffn__prompt_kernel_pb9:
  s_add_u32 m0, s21, 122880
  s_add_u32 s15, s20, 163840
  buffer_load_dwordx4 v17, s[40:43], s15 offen lds
  s_add_u32 m0, s21, 123904
  s_nop 0
  buffer_load_dwordx4 v18, s[40:43], s15 offen lds
  s_add_u32 m0, s21, 124928
  s_nop 0
  buffer_load_dwordx4 v19, s[40:43], s15 offen lds
  s_add_u32 m0, s21, 125952
  s_nop 0
  buffer_load_dwordx4 v20, s[40:43], s15 offen lds
  s_add_u32 m0, s21, 126976
  s_nop 0
  buffer_load_dwordx4 v21, s[40:43], s15 offen lds
  s_add_u32 m0, s21, 0
  s_add_u32 s15, s20, 245760
  buffer_load_dwordx4 v17, s[40:43], s15 offen lds
  s_add_u32 m0, s21, 1024
  s_nop 0
  buffer_load_dwordx4 v18, s[40:43], s15 offen lds
  s_add_u32 m0, s21, 2048
  s_nop 0
  buffer_load_dwordx4 v19, s[40:43], s15 offen lds
  s_add_u32 m0, s21, 3072
  s_nop 0
  buffer_load_dwordx4 v20, s[40:43], s15 offen lds
  s_add_u32 m0, s21, 4096
  s_nop 0
  buffer_load_dwordx4 v21, s[40:43], s15 offen lds
  s_waitcnt vmcnt(16)
  s_barrier
  s_add_u32 m0, s21, 20480
  s_add_u32 s15, s20, 327680
  buffer_load_dwordx4 v17, s[40:43], s15 offen lds
  s_add_u32 m0, s21, 21504
  s_nop 0
  buffer_load_dwordx4 v18, s[40:43], s15 offen lds
  s_add_u32 m0, s21, 22528
  s_nop 0
  buffer_load_dwordx4 v19, s[40:43], s15 offen lds
  s_add_u32 m0, s21, 23552
  s_nop 0
  buffer_load_dwordx4 v20, s[40:43], s15 offen lds
  s_add_u32 m0, s21, 24576
  s_nop 0
  buffer_load_dwordx4 v21, s[40:43], s15 offen lds
  v_lshlrev_b32 v234, 3, v1
  s_add_u32 s18, s5, 20806912
  s_mov_b32 s17, 0
  s_sub_u32 s83, s89, 27
  s_lshl_b32 s83, s83, 2
  s_add_u32 s83, s83, s19
  s_mul_i32 s83, s83, 10
  s_mul_i32 s101, s19, 20480
  s_waitcnt vmcnt(16)
  s_barrier
  s_add_u32 m0, s21, 81920
  s_add_u32 s15, s20, 409600
  buffer_load_dwordx4 v17, s[40:43], s15 offen lds
  s_add_u32 m0, s21, 82944
  s_nop 0
  buffer_load_dwordx4 v18, s[40:43], s15 offen lds
  s_add_u32 m0, s21, 83968
  s_nop 0
  buffer_load_dwordx4 v19, s[40:43], s15 offen lds
  s_add_u32 m0, s21, 84992
  s_nop 0
  buffer_load_dwordx4 v20, s[40:43], s15 offen lds
  s_add_u32 m0, s21, 86016
  s_nop 0
  buffer_load_dwordx4 v21, s[40:43], s15 offen lds
  s_cmp_lg_u32 s19, 0
  s_cbranch_scc1 gated_mix__grouped_kv_mqa__geglu_ffn__prompt_kernel_pf_8
  s_cmp_ge_u32 s22, 2
  s_cbranch_scc1 gated_mix__grouped_kv_mqa__geglu_ffn__prompt_kernel_pf_8
  s_lshl_b32 s12, s4, 1
  s_add_u32 s12, s12, s22
  s_lshl_b32 s12, s12, 2
  s_add_u32 s12, s12, 20806912
  v_mov_b32 v168, s29
  s_waitcnt vmcnt(20)
  s_mov_b64 exec, 0xff
  buffer_store_dword v168, v95, s[8:11], s12 offen sc1
  s_mov_b64 exec, -1
gated_mix__grouped_kv_mqa__geglu_ffn__prompt_kernel_pf_8:
  s_waitcnt vmcnt(15)
  s_barrier
  s_add_u32 m0, s21, 102400
  s_add_u32 s15, s20, 491520
  buffer_load_dwordx4 v17, s[40:43], s15 offen lds
  s_add_u32 m0, s21, 103424
  s_nop 0
  buffer_load_dwordx4 v18, s[40:43], s15 offen lds
  s_add_u32 m0, s21, 104448
  s_nop 0
  buffer_load_dwordx4 v19, s[40:43], s15 offen lds
  s_add_u32 m0, s21, 105472
  s_nop 0
  buffer_load_dwordx4 v20, s[40:43], s15 offen lds
  s_add_u32 m0, s21, 106496
  s_nop 0
  buffer_load_dwordx4 v21, s[40:43], s15 offen lds
  s_waitcnt vmcnt(15)
  s_barrier
  s_add_u32 m0, s21, 122880
  s_add_u32 s15, s20, 573440
  buffer_load_dwordx4 v17, s[40:43], s15 offen lds
  s_add_u32 m0, s21, 123904
  s_nop 0
  buffer_load_dwordx4 v18, s[40:43], s15 offen lds
  s_add_u32 m0, s21, 124928
  s_nop 0
  buffer_load_dwordx4 v19, s[40:43], s15 offen lds
  s_add_u32 m0, s21, 125952
  s_nop 0
  buffer_load_dwordx4 v20, s[40:43], s15 offen lds
  s_add_u32 m0, s21, 126976
  s_nop 0
  buffer_load_dwordx4 v21, s[40:43], s15 offen lds
  s_waitcnt vmcnt(15)
  s_barrier
  s_add_u32 m0, s21, 0
  s_add_u32 s15, s20, 655360
  buffer_load_dwordx4 v17, s[40:43], s15 offen lds
  s_add_u32 m0, s21, 1024
  s_nop 0
  buffer_load_dwordx4 v18, s[40:43], s15 offen lds
  s_add_u32 m0, s21, 2048
  s_nop 0
  buffer_load_dwordx4 v19, s[40:43], s15 offen lds
  s_add_u32 m0, s21, 3072
  s_nop 0
  buffer_load_dwordx4 v20, s[40:43], s15 offen lds
  s_add_u32 m0, s21, 4096
  s_nop 0
  buffer_load_dwordx4 v21, s[40:43], s15 offen lds
  s_waitcnt vmcnt(15)
  s_barrier
  s_add_u32 m0, s21, 20480
  s_add_u32 s15, s20, 737280
  buffer_load_dwordx4 v17, s[40:43], s15 offen lds
  s_add_u32 m0, s21, 21504
  s_nop 0
  buffer_load_dwordx4 v18, s[40:43], s15 offen lds
  s_add_u32 m0, s21, 22528
  s_nop 0
  buffer_load_dwordx4 v19, s[40:43], s15 offen lds
  s_add_u32 m0, s21, 23552
  s_nop 0
  buffer_load_dwordx4 v20, s[40:43], s15 offen lds
  s_add_u32 m0, s21, 24576
  s_nop 0
  buffer_load_dwordx4 v21, s[40:43], s15 offen lds
  s_waitcnt vmcnt(15)
  s_barrier
  s_mov_b32 s40, s72
  s_and_b32 s41, s73, 0xffff
  s_mov_b32 s42, 2211840
  s_mov_b32 s43, 0x20000
  s_mov_b32 s44, s74
  s_and_b32 s45, s75, 0xffff
  s_mov_b32 s46, 2211840
  s_mov_b32 s47, 0x20000
  v_add_u32 v253, 18432, v245
  v_add_u32 v254, 17408, v246
  v_subrev_u32 v246, 1024, v246
  s_sub_u32 s44, s44, 1024
  s_subb_u32 s45, s45, 0
  s_add_u32 s46, s46, 1024
  v_mov_b32 v255, v247
  s_cmp_eq_u32 s19, 1
  s_cselect_b32 exec_lo, -1, 1
  s_cselect_b32 exec_hi, -1, 0
  buffer_load_dwordx2 v[232:233], v234, s[8:11], s18 offen sc1
  s_mov_b64 exec, -1
  s_waitcnt vmcnt(11)
  s_barrier
  s_waitcnt vmcnt(1)
  s_cmp_lg_u32 s19, 1
  s_cbranch_scc1 gated_mix__grouped_kv_mqa__geglu_ffn__prompt_kernel_kc7
  s_waitcnt vmcnt(0)
  v_cmp_ne_u32 vcc, s29, v232
  v_cmp_ne_u32 s[92:93], s29, v233
  s_nop 1
  s_or_b64 vcc, vcc, s[92:93]
  s_cbranch_vccnz gated_mix__grouped_kv_mqa__geglu_ffn__prompt_kernel_kc_9
  ds_write_b32 v92, v90 offset:48
  s_mov_b32 s17, 1
gated_mix__grouped_kv_mqa__geglu_ffn__prompt_kernel_kc_9:
  s_waitcnt lgkmcnt(0)
gated_mix__grouped_kv_mqa__geglu_ffn__prompt_kernel_kc7:
  s_barrier
  s_cmp_ge_u32 s89, 27
  s_cbranch_scc1 gated_mix__grouped_kv_mqa__geglu_ffn__prompt_kernel_g1f
  s_add_u32 m0, s99, 0
  s_add_u32 s15, s91, 0
  buffer_load_dwordx4 v247, s[40:43], s15 offen lds
  buffer_load_dwordx4 v255, s[44:47], s15 offen offset:1024 lds
  s_add_u32 m0, s98, 32768
  s_add_u32 s15, s90, 0
  buffer_load_dwordx4 v245, s[36:39], s15 offen offset:0 lds
  buffer_load_dwordx4 v246, s[36:39], s15 offen offset:1024 lds
  buffer_load_dwordx4 v253, s[36:39], s15 offen offset:2048 lds
  buffer_load_dwordx4 v254, s[36:39], s15 offen offset:3072 lds
  s_add_u32 m0, s98, 36864
  s_add_u32 s15, s90, 40960
  buffer_load_dwordx4 v245, s[36:39], s15 offen offset:0 lds
  buffer_load_dwordx4 v246, s[36:39], s15 offen offset:1024 lds
  buffer_load_dwordx4 v253, s[36:39], s15 offen offset:2048 lds
  buffer_load_dwordx4 v254, s[36:39], s15 offen offset:3072 lds
  s_add_u32 m0, s99, 8192
  s_add_u32 s15, s91, 110592
  buffer_load_dwordx4 v247, s[40:43], s15 offen lds
  buffer_load_dwordx4 v255, s[44:47], s15 offen offset:1024 lds
gated_mix__grouped_kv_mqa__geglu_ffn__prompt_kernel_g1f:
  s_barrier
  ds_read_b32 v91, v92 offset:48
  s_lshl_b32 s20, s19, 10
  s_add_u32 s21, s20, 9709952
  s_waitcnt lgkmcnt(0)
  v_readfirstlane_b32 s17, v91
  s_barrier
  s_cmp_lg_u32 s17, 0
  s_cbranch_scc1 gated_mix__grouped_kv_mqa__geglu_ffn__prompt_kernel_np2
  s_cmp_lg_u32 s19, 1
  s_cbranch_scc1 gated_mix__grouped_kv_mqa__geglu_ffn__prompt_kernel_kp_10_d
gated_mix__grouped_kv_mqa__geglu_ffn__prompt_kernel_kp_10:
  s_cmp_lg_u32 s17, 0
  s_cbranch_scc1 gated_mix__grouped_kv_mqa__geglu_ffn__prompt_kernel_kp_10_d
  buffer_load_dwordx2 v[232:233], v234, s[8:11], s18 offen sc1
  s_waitcnt vmcnt(0)
  v_cmp_ne_u32 vcc, s29, v232
  v_cmp_ne_u32 s[92:93], s29, v233
  s_nop 1
  s_or_b64 vcc, vcc, s[92:93]
  s_cbranch_vccnz gated_mix__grouped_kv_mqa__geglu_ffn__prompt_kernel_kc_11
  ds_write_b32 v92, v90 offset:48
  s_mov_b32 s17, 1
gated_mix__grouped_kv_mqa__geglu_ffn__prompt_kernel_kc_11:
  s_sleep 2
  s_sub_u32 s28, s28, 1
  s_cbranch_scc0 gated_mix__grouped_kv_mqa__geglu_ffn__prompt_kernel_kp_10
gated_mix__grouped_kv_mqa__geglu_ffn__prompt_kernel_kp_10_d:
gated_mix__grouped_kv_mqa__geglu_ffn__prompt_kernel_sp_12:
  ds_read_b32 v91, v92 offset:48
  s_waitcnt lgkmcnt(0)
  v_readfirstlane_b32 s12, v91
  s_nop 0
  s_cmp_ge_u32 s12, 1
  s_cbranch_scc1 gated_mix__grouped_kv_mqa__geglu_ffn__prompt_kernel_sp_12_d
  s_sub_u32 s28, s28, 1
  s_cbranch_scc0 gated_mix__grouped_kv_mqa__geglu_ffn__prompt_kernel_sp_12
gated_mix__grouped_kv_mqa__geglu_ffn__prompt_kernel_sp_12_d:
gated_mix__grouped_kv_mqa__geglu_ffn__prompt_kernel_np2:
  s_add_u32 m0, s20, 0
  s_add_u32 s14, s21, 0
  buffer_load_dwordx4 v2, s[24:27], s14 offen sc1 lds
  s_add_u32 m0, s20, 4096
  s_add_u32 s14, s21, 4096
  buffer_load_dwordx4 v2, s[24:27], s14 offen sc1 lds
  s_add_u32 m0, s20, 8192
  s_add_u32 s14, s21, 8192
  buffer_load_dwordx4 v2, s[24:27], s14 offen sc1 lds
  s_mul_i32 s12, s19, 27
  s_mul_i32 s87, s22, 108
  s_add_u32 s87, s87, s12
  s_mul_i32 s87, s87, 5120
  s_add_u32 s87, s87, 12499200
  v_min_u32 v13, 39, v1
  v_lshlrev_b32 v13, 2, v13
  s_add_u32 s18, s5, 20807936
  s_mov_b32 s86, 0
  s_cmp_ge_u32 s89, 27
  s_cbranch_scc1 gated_mix__grouped_kv_mqa__geglu_ffn__prompt_kernel_R
  s_setprio 2
  s_waitcnt vmcnt(5)
  s_mov_b64 exec, 1
  ds_add_u32 v92, v90 offset:40
  s_mov_b64 exec, -1
  ds_read_b32 v91, v92 offset:40
  s_waitcnt lgkmcnt(0)
  v_readfirstlane_b32 s12, v91
  s_nop 0
  s_cmp_ge_u32 s12, 4
  s_cbranch_scc1 gated_mix__grouped_kv_mqa__geglu_ffn__prompt_kernel_ck_13
gated_mix__grouped_kv_mqa__geglu_ffn__prompt_kernel_sp_14:
  ds_read_b32 v91, v92 offset:40
  s_waitcnt lgkmcnt(0)
  v_readfirstlane_b32 s12, v91
  s_nop 0
  s_cmp_ge_u32 s12, 4
  s_cbranch_scc1 gated_mix__grouped_kv_mqa__geglu_ffn__prompt_kernel_sp_14_d
  s_sub_u32 s28, s28, 1
  s_cbranch_scc0 gated_mix__grouped_kv_mqa__geglu_ffn__prompt_kernel_sp_14
gated_mix__grouped_kv_mqa__geglu_ffn__prompt_kernel_sp_14_d:
gated_mix__grouped_kv_mqa__geglu_ffn__prompt_kernel_ck_13:
  ds_read_b64_tr_b16 v[56:57], v244 offset:0
  ds_read_b64_tr_b16 v[58:59], v244 offset:512
  ds_read_b64_tr_b16 v[60:61], v244 offset:1024
  ds_read_b64_tr_b16 v[62:63], v244 offset:1536
  ds_read_b128 v[24:27], v240 offset:32768
  ds_read_b128 v[28:31], v240 offset:36864
  ds_read_b128 v[32:35], v240 offset:40960
  ds_read_b128 v[36:39], v240 offset:45056
  s_add_u32 m0, s99, 16384
  s_add_u32 s15, s91, 221184
  buffer_load_dwordx4 v247, s[40:43], s15 offen lds
  buffer_load_dwordx4 v255, s[44:47], s15 offen offset:1024 lds
  s_add_u32 m0, s98, 0
  s_add_u32 s15, s90, 128
  buffer_load_dwordx4 v245, s[36:39], s15 offen offset:0 lds
  buffer_load_dwordx4 v246, s[36:39], s15 offen offset:1024 lds
  buffer_load_dwordx4 v253, s[36:39], s15 offen offset:2048 lds
  buffer_load_dwordx4 v254, s[36:39], s15 offen offset:3072 lds
  s_waitcnt lgkmcnt(3)
  v_mfma_f32_32x32x16_bf16 v[96:111], v[56:59], v[24:27], 0
  ds_read_b64_tr_b16 v[64:65], v244 offset:4096
  ds_read_b64_tr_b16 v[66:67], v244 offset:4608
  v_mfma_f32_32x32x16_bf16 v[160:175], v[60:63], v[24:27], 0
  ds_read_b64_tr_b16 v[68:69], v244 offset:5120
  ds_read_b64_tr_b16 v[70:71], v244 offset:5632
  s_add_u32 m0, s98, 4096
  s_add_u32 s15, s90, 41088
  buffer_load_dwordx4 v245, s[36:39], s15 offen offset:0 lds
  buffer_load_dwordx4 v246, s[36:39], s15 offen offset:1024 lds
  buffer_load_dwordx4 v253, s[36:39], s15 offen offset:2048 lds
  buffer_load_dwordx4 v254, s[36:39], s15 offen offset:3072 lds
  s_waitcnt lgkmcnt(6)
  v_mfma_f32_32x32x16_bf16 v[112:127], v[56:59], v[28:31], 0
  ds_read_b128 v[40:43], v241 offset:32768
  ds_read_b128 v[44:47], v241 offset:36864
  v_mfma_f32_32x32x16_bf16 v[176:191], v[60:63], v[28:31], 0
  ds_read_b128 v[48:51], v241 offset:40960
  ds_read_b128 v[52:55], v241 offset:45056
  s_add_u32 m0, s20, 12288
  s_add_u32 s14, s21, 12288
  buffer_load_dwordx4 v2, s[24:27], s14 offen sc1 lds
  s_waitcnt lgkmcnt(9)
  v_mfma_f32_32x32x16_bf16 v[128:143], v[56:59], v[32:35], 0
  s_add_u32 m0, s20, 16384
  s_add_u32 s14, s21, 16384
  buffer_load_dwordx4 v2, s[24:27], s14 offen sc1 lds
  v_mfma_f32_32x32x16_bf16 v[192:207], v[60:63], v[32:35], 0
  s_add_u32 m0, s20, 20480
  s_add_u32 s14, s21, 20480
  buffer_load_dwordx4 v2, s[24:27], s14 offen sc1 lds
  s_waitcnt lgkmcnt(8)
  v_mfma_f32_32x32x16_bf16 v[144:159], v[56:59], v[36:39], 0
  s_add_u32 m0, s20, 24576
  s_add_u32 s14, s21, 24576
  buffer_load_dwordx4 v2, s[24:27], s14 offen sc1 lds
  v_mfma_f32_32x32x16_bf16 v[208:223], v[60:63], v[36:39], 0
  s_add_u32 m0, s20, 28672
  s_add_u32 s14, s21, 28672
  buffer_load_dwordx4 v2, s[24:27], s14 offen sc1 lds
  s_waitcnt lgkmcnt(0)
  v_mfma_f32_32x32x16_bf16 v[96:111], v[64:67], v[40:43], v[96:111]
  s_waitcnt vmcnt(15)
  s_mov_b64 exec, 1
  ds_add_u32 v92, v90 offset:0
  s_mov_b64 exec, -1
  s_mov_b64 exec, 1
  ds_add_u32 v92, v90 offset:40
  s_mov_b64 exec, -1
  ds_read_b32 v91, v92 offset:40
  v_mfma_f32_32x32x16_bf16 v[160:175], v[68:71], v[40:43], v[160:175]
  v_mfma_f32_32x32x16_bf16 v[112:127], v[64:67], v[44:47], v[112:127]
  v_mfma_f32_32x32x16_bf16 v[176:191], v[68:71], v[44:47], v[176:191]
  s_waitcnt lgkmcnt(0)
  v_readfirstlane_b32 s12, v91
  s_nop 0
  s_cmp_ge_u32 s12, 8
  s_cbranch_scc1 gated_mix__grouped_kv_mqa__geglu_ffn__prompt_kernel_ck_15
gated_mix__grouped_kv_mqa__geglu_ffn__prompt_kernel_sp_16:
  ds_read_b32 v91, v92 offset:40
  s_waitcnt lgkmcnt(0)
  v_readfirstlane_b32 s12, v91
  s_nop 0
  s_cmp_ge_u32 s12, 8
  s_cbranch_scc1 gated_mix__grouped_kv_mqa__geglu_ffn__prompt_kernel_sp_16_d
  s_sub_u32 s28, s28, 1
  s_cbranch_scc0 gated_mix__grouped_kv_mqa__geglu_ffn__prompt_kernel_sp_16
gated_mix__grouped_kv_mqa__geglu_ffn__prompt_kernel_sp_16_d:
gated_mix__grouped_kv_mqa__geglu_ffn__prompt_kernel_ck_15:
  v_mfma_f32_32x32x16_bf16 v[128:143], v[64:67], v[48:51], v[128:143]
  ds_read_b64_tr_b16 v[72:73], v244 offset:8192
  ds_read_b64_tr_b16 v[74:75], v244 offset:8704
  ds_read_b64_tr_b16 v[76:77], v244 offset:9216
  v_mfma_f32_32x32x16_bf16 v[192:207], v[68:71], v[48:51], v[192:207]
  ds_read_b64_tr_b16 v[78:79], v244 offset:9728
  ds_read_b128 v[24:27], v242 offset:32768
  ds_read_b128 v[28:31], v242 offset:36864
  v_mfma_f32_32x32x16_bf16 v[144:159], v[64:67], v[52:55], v[144:159]
  ds_read_b128 v[32:35], v242 offset:40960
  ds_read_b128 v[36:39], v242 offset:45056
  v_mfma_f32_32x32x16_bf16 v[208:223], v[68:71], v[52:55], v[208:223]
  s_waitcnt lgkmcnt(3)
  v_mfma_f32_32x32x16_bf16 v[96:111], v[72:75], v[24:27], v[96:111]
  ds_read_b64_tr_b16 v[80:81], v244 offset:12288
  ds_read_b64_tr_b16 v[82:83], v244 offset:12800
  v_mfma_f32_32x32x16_bf16 v[160:175], v[76:79], v[24:27], v[160:175]
  ds_read_b64_tr_b16 v[84:85], v244 offset:13312
  ds_read_b64_tr_b16 v[86:87], v244 offset:13824
  s_add_u32 m0, s99, 0
  s_add_u32 s15, s91, 331776
  buffer_load_dwordx4 v247, s[40:43], s15 offen lds
  buffer_load_dwordx4 v255, s[44:47], s15 offen offset:1024 lds
  s_waitcnt lgkmcnt(6)
  v_mfma_f32_32x32x16_bf16 v[112:127], v[72:75], v[28:31], v[112:127]
  ds_read_b128 v[40:43], v243 offset:32768
  ds_read_b128 v[44:47], v243 offset:36864
  v_mfma_f32_32x32x16_bf16 v[176:191], v[76:79], v[28:31], v[176:191]
  ds_read_b128 v[48:51], v243 offset:40960
  ds_read_b128 v[52:55], v243 offset:45056
  s_add_u32 m0, s20, 32768
  s_add_u32 s14, s21, 32768
  buffer_load_dwordx4 v2, s[24:27], s14 offen sc1 lds
  s_waitcnt lgkmcnt(9)
  v_mfma_f32_32x32x16_bf16 v[128:143], v[72:75], v[32:35], v[128:143]
  s_add_u32 m0, s20, 36864
  s_add_u32 s14, s21, 36864
  buffer_load_dwordx4 v2, s[24:27], s14 offen sc1 lds
  v_mfma_f32_32x32x16_bf16 v[192:207], v[76:79], v[32:35], v[192:207]
  s_add_u32 m0, s20, 40960
  s_add_u32 s14, s21, 40960
  buffer_load_dwordx4 v2, s[24:27], s14 offen sc1 lds
  s_waitcnt lgkmcnt(8)
  v_mfma_f32_32x32x16_bf16 v[144:159], v[72:75], v[36:39], v[144:159]
  s_add_u32 m0, s20, 45056
  s_add_u32 s14, s21, 45056
  buffer_load_dwordx4 v2, s[24:27], s14 offen sc1 lds
  v_mfma_f32_32x32x16_bf16 v[208:223], v[76:79], v[36:39], v[208:223]
  s_add_u32 m0, s20, 49152
  s_add_u32 s14, s21, 49152
  buffer_load_dwordx4 v2, s[24:27], s14 offen sc1 lds
  s_waitcnt lgkmcnt(0)
  v_mfma_f32_32x32x16_bf16 v[96:111], v[80:83], v[40:43], v[96:111]
  s_waitcnt vmcnt(7)
  s_mov_b64 exec, 1
  ds_add_u32 v92, v90 offset:4
  s_mov_b64 exec, -1
  s_mov_b64 exec, 1
  ds_add_u32 v92, v90 offset:40
  s_mov_b64 exec, -1
  ds_read_b32 v91, v92 offset:40
  v_mfma_f32_32x32x16_bf16 v[160:175], v[84:87], v[40:43], v[160:175]
  v_mfma_f32_32x32x16_bf16 v[112:127], v[80:83], v[44:47], v[112:127]
  v_mfma_f32_32x32x16_bf16 v[176:191], v[84:87], v[44:47], v[176:191]
  s_waitcnt lgkmcnt(0)
  v_readfirstlane_b32 s12, v91
  s_nop 0
  s_cmp_ge_u32 s12, 12
  s_cbranch_scc1 gated_mix__grouped_kv_mqa__geglu_ffn__prompt_kernel_ck_17
gated_mix__grouped_kv_mqa__geglu_ffn__prompt_kernel_sp_18:
  ds_read_b32 v91, v92 offset:40
  s_waitcnt lgkmcnt(0)
  v_readfirstlane_b32 s12, v91
  s_nop 0
  s_cmp_ge_u32 s12, 12
  s_cbranch_scc1 gated_mix__grouped_kv_mqa__geglu_ffn__prompt_kernel_sp_18_d
  s_sub_u32 s28, s28, 1
  s_cbranch_scc0 gated_mix__grouped_kv_mqa__geglu_ffn__prompt_kernel_sp_18
gated_mix__grouped_kv_mqa__geglu_ffn__prompt_kernel_sp_18_d:
gated_mix__grouped_kv_mqa__geglu_ffn__prompt_kernel_ck_17:
  v_mfma_f32_32x32x16_bf16 v[128:143], v[80:83], v[48:51], v[128:143]
  ds_read_b64_tr_b16 v[56:57], v244 offset:16384
  ds_read_b64_tr_b16 v[58:59], v244 offset:16896
  ds_read_b64_tr_b16 v[60:61], v244 offset:17408
  v_mfma_f32_32x32x16_bf16 v[192:207], v[84:87], v[48:51], v[192:207]
  ds_read_b64_tr_b16 v[62:63], v244 offset:17920
  ds_read_b128 v[24:27], v240 offset:0
  ds_read_b128 v[28:31], v240 offset:4096
  v_mfma_f32_32x32x16_bf16 v[144:159], v[80:83], v[52:55], v[144:159]
  ds_read_b128 v[32:35], v240 offset:8192
  ds_read_b128 v[36:39], v240 offset:12288
  v_mfma_f32_32x32x16_bf16 v[208:223], v[84:87], v[52:55], v[208:223]
  s_waitcnt lgkmcnt(3)
  v_mfma_f32_32x32x16_bf16 v[96:111], v[56:59], v[24:27], v[96:111]
  ds_read_b64_tr_b16 v[64:65], v244 offset:20480
  ds_read_b64_tr_b16 v[66:67], v244 offset:20992
  v_mfma_f32_32x32x16_bf16 v[160:175], v[60:63], v[24:27], v[160:175]
  ds_read_b64_tr_b16 v[68:69], v244 offset:21504
  ds_read_b64_tr_b16 v[70:71], v244 offset:22016
  s_add_u32 m0, s99, 8192
  s_add_u32 s15, s91, 442368
  buffer_load_dwordx4 v247, s[40:43], s15 offen lds
  buffer_load_dwordx4 v255, s[44:47], s15 offen offset:1024 lds
  s_waitcnt lgkmcnt(6)
  v_mfma_f32_32x32x16_bf16 v[112:127], v[56:59], v[28:31], v[112:127]
  ds_read_b128 v[40:43], v241 offset:0
  ds_read_b128 v[44:47], v241 offset:4096
  v_mfma_f32_32x32x16_bf16 v[176:191], v[60:63], v[28:31], v[176:191]
  ds_read_b128 v[48:51], v241 offset:8192
  ds_read_b128 v[52:55], v241 offset:12288
  s_add_u32 m0, s98, 32768
  s_add_u32 s15, s90, 256
  buffer_load_dwordx4 v245, s[36:39], s15 offen offset:0 lds
  buffer_load_dwordx4 v246, s[36:39], s15 offen offset:1024 lds
  buffer_load_dwordx4 v253, s[36:39], s15 offen offset:2048 lds
  buffer_load_dwordx4 v254, s[36:39], s15 offen offset:3072 lds
  s_waitcnt lgkmcnt(9)
  v_mfma_f32_32x32x16_bf16 v[128:143], v[56:59], v[32:35], v[128:143]
  s_add_u32 m0, s98, 36864
  s_add_u32 s15, s90, 41216
  buffer_load_dwordx4 v245, s[36:39], s15 offen offset:0 lds
  buffer_load_dwordx4 v246, s[36:39], s15 offen offset:1024 lds
  buffer_load_dwordx4 v253, s[36:39], s15 offen offset:2048 lds
  buffer_load_dwordx4 v254, s[36:39], s15 offen offset:3072 lds
  v_mfma_f32_32x32x16_bf16 v[192:207], v[60:63], v[32:35], v[192:207]
  s_add_u32 m0, s20, 53248
  s_add_u32 s14, s21, 53248
  buffer_load_dwordx4 v2, s[24:27], s14 offen sc1 lds
  s_waitcnt lgkmcnt(8)
  v_mfma_f32_32x32x16_bf16 v[144:159], v[56:59], v[36:39], v[144:159]
  s_add_u32 m0, s20, 57344
  s_add_u32 s14, s21, 57344
  buffer_load_dwordx4 v2, s[24:27], s14 offen sc1 lds
  v_mfma_f32_32x32x16_bf16 v[208:223], v[60:63], v[36:39], v[208:223]
  s_add_u32 m0, s20, 61440
  s_add_u32 s14, s21, 61440
  buffer_load_dwordx4 v2, s[24:27], s14 offen sc1 lds
  s_waitcnt lgkmcnt(0)
  v_mfma_f32_32x32x16_bf16 v[96:111], v[64:67], v[40:43], v[96:111]
  s_waitcnt vmcnt(18)
  s_mov_b64 exec, 1
  ds_add_u32 v92, v90 offset:40
  s_mov_b64 exec, -1
  ds_read_b32 v91, v92 offset:40
  v_mfma_f32_32x32x16_bf16 v[160:175], v[68:71], v[40:43], v[160:175]
  s_add_u32 m0, s20, 65536
  s_add_u32 s14, s21, 65536
  buffer_load_dwordx4 v2, s[24:27], s14 offen sc1 lds
  v_mfma_f32_32x32x16_bf16 v[112:127], v[64:67], v[44:47], v[112:127]
  s_cmp_eq_u32 s19, 3
  s_cselect_b32 exec_lo, 0xffffff, -1
  s_cselect_b32 exec_hi, 0, -1
  s_add_u32 m0, s20, 69632
  s_add_u32 s14, s21, 69632
  buffer_load_dwordx4 v2, s[24:27], s14 offen sc1 lds
  s_mov_b64 exec, -1
  v_mfma_f32_32x32x16_bf16 v[176:191], v[68:71], v[44:47], v[176:191]
  s_waitcnt lgkmcnt(0)
  v_readfirstlane_b32 s12, v91
  s_nop 0
  s_cmp_ge_u32 s12, 16
  s_cbranch_scc1 gated_mix__grouped_kv_mqa__geglu_ffn__prompt_kernel_ck_19
gated_mix__grouped_kv_mqa__geglu_ffn__prompt_kernel_sp_20:
  ds_read_b32 v91, v92 offset:40
  s_waitcnt lgkmcnt(0)
  v_readfirstlane_b32 s12, v91
  s_nop 0
  s_cmp_ge_u32 s12, 16
  s_cbranch_scc1 gated_mix__grouped_kv_mqa__geglu_ffn__prompt_kernel_sp_20_d
  s_sub_u32 s28, s28, 1
  s_cbranch_scc0 gated_mix__grouped_kv_mqa__geglu_ffn__prompt_kernel_sp_20
gated_mix__grouped_kv_mqa__geglu_ffn__prompt_kernel_sp_20_d:
gated_mix__grouped_kv_mqa__geglu_ffn__prompt_kernel_ck_19:
  v_mfma_f32_32x32x16_bf16 v[128:143], v[64:67], v[48:51], v[128:143]
  ds_read_b64_tr_b16 v[72:73], v244 offset:0
  ds_read_b64_tr_b16 v[74:75], v244 offset:512
  ds_read_b64_tr_b16 v[76:77], v244 offset:1024
  v_mfma_f32_32x32x16_bf16 v[192:207], v[68:71], v[48:51], v[192:207]
  ds_read_b64_tr_b16 v[78:79], v244 offset:1536
  ds_read_b128 v[24:27], v242 offset:0
  ds_read_b128 v[28:31], v242 offset:4096
  v_mfma_f32_32x32x16_bf16 v[144:159], v[64:67], v[52:55], v[144:159]
  ds_read_b128 v[32:35], v242 offset:8192
  ds_read_b128 v[36:39], v242 offset:12288
  v_mfma_f32_32x32x16_bf16 v[208:223], v[68:71], v[52:55], v[208:223]
  s_waitcnt lgkmcnt(3)
  v_mfma_f32_32x32x16_bf16 v[96:111], v[72:75], v[24:27], v[96:111]
  ds_read_b64_tr_b16 v[80:81], v244 offset:4096
  ds_read_b64_tr_b16 v[82:83], v244 offset:4608
  v_mfma_f32_32x32x16_bf16 v[160:175], v[76:79], v[24:27], v[160:175]
  ds_read_b64_tr_b16 v[84:85], v244 offset:5120
  ds_read_b64_tr_b16 v[86:87], v244 offset:5632
  s_add_u32 m0, s99, 16384
  s_add_u32 s15, s91, 552960
  buffer_load_dwordx4 v247, s[40:43], s15 offen lds
  buffer_load_dwordx4 v255, s[44:47], s15 offen offset:1024 lds
  s_waitcnt lgkmcnt(6)
  v_mfma_f32_32x32x16_bf16 v[112:127], v[72:75], v[28:31], v[112:127]
  ds_read_b128 v[40:43], v243 offset:0
  ds_read_b128 v[44:47], v243 offset:4096
  v_mfma_f32_32x32x16_bf16 v[176:191], v[76:79], v[28:31], v[176:191]
  ds_read_b128 v[48:51], v243 offset:8192
  ds_read_b128 v[52:55], v243 offset:12288
  s_waitcnt lgkmcnt(9)
  v_mfma_f32_32x32x16_bf16 v[128:143], v[72:75], v[32:35], v[128:143]
  v_mfma_f32_32x32x16_bf16 v[192:207], v[76:79], v[32:35], v[192:207]
  s_waitcnt lgkmcnt(8)
  v_mfma_f32_32x32x16_bf16 v[144:159], v[72:75], v[36:39], v[144:159]
  v_mfma_f32_32x32x16_bf16 v[208:223], v[76:79], v[36:39], v[208:223]
  s_waitcnt lgkmcnt(0)
  v_mfma_f32_32x32x16_bf16 v[96:111], v[80:83], v[40:43], v[96:111]
  s_waitcnt vmcnt(7)
  s_mov_b64 exec, 1
  ds_add_u32 v92, v90 offset:40
  s_mov_b64 exec, -1
  ds_read_b32 v91, v92 offset:40
  v_mfma_f32_32x32x16_bf16 v[160:175], v[84:87], v[40:43], v[160:175]
  v_mfma_f32_32x32x16_bf16 v[112:127], v[80:83], v[44:47], v[112:127]
  v_mfma_f32_32x32x16_bf16 v[176:191], v[84:87], v[44:47], v[176:191]
  s_waitcnt lgkmcnt(0)
  v_readfirstlane_b32 s12, v91
  s_nop 0
  s_cmp_ge_u32 s12, 20
  s_cbranch_scc1 gated_mix__grouped_kv_mqa__geglu_ffn__prompt_kernel_ck_21
gated_mix__grouped_kv_mqa__geglu_ffn__prompt_kernel_sp_22:
  ds_read_b32 v91, v92 offset:40
  s_waitcnt lgkmcnt(0)
  v_readfirstlane_b32 s12, v91
  s_nop 0
  s_cmp_ge_u32 s12, 20
  s_cbranch_scc1 gated_mix__grouped_kv_mqa__geglu_ffn__prompt_kernel_sp_22_d
  s_sub_u32 s28, s28, 1
  s_cbranch_scc0 gated_mix__grouped_kv_mqa__geglu_ffn__prompt_kernel_sp_22
gated_mix__grouped_kv_mqa__geglu_ffn__prompt_kernel_sp_22_d:
gated_mix__grouped_kv_mqa__geglu_ffn__prompt_kernel_ck_21:
  v_mfma_f32_32x32x16_bf16 v[128:143], v[80:83], v[48:51], v[128:143]
  ds_read_b64_tr_b16 v[56:57], v244 offset:8192
  ds_read_b64_tr_b16 v[58:59], v244 offset:8704
  ds_read_b64_tr_b16 v[60:61], v244 offset:9216
  v_mfma_f32_32x32x16_bf16 v[192:207], v[84:87], v[48:51], v[192:207]
  ds_read_b64_tr_b16 v[62:63], v244 offset:9728
  ds_read_b128 v[24:27], v240 offset:32768
  ds_read_b128 v[28:31], v240 offset:36864
  v_mfma_f32_32x32x16_bf16 v[144:159], v[80:83], v[52:55], v[144:159]
  ds_read_b128 v[32:35], v240 offset:40960
  ds_read_b128 v[36:39], v240 offset:45056
  v_mfma_f32_32x32x16_bf16 v[208:223], v[84:87], v[52:55], v[208:223]
  s_waitcnt lgkmcnt(3)
  v_mfma_f32_32x32x16_bf16 v[96:111], v[56:59], v[24:27], v[96:111]
  ds_read_b64_tr_b16 v[64:65], v244 offset:12288
  ds_read_b64_tr_b16 v[66:67], v244 offset:12800
  v_mfma_f32_32x32x16_bf16 v[160:175], v[60:63], v[24:27], v[160:175]
  ds_read_b64_tr_b16 v[68:69], v244 offset:13312
  ds_read_b64_tr_b16 v[70:71], v244 offset:13824
  s_waitcnt lgkmcnt(6)
  v_mfma_f32_32x32x16_bf16 v[112:127], v[56:59], v[28:31], v[112:127]
  ds_read_b128 v[40:43], v241 offset:32768
  ds_read_b128 v[44:47], v241 offset:36864
  v_mfma_f32_32x32x16_bf16 v[176:191], v[60:63], v[28:31], v[176:191]
  ds_read_b128 v[48:51], v241 offset:40960
  ds_read_b128 v[52:55], v241 offset:45056
  s_waitcnt lgkmcnt(9)
  v_mfma_f32_32x32x16_bf16 v[128:143], v[56:59], v[32:35], v[128:143]
  s_add_u32 m0, s99, 0
  s_add_u32 s15, s91, 663552
  buffer_load_dwordx4 v247, s[40:43], s15 offen lds
  buffer_load_dwordx4 v255, s[44:47], s15 offen offset:1024 lds
  v_mfma_f32_32x32x16_bf16 v[192:207], v[60:63], v[32:35], v[192:207]
  s_add_u32 m0, s98, 0
  s_add_u32 s15, s90, 384
  buffer_load_dwordx4 v245, s[36:39], s15 offen offset:0 lds
  buffer_load_dwordx4 v246, s[36:39], s15 offen offset:1024 lds
  buffer_load_dwordx4 v253, s[36:39], s15 offen offset:2048 lds
  buffer_load_dwordx4 v254, s[36:39], s15 offen offset:3072 lds
  s_waitcnt lgkmcnt(8)
  v_mfma_f32_32x32x16_bf16 v[144:159], v[56:59], v[36:39], v[144:159]
  s_add_u32 m0, s98, 4096
  s_add_u32 s15, s90, 41344
  buffer_load_dwordx4 v245, s[36:39], s15 offen offset:0 lds
  buffer_load_dwordx4 v246, s[36:39], s15 offen offset:1024 lds
  buffer_load_dwordx4 v253, s[36:39], s15 offen offset:2048 lds
  buffer_load_dwordx4 v254, s[36:39], s15 offen offset:3072 lds
  v_mfma_f32_32x32x16_bf16 v[208:223], v[60:63], v[36:39], v[208:223]
  s_waitcnt lgkmcnt(0)
  v_mfma_f32_32x32x16_bf16 v[96:111], v[64:67], v[40:43], v[96:111]
  s_waitcnt vmcnt(12)
  s_waitcnt vmcnt(10)
  s_mov_b64 exec, 1
  ds_add_u32 v92, v90 offset:8
  s_mov_b64 exec, -1
  s_mov_b64 exec, 1
  ds_add_u32 v92, v90 offset:40
  s_mov_b64 exec, -1
  ds_read_b32 v91, v92 offset:40
  v_mfma_f32_32x32x16_bf16 v[160:175], v[68:71], v[40:43], v[160:175]
  v_mfma_f32_32x32x16_bf16 v[112:127], v[64:67], v[44:47], v[112:127]
  v_mfma_f32_32x32x16_bf16 v[176:191], v[68:71], v[44:47], v[176:191]
  s_waitcnt lgkmcnt(0)
  v_readfirstlane_b32 s12, v91
  s_nop 0
  s_cmp_ge_u32 s12, 24
  s_cbranch_scc1 gated_mix__grouped_kv_mqa__geglu_ffn__prompt_kernel_ck_23
gated_mix__grouped_kv_mqa__geglu_ffn__prompt_kernel_sp_24:
  ds_read_b32 v91, v92 offset:40
  s_waitcnt lgkmcnt(0)
  v_readfirstlane_b32 s12, v91
  s_nop 0
  s_cmp_ge_u32 s12, 24
  s_cbranch_scc1 gated_mix__grouped_kv_mqa__geglu_ffn__prompt_kernel_sp_24_d
  s_sub_u32 s28, s28, 1
  s_cbranch_scc0 gated_mix__grouped_kv_mqa__geglu_ffn__prompt_kernel_sp_24
gated_mix__grouped_kv_mqa__geglu_ffn__prompt_kernel_sp_24_d:
gated_mix__grouped_kv_mqa__geglu_ffn__prompt_kernel_ck_23:
  v_mfma_f32_32x32x16_bf16 v[128:143], v[64:67], v[48:51], v[128:143]
  ds_read_b64_tr_b16 v[72:73], v244 offset:16384
  ds_read_b64_tr_b16 v[74:75], v244 offset:16896
  ds_read_b64_tr_b16 v[76:77], v244 offset:17408
  v_mfma_f32_32x32x16_bf16 v[192:207], v[68:71], v[48:51], v[192:207]
  ds_read_b64_tr_b16 v[78:79], v244 offset:17920
  ds_read_b128 v[24:27], v242 offset:32768
  ds_read_b128 v[28:31], v242 offset:36864
  v_mfma_f32_32x32x16_bf16 v[144:159], v[64:67], v[52:55], v[144:159]
  ds_read_b128 v[32:35], v242 offset:40960
  ds_read_b128 v[36:39], v242 offset:45056
  v_mfma_f32_32x32x16_bf16 v[208:223], v[68:71], v[52:55], v[208:223]
  s_waitcnt lgkmcnt(3)
  v_mfma_f32_32x32x16_bf16 v[96:111], v[72:75], v[24:27], v[96:111]
  ds_read_b64_tr_b16 v[80:81], v244 offset:20480
  ds_read_b64_tr_b16 v[82:83], v244 offset:20992
  v_mfma_f32_32x32x16_bf16 v[160:175], v[76:79], v[24:27], v[160:175]
  ds_read_b64_tr_b16 v[84:85], v244 offset:21504
  ds_read_b64_tr_b16 v[86:87], v244 offset:22016
  s_waitcnt lgkmcnt(6)
  v_mfma_f32_32x32x16_bf16 v[112:127], v[72:75], v[28:31], v[112:127]
  ds_read_b128 v[40:43], v243 offset:32768
  ds_read_b128 v[44:47], v243 offset:36864
  v_mfma_f32_32x32x16_bf16 v[176:191], v[76:79], v[28:31], v[176:191]
  ds_read_b128 v[48:51], v243 offset:40960
  ds_read_b128 v[52:55], v243 offset:45056
  s_waitcnt lgkmcnt(9)
  v_mfma_f32_32x32x16_bf16 v[128:143], v[72:75], v[32:35], v[128:143]
  s_add_u32 m0, s99, 8192
  s_add_u32 s15, s91, 774144
  buffer_load_dwordx4 v247, s[40:43], s15 offen lds
  buffer_load_dwordx4 v255, s[44:47], s15 offen offset:1024 lds
  v_mfma_f32_32x32x16_bf16 v[192:207], v[76:79], v[32:35], v[192:207]
  s_waitcnt lgkmcnt(8)
  v_mfma_f32_32x32x16_bf16 v[144:159], v[72:75], v[36:39], v[144:159]
  v_mfma_f32_32x32x16_bf16 v[208:223], v[76:79], v[36:39], v[208:223]
  s_waitcnt lgkmcnt(0)
  v_mfma_f32_32x32x16_bf16 v[96:111], v[80:83], v[40:43], v[96:111]
  s_waitcnt vmcnt(2)
  s_mov_b64 exec, 1
  ds_add_u32 v92, v90 offset:40
  s_mov_b64 exec, -1
  ds_read_b32 v91, v92 offset:40
  v_mfma_f32_32x32x16_bf16 v[160:175], v[84:87], v[40:43], v[160:175]
  v_mfma_f32_32x32x16_bf16 v[112:127], v[80:83], v[44:47], v[112:127]
  v_mfma_f32_32x32x16_bf16 v[176:191], v[84:87], v[44:47], v[176:191]
  s_waitcnt lgkmcnt(0)
  v_readfirstlane_b32 s12, v91
  s_nop 0
  s_cmp_ge_u32 s12, 28
  s_cbranch_scc1 gated_mix__grouped_kv_mqa__geglu_ffn__prompt_kernel_ck_25
gated_mix__grouped_kv_mqa__geglu_ffn__prompt_kernel_sp_26:
  ds_read_b32 v91, v92 offset:40
  s_waitcnt lgkmcnt(0)
  v_readfirstlane_b32 s12, v91
  s_nop 0
  s_cmp_ge_u32 s12, 28
  s_cbranch_scc1 gated_mix__grouped_kv_mqa__geglu_ffn__prompt_kernel_sp_26_d
  s_sub_u32 s28, s28, 1
  s_cbranch_scc0 gated_mix__grouped_kv_mqa__geglu_ffn__prompt_kernel_sp_26
gated_mix__grouped_kv_mqa__geglu_ffn__prompt_kernel_sp_26_d:
gated_mix__grouped_kv_mqa__geglu_ffn__prompt_kernel_ck_25:
  v_mfma_f32_32x32x16_bf16 v[128:143], v[80:83], v[48:51], v[128:143]
  ds_read_b64_tr_b16 v[56:57], v244 offset:0
  ds_read_b64_tr_b16 v[58:59], v244 offset:512
  ds_read_b64_tr_b16 v[60:61], v244 offset:1024
  v_mfma_f32_32x32x16_bf16 v[192:207], v[84:87], v[48:51], v[192:207]
  ds_read_b64_tr_b16 v[62:63], v244 offset:1536
  ds_read_b128 v[24:27], v240 offset:0
  ds_read_b128 v[28:31], v240 offset:4096
  v_mfma_f32_32x32x16_bf16 v[144:159], v[80:83], v[52:55], v[144:159]
  ds_read_b128 v[32:35], v240 offset:8192
  ds_read_b128 v[36:39], v240 offset:12288
  v_mfma_f32_32x32x16_bf16 v[208:223], v[84:87], v[52:55], v[208:223]
  s_waitcnt lgkmcnt(3)
  v_mfma_f32_32x32x16_bf16 v[96:111], v[56:59], v[24:27], v[96:111]
  ds_read_b64_tr_b16 v[64:65], v244 offset:4096
  ds_read_b64_tr_b16 v[66:67], v244 offset:4608
  v_mfma_f32_32x32x16_bf16 v[160:175], v[60:63], v[24:27], v[160:175]
  ds_read_b64_tr_b16 v[68:69], v244 offset:5120
  ds_read_b64_tr_b16 v[70:71], v244 offset:5632
  s_waitcnt lgkmcnt(6)
  v_mfma_f32_32x32x16_bf16 v[112:127], v[56:59], v[28:31], v[112:127]
  ds_read_b128 v[40:43], v241 offset:0
  ds_read_b128 v[44:47], v241 offset:4096
  v_mfma_f32_32x32x16_bf16 v[176:191], v[60:63], v[28:31], v[176:191]
  ds_read_b128 v[48:51], v241 offset:8192
  ds_read_b128 v[52:55], v241 offset:12288
  s_waitcnt lgkmcnt(9)
  v_mfma_f32_32x32x16_bf16 v[128:143], v[56:59], v[32:35], v[128:143]
  s_add_u32 m0, s99, 16384
  s_add_u32 s15, s91, 884736
  buffer_load_dwordx4 v247, s[40:43], s15 offen lds
  buffer_load_dwordx4 v255, s[44:47], s15 offen offset:1024 lds
  v_mfma_f32_32x32x16_bf16 v[192:207], v[60:63], v[32:35], v[192:207]
  s_add_u32 m0, s98, 32768
  s_add_u32 s15, s90, 512
  buffer_load_dwordx4 v245, s[36:39], s15 offen offset:0 lds
  buffer_load_dwordx4 v246, s[36:39], s15 offen offset:1024 lds
  buffer_load_dwordx4 v253, s[36:39], s15 offen offset:2048 lds
  buffer_load_dwordx4 v254, s[36:39], s15 offen offset:3072 lds
  s_waitcnt lgkmcnt(8)
  v_mfma_f32_32x32x16_bf16 v[144:159], v[56:59], v[36:39], v[144:159]
  s_add_u32 m0, s98, 36864
  s_add_u32 s15, s90, 41472
  buffer_load_dwordx4 v245, s[36:39], s15 offen offset:0 lds
  buffer_load_dwordx4 v246, s[36:39], s15 offen offset:1024 lds
  buffer_load_dwordx4 v253, s[36:39], s15 offen offset:2048 lds
  buffer_load_dwordx4 v254, s[36:39], s15 offen offset:3072 lds
  v_mfma_f32_32x32x16_bf16 v[208:223], v[60:63], v[36:39], v[208:223]
  s_waitcnt lgkmcnt(0)
  v_mfma_f32_32x32x16_bf16 v[96:111], v[64:67], v[40:43], v[96:111]
  s_waitcnt vmcnt(10)
  s_mov_b64 exec, 1
  ds_add_u32 v92, v90 offset:40
  s_mov_b64 exec, -1
  ds_read_b32 v91, v92 offset:40
  v_mfma_f32_32x32x16_bf16 v[160:175], v[68:71], v[40:43], v[160:175]
  v_mfma_f32_32x32x16_bf16 v[112:127], v[64:67], v[44:47], v[112:127]
  v_mfma_f32_32x32x16_bf16 v[176:191], v[68:71], v[44:47], v[176:191]
  s_waitcnt lgkmcnt(0)
  v_readfirstlane_b32 s12, v91
  s_nop 0
  s_cmp_ge_u32 s12, 32
  s_cbranch_scc1 gated_mix__grouped_kv_mqa__geglu_ffn__prompt_kernel_ck_27
gated_mix__grouped_kv_mqa__geglu_ffn__prompt_kernel_sp_28:
  ds_read_b32 v91, v92 offset:40
  s_waitcnt lgkmcnt(0)
  v_readfirstlane_b32 s12, v91
  s_nop 0
  s_cmp_ge_u32 s12, 32
  s_cbranch_scc1 gated_mix__grouped_kv_mqa__geglu_ffn__prompt_kernel_sp_28_d
  s_sub_u32 s28, s28, 1
  s_cbranch_scc0 gated_mix__grouped_kv_mqa__geglu_ffn__prompt_kernel_sp_28
gated_mix__grouped_kv_mqa__geglu_ffn__prompt_kernel_sp_28_d:
gated_mix__grouped_kv_mqa__geglu_ffn__prompt_kernel_ck_27:
  v_mfma_f32_32x32x16_bf16 v[128:143], v[64:67], v[48:51], v[128:143]
  ds_read_b64_tr_b16 v[72:73], v244 offset:8192
  ds_read_b64_tr_b16 v[74:75], v244 offset:8704
  ds_read_b64_tr_b16 v[76:77], v244 offset:9216
  v_mfma_f32_32x32x16_bf16 v[192:207], v[68:71], v[48:51], v[192:207]
  ds_read_b64_tr_b16 v[78:79], v244 offset:9728
  ds_read_b128 v[24:27], v242 offset:0
  ds_read_b128 v[28:31], v242 offset:4096
  v_mfma_f32_32x32x16_bf16 v[144:159], v[64:67], v[52:55], v[144:159]
  ds_read_b128 v[32:35], v242 offset:8192
  ds_read_b128 v[36:39], v242 offset:12288
  v_mfma_f32_32x32x16_bf16 v[208:223], v[68:71], v[52:55], v[208:223]
  s_waitcnt lgkmcnt(3)
  v_mfma_f32_32x32x16_bf16 v[96:111], v[72:75], v[24:27], v[96:111]
  ds_read_b64_tr_b16 v[80:81], v244 offset:12288
  ds_read_b64_tr_b16 v[82:83], v244 offset:12800
  v_mfma_f32_32x32x16_bf16 v[160:175], v[76:79], v[24:27], v[160:175]
  ds_read_b64_tr_b16 v[84:85], v244 offset:13312
  ds_read_b64_tr_b16 v[86:87], v244 offset:13824
  s_waitcnt lgkmcnt(6)
  v_mfma_f32_32x32x16_bf16 v[112:127], v[72:75], v[28:31], v[112:127]
  ds_read_b128 v[40:43], v243 offset:0
  ds_read_b128 v[44:47], v243 offset:4096
  v_mfma_f32_32x32x16_bf16 v[176:191], v[76:79], v[28:31], v[176:191]
  ds_read_b128 v[48:51], v243 offset:8192
  ds_read_b128 v[52:55], v243 offset:12288
  s_waitcnt lgkmcnt(9)
  v_mfma_f32_32x32x16_bf16 v[128:143], v[72:75], v[32:35], v[128:143]
  s_add_u32 m0, s99, 0
  s_add_u32 s15, s91, 995328
  buffer_load_dwordx4 v247, s[40:43], s15 offen lds
  buffer_load_dwordx4 v255, s[44:47], s15 offen offset:1024 lds
  v_mfma_f32_32x32x16_bf16 v[192:207], v[76:79], v[32:35], v[192:207]
  s_waitcnt lgkmcnt(8)
  v_mfma_f32_32x32x16_bf16 v[144:159], v[72:75], v[36:39], v[144:159]
  v_mfma_f32_32x32x16_bf16 v[208:223], v[76:79], v[36:39], v[208:223]
  s_waitcnt lgkmcnt(0)
  v_mfma_f32_32x32x16_bf16 v[96:111], v[80:83], v[40:43], v[96:111]
  s_waitcnt vmcnt(2)
  s_mov_b64 exec, 1
  ds_add_u32 v92, v90 offset:40
  s_mov_b64 exec, -1
  ds_read_b32 v91, v92 offset:40
  v_mfma_f32_32x32x16_bf16 v[160:175], v[84:87], v[40:43], v[160:175]
  v_mfma_f32_32x32x16_bf16 v[112:127], v[80:83], v[44:47], v[112:127]
  v_mfma_f32_32x32x16_bf16 v[176:191], v[84:87], v[44:47], v[176:191]
  s_waitcnt lgkmcnt(0)
  v_readfirstlane_b32 s12, v91
  s_nop 0
  s_cmp_ge_u32 s12, 36
  s_cbranch_scc1 gated_mix__grouped_kv_mqa__geglu_ffn__prompt_kernel_ck_29
gated_mix__grouped_kv_mqa__geglu_ffn__prompt_kernel_sp_30:
  ds_read_b32 v91, v92 offset:40
  s_waitcnt lgkmcnt(0)
  v_readfirstlane_b32 s12, v91
  s_nop 0
  s_cmp_ge_u32 s12, 36
  s_cbranch_scc1 gated_mix__grouped_kv_mqa__geglu_ffn__prompt_kernel_sp_30_d
  s_sub_u32 s28, s28, 1
  s_cbranch_scc0 gated_mix__grouped_kv_mqa__geglu_ffn__prompt_kernel_sp_30
gated_mix__grouped_kv_mqa__geglu_ffn__prompt_kernel_sp_30_d:
gated_mix__grouped_kv_mqa__geglu_ffn__prompt_kernel_ck_29:
  v_mfma_f32_32x32x16_bf16 v[128:143], v[80:83], v[48:51], v[128:143]
  ds_read_b64_tr_b16 v[56:57], v244 offset:16384
  ds_read_b64_tr_b16 v[58:59], v244 offset:16896
  ds_read_b64_tr_b16 v[60:61], v244 offset:17408
  v_mfma_f32_32x32x16_bf16 v[192:207], v[84:87], v[48:51], v[192:207]
  ds_read_b64_tr_b16 v[62:63], v244 offset:17920
  ds_read_b128 v[24:27], v240 offset:32768
  ds_read_b128 v[28:31], v240 offset:36864
  v_mfma_f32_32x32x16_bf16 v[144:159], v[80:83], v[52:55], v[144:159]
  ds_read_b128 v[32:35], v240 offset:40960
  ds_read_b128 v[36:39], v240 offset:45056
  v_mfma_f32_32x32x16_bf16 v[208:223], v[84:87], v[52:55], v[208:223]
  s_waitcnt lgkmcnt(3)
  v_mfma_f32_32x32x16_bf16 v[96:111], v[56:59], v[24:27], v[96:111]
  ds_read_b64_tr_b16 v[64:65], v244 offset:20480
  ds_read_b64_tr_b16 v[66:67], v244 offset:20992
  v_mfma_f32_32x32x16_bf16 v[160:175], v[60:63], v[24:27], v[160:175]
  ds_read_b64_tr_b16 v[68:69], v244 offset:21504
  ds_read_b64_tr_b16 v[70:71], v244 offset:22016
  s_waitcnt lgkmcnt(6)
  v_mfma_f32_32x32x16_bf16 v[112:127], v[56:59], v[28:31], v[112:127]
  ds_read_b128 v[40:43], v241 offset:32768
  ds_read_b128 v[44:47], v241 offset:36864
  v_mfma_f32_32x32x16_bf16 v[176:191], v[60:63], v[28:31], v[176:191]
  ds_read_b128 v[48:51], v241 offset:40960
  ds_read_b128 v[52:55], v241 offset:45056
  s_waitcnt lgkmcnt(9)
  v_mfma_f32_32x32x16_bf16 v[128:143], v[56:59], v[32:35], v[128:143]
  s_add_u32 m0, s99, 8192
  s_add_u32 s15, s91, 1105920
  buffer_load_dwordx4 v247, s[40:43], s15 offen lds
  buffer_load_dwordx4 v255, s[44:47], s15 offen offset:1024 lds
  v_mfma_f32_32x32x16_bf16 v[192:207], v[60:63], v[32:35], v[192:207]
  s_add_u32 m0, s98, 0
  s_add_u32 s15, s90, 640
  buffer_load_dwordx4 v245, s[36:39], s15 offen offset:0 lds
  buffer_load_dwordx4 v246, s[36:39], s15 offen offset:1024 lds
  buffer_load_dwordx4 v253, s[36:39], s15 offen offset:2048 lds
  buffer_load_dwordx4 v254, s[36:39], s15 offen offset:3072 lds
  s_waitcnt lgkmcnt(8)
  v_mfma_f32_32x32x16_bf16 v[144:159], v[56:59], v[36:39], v[144:159]
  s_add_u32 m0, s98, 4096
  s_add_u32 s15, s90, 41600
  buffer_load_dwordx4 v245, s[36:39], s15 offen offset:0 lds
  buffer_load_dwordx4 v246, s[36:39], s15 offen offset:1024 lds
  buffer_load_dwordx4 v253, s[36:39], s15 offen offset:2048 lds
  buffer_load_dwordx4 v254, s[36:39], s15 offen offset:3072 lds
  v_mfma_f32_32x32x16_bf16 v[208:223], v[60:63], v[36:39], v[208:223]
  s_waitcnt lgkmcnt(0)
  v_mfma_f32_32x32x16_bf16 v[96:111], v[64:67], v[40:43], v[96:111]
  s_waitcnt vmcnt(10)
  s_mov_b64 exec, 1
  ds_add_u32 v92, v90 offset:40
  s_mov_b64 exec, -1
  ds_read_b32 v91, v92 offset:40
  v_mfma_f32_32x32x16_bf16 v[160:175], v[68:71], v[40:43], v[160:175]
  v_mfma_f32_32x32x16_bf16 v[112:127], v[64:67], v[44:47], v[112:127]
  v_mfma_f32_32x32x16_bf16 v[176:191], v[68:71], v[44:47], v[176:191]
  s_waitcnt lgkmcnt(0)
  v_readfirstlane_b32 s12, v91
  s_nop 0
  s_cmp_ge_u32 s12, 40
  s_cbranch_scc1 gated_mix__grouped_kv_mqa__geglu_ffn__prompt_kernel_ck_31
gated_mix__grouped_kv_mqa__geglu_ffn__prompt_kernel_sp_32:
  ds_read_b32 v91, v92 offset:40
  s_waitcnt lgkmcnt(0)
  v_readfirstlane_b32 s12, v91
  s_nop 0
  s_cmp_ge_u32 s12, 40
  s_cbranch_scc1 gated_mix__grouped_kv_mqa__geglu_ffn__prompt_kernel_sp_32_d
  s_sub_u32 s28, s28, 1
  s_cbranch_scc0 gated_mix__grouped_kv_mqa__geglu_ffn__prompt_kernel_sp_32
gated_mix__grouped_kv_mqa__geglu_ffn__prompt_kernel_sp_32_d:
gated_mix__grouped_kv_mqa__geglu_ffn__prompt_kernel_ck_31:
  v_mfma_f32_32x32x16_bf16 v[128:143], v[64:67], v[48:51], v[128:143]
  ds_read_b64_tr_b16 v[72:73], v244 offset:0
  ds_read_b64_tr_b16 v[74:75], v244 offset:512
  ds_read_b64_tr_b16 v[76:77], v244 offset:1024
  v_mfma_f32_32x32x16_bf16 v[192:207], v[68:71], v[48:51], v[192:207]
  ds_read_b64_tr_b16 v[78:79], v244 offset:1536
  ds_read_b128 v[24:27], v242 offset:32768
  ds_read_b128 v[28:31], v242 offset:36864
  v_mfma_f32_32x32x16_bf16 v[144:159], v[64:67], v[52:55], v[144:159]
  ds_read_b128 v[32:35], v242 offset:40960
  ds_read_b128 v[36:39], v242 offset:45056
  v_mfma_f32_32x32x16_bf16 v[208:223], v[68:71], v[52:55], v[208:223]
  s_waitcnt lgkmcnt(3)
  v_mfma_f32_32x32x16_bf16 v[96:111], v[72:75], v[24:27], v[96:111]
  ds_read_b64_tr_b16 v[80:81], v244 offset:4096
  ds_read_b64_tr_b16 v[82:83], v244 offset:4608
  v_mfma_f32_32x32x16_bf16 v[160:175], v[76:79], v[24:27], v[160:175]
  ds_read_b64_tr_b16 v[84:85], v244 offset:5120
  ds_read_b64_tr_b16 v[86:87], v244 offset:5632
  s_waitcnt lgkmcnt(6)
  v_mfma_f32_32x32x16_bf16 v[112:127], v[72:75], v[28:31], v[112:127]
  ds_read_b128 v[40:43], v243 offset:32768
  ds_read_b128 v[44:47], v243 offset:36864
  v_mfma_f32_32x32x16_bf16 v[176:191], v[76:79], v[28:31], v[176:191]
  ds_read_b128 v[48:51], v243 offset:40960
  ds_read_b128 v[52:55], v243 offset:45056
  s_waitcnt lgkmcnt(9)
  v_mfma_f32_32x32x16_bf16 v[128:143], v[72:75], v[32:35], v[128:143]
  s_add_u32 m0, s99, 16384
  s_add_u32 s15, s91, 1216512
  buffer_load_dwordx4 v247, s[40:43], s15 offen lds
  buffer_load_dwordx4 v255, s[44:47], s15 offen offset:1024 lds
  v_mfma_f32_32x32x16_bf16 v[192:207], v[76:79], v[32:35], v[192:207]
  s_waitcnt lgkmcnt(8)
  v_mfma_f32_32x32x16_bf16 v[144:159], v[72:75], v[36:39], v[144:159]
  v_mfma_f32_32x32x16_bf16 v[208:223], v[76:79], v[36:39], v[208:223]
  s_waitcnt lgkmcnt(0)
  v_mfma_f32_32x32x16_bf16 v[96:111], v[80:83], v[40:43], v[96:111]
  s_waitcnt vmcnt(2)
  s_mov_b64 exec, 1
  ds_add_u32 v92, v90 offset:40
  s_mov_b64 exec, -1
  ds_read_b32 v91, v92 offset:40
  v_mfma_f32_32x32x16_bf16 v[160:175], v[84:87], v[40:43], v[160:175]
  v_mfma_f32_32x32x16_bf16 v[112:127], v[80:83], v[44:47], v[112:127]
  v_mfma_f32_32x32x16_bf16 v[176:191], v[84:87], v[44:47], v[176:191]
  s_waitcnt lgkmcnt(0)
  v_readfirstlane_b32 s12, v91
  s_nop 0
  s_cmp_ge_u32 s12, 44
  s_cbranch_scc1 gated_mix__grouped_kv_mqa__geglu_ffn__prompt_kernel_ck_33
gated_mix__grouped_kv_mqa__geglu_ffn__prompt_kernel_sp_34:
  ds_read_b32 v91, v92 offset:40
  s_waitcnt lgkmcnt(0)
  v_readfirstlane_b32 s12, v91
  s_nop 0
  s_cmp_ge_u32 s12, 44
  s_cbranch_scc1 gated_mix__grouped_kv_mqa__geglu_ffn__prompt_kernel_sp_34_d
  s_sub_u32 s28, s28, 1
  s_cbranch_scc0 gated_mix__grouped_kv_mqa__geglu_ffn__prompt_kernel_sp_34
gated_mix__grouped_kv_mqa__geglu_ffn__prompt_kernel_sp_34_d:
gated_mix__grouped_kv_mqa__geglu_ffn__prompt_kernel_ck_33:
  v_mfma_f32_32x32x16_bf16 v[128:143], v[80:83], v[48:51], v[128:143]
  ds_read_b64_tr_b16 v[56:57], v244 offset:8192
  ds_read_b64_tr_b16 v[58:59], v244 offset:8704
  ds_read_b64_tr_b16 v[60:61], v244 offset:9216
  v_mfma_f32_32x32x16_bf16 v[192:207], v[84:87], v[48:51], v[192:207]
  ds_read_b64_tr_b16 v[62:63], v244 offset:9728
  ds_read_b128 v[24:27], v240 offset:0
  ds_read_b128 v[28:31], v240 offset:4096
  v_mfma_f32_32x32x16_bf16 v[144:159], v[80:83], v[52:55], v[144:159]
  ds_read_b128 v[32:35], v240 offset:8192
  ds_read_b128 v[36:39], v240 offset:12288
  v_mfma_f32_32x32x16_bf16 v[208:223], v[84:87], v[52:55], v[208:223]
  s_waitcnt lgkmcnt(3)
  v_mfma_f32_32x32x16_bf16 v[96:111], v[56:59], v[24:27], v[96:111]
  ds_read_b64_tr_b16 v[64:65], v244 offset:12288
  ds_read_b64_tr_b16 v[66:67], v244 offset:12800
  v_mfma_f32_32x32x16_bf16 v[160:175], v[60:63], v[24:27], v[160:175]
  ds_read_b64_tr_b16 v[68:69], v244 offset:13312
  ds_read_b64_tr_b16 v[70:71], v244 offset:13824
  s_waitcnt lgkmcnt(6)
  v_mfma_f32_32x32x16_bf16 v[112:127], v[56:59], v[28:31], v[112:127]
  ds_read_b128 v[40:43], v241 offset:0
  ds_read_b128 v[44:47], v241 offset:4096
  v_mfma_f32_32x32x16_bf16 v[176:191], v[60:63], v[28:31], v[176:191]
  ds_read_b128 v[48:51], v241 offset:8192
  ds_read_b128 v[52:55], v241 offset:12288
  s_waitcnt lgkmcnt(9)
  v_mfma_f32_32x32x16_bf16 v[128:143], v[56:59], v[32:35], v[128:143]
  s_add_u32 m0, s99, 0
  s_add_u32 s15, s91, 1327104
  buffer_load_dwordx4 v247, s[40:43], s15 offen lds
  buffer_load_dwordx4 v255, s[44:47], s15 offen offset:1024 lds
  v_mfma_f32_32x32x16_bf16 v[192:207], v[60:63], v[32:35], v[192:207]
  s_add_u32 m0, s98, 32768
  s_add_u32 s15, s90, 768
  buffer_load_dwordx4 v245, s[36:39], s15 offen offset:0 lds
  buffer_load_dwordx4 v246, s[36:39], s15 offen offset:1024 lds
  buffer_load_dwordx4 v253, s[36:39], s15 offen offset:2048 lds
  buffer_load_dwordx4 v254, s[36:39], s15 offen offset:3072 lds
  s_waitcnt lgkmcnt(8)
  v_mfma_f32_32x32x16_bf16 v[144:159], v[56:59], v[36:39], v[144:159]
  s_add_u32 m0, s98, 36864
  s_add_u32 s15, s90, 41728
  buffer_load_dwordx4 v245, s[36:39], s15 offen offset:0 lds
  buffer_load_dwordx4 v246, s[36:39], s15 offen offset:1024 lds
  buffer_load_dwordx4 v253, s[36:39], s15 offen offset:2048 lds
  buffer_load_dwordx4 v254, s[36:39], s15 offen offset:3072 lds
  v_mfma_f32_32x32x16_bf16 v[208:223], v[60:63], v[36:39], v[208:223]
  s_waitcnt lgkmcnt(0)
  v_mfma_f32_32x32x16_bf16 v[96:111], v[64:67], v[40:43], v[96:111]
  s_waitcnt vmcnt(10)
  s_mov_b64 exec, 1
  ds_add_u32 v92, v90 offset:40
  s_mov_b64 exec, -1
  ds_read_b32 v91, v92 offset:40
  v_mfma_f32_32x32x16_bf16 v[160:175], v[68:71], v[40:43], v[160:175]
  v_mfma_f32_32x32x16_bf16 v[112:127], v[64:67], v[44:47], v[112:127]
  v_mfma_f32_32x32x16_bf16 v[176:191], v[68:71], v[44:47], v[176:191]
  s_waitcnt lgkmcnt(0)
  v_readfirstlane_b32 s12, v91
  s_nop 0
  s_cmp_ge_u32 s12, 48
  s_cbranch_scc1 gated_mix__grouped_kv_mqa__geglu_ffn__prompt_kernel_ck_35
gated_mix__grouped_kv_mqa__geglu_ffn__prompt_kernel_sp_36:
  ds_read_b32 v91, v92 offset:40
  s_waitcnt lgkmcnt(0)
  v_readfirstlane_b32 s12, v91
  s_nop 0
  s_cmp_ge_u32 s12, 48
  s_cbranch_scc1 gated_mix__grouped_kv_mqa__geglu_ffn__prompt_kernel_sp_36_d
  s_sub_u32 s28, s28, 1
  s_cbranch_scc0 gated_mix__grouped_kv_mqa__geglu_ffn__prompt_kernel_sp_36
gated_mix__grouped_kv_mqa__geglu_ffn__prompt_kernel_sp_36_d:
gated_mix__grouped_kv_mqa__geglu_ffn__prompt_kernel_ck_35:
  v_mfma_f32_32x32x16_bf16 v[128:143], v[64:67], v[48:51], v[128:143]
  ds_read_b64_tr_b16 v[72:73], v244 offset:16384
  ds_read_b64_tr_b16 v[74:75], v244 offset:16896
  ds_read_b64_tr_b16 v[76:77], v244 offset:17408
  v_mfma_f32_32x32x16_bf16 v[192:207], v[68:71], v[48:51], v[192:207]
  ds_read_b64_tr_b16 v[78:79], v244 offset:17920
  ds_read_b128 v[24:27], v242 offset:0
  ds_read_b128 v[28:31], v242 offset:4096
  v_mfma_f32_32x32x16_bf16 v[144:159], v[64:67], v[52:55], v[144:159]
  ds_read_b128 v[32:35], v242 offset:8192
  ds_read_b128 v[36:39], v242 offset:12288
  v_mfma_f32_32x32x16_bf16 v[208:223], v[68:71], v[52:55], v[208:223]
  s_waitcnt lgkmcnt(3)
  v_mfma_f32_32x32x16_bf16 v[96:111], v[72:75], v[24:27], v[96:111]
  ds_read_b64_tr_b16 v[80:81], v244 offset:20480
  ds_read_b64_tr_b16 v[82:83], v244 offset:20992
  v_mfma_f32_32x32x16_bf16 v[160:175], v[76:79], v[24:27], v[160:175]
  ds_read_b64_tr_b16 v[84:85], v244 offset:21504
  ds_read_b64_tr_b16 v[86:87], v244 offset:22016
  s_waitcnt lgkmcnt(6)
  v_mfma_f32_32x32x16_bf16 v[112:127], v[72:75], v[28:31], v[112:127]
  ds_read_b128 v[40:43], v243 offset:0
  ds_read_b128 v[44:47], v243 offset:4096
  v_mfma_f32_32x32x16_bf16 v[176:191], v[76:79], v[28:31], v[176:191]
  ds_read_b128 v[48:51], v243 offset:8192
  ds_read_b128 v[52:55], v243 offset:12288
  s_waitcnt lgkmcnt(9)
  v_mfma_f32_32x32x16_bf16 v[128:143], v[72:75], v[32:35], v[128:143]
  s_add_u32 m0, s99, 8192
  s_add_u32 s15, s91, 1437696
  buffer_load_dwordx4 v247, s[40:43], s15 offen lds
  buffer_load_dwordx4 v255, s[44:47], s15 offen offset:1024 lds
  v_mfma_f32_32x32x16_bf16 v[192:207], v[76:79], v[32:35], v[192:207]
  s_waitcnt lgkmcnt(8)
  v_mfma_f32_32x32x16_bf16 v[144:159], v[72:75], v[36:39], v[144:159]
  v_mfma_f32_32x32x16_bf16 v[208:223], v[76:79], v[36:39], v[208:223]
  s_waitcnt lgkmcnt(0)
  v_mfma_f32_32x32x16_bf16 v[96:111], v[80:83], v[40:43], v[96:111]
  s_waitcnt vmcnt(2)
  s_mov_b64 exec, 1
  ds_add_u32 v92, v90 offset:40
  s_mov_b64 exec, -1
  ds_read_b32 v91, v92 offset:40
  v_mfma_f32_32x32x16_bf16 v[160:175], v[84:87], v[40:43], v[160:175]
  v_mfma_f32_32x32x16_bf16 v[112:127], v[80:83], v[44:47], v[112:127]
  v_mfma_f32_32x32x16_bf16 v[176:191], v[84:87], v[44:47], v[176:191]
  s_waitcnt lgkmcnt(0)
  v_readfirstlane_b32 s12, v91
  s_nop 0
  s_cmp_ge_u32 s12, 52
  s_cbranch_scc1 gated_mix__grouped_kv_mqa__geglu_ffn__prompt_kernel_ck_37
gated_mix__grouped_kv_mqa__geglu_ffn__prompt_kernel_sp_38:
  ds_read_b32 v91, v92 offset:40
  s_waitcnt lgkmcnt(0)
  v_readfirstlane_b32 s12, v91
  s_nop 0
  s_cmp_ge_u32 s12, 52
  s_cbranch_scc1 gated_mix__grouped_kv_mqa__geglu_ffn__prompt_kernel_sp_38_d
  s_sub_u32 s28, s28, 1
  s_cbranch_scc0 gated_mix__grouped_kv_mqa__geglu_ffn__prompt_kernel_sp_38
gated_mix__grouped_kv_mqa__geglu_ffn__prompt_kernel_sp_38_d:
gated_mix__grouped_kv_mqa__geglu_ffn__prompt_kernel_ck_37:
  v_mfma_f32_32x32x16_bf16 v[128:143], v[80:83], v[48:51], v[128:143]
  ds_read_b64_tr_b16 v[56:57], v244 offset:0
  ds_read_b64_tr_b16 v[58:59], v244 offset:512
  ds_read_b64_tr_b16 v[60:61], v244 offset:1024
  v_mfma_f32_32x32x16_bf16 v[192:207], v[84:87], v[48:51], v[192:207]
  ds_read_b64_tr_b16 v[62:63], v244 offset:1536
  ds_read_b128 v[24:27], v240 offset:32768
  ds_read_b128 v[28:31], v240 offset:36864
  v_mfma_f32_32x32x16_bf16 v[144:159], v[80:83], v[52:55], v[144:159]
  ds_read_b128 v[32:35], v240 offset:40960
  ds_read_b128 v[36:39], v240 offset:45056
  v_mfma_f32_32x32x16_bf16 v[208:223], v[84:87], v[52:55], v[208:223]
  s_waitcnt lgkmcnt(3)
  v_mfma_f32_32x32x16_bf16 v[96:111], v[56:59], v[24:27], v[96:111]
  ds_read_b64_tr_b16 v[64:65], v244 offset:4096
  ds_read_b64_tr_b16 v[66:67], v244 offset:4608
  v_mfma_f32_32x32x16_bf16 v[160:175], v[60:63], v[24:27], v[160:175]
  ds_read_b64_tr_b16 v[68:69], v244 offset:5120
  ds_read_b64_tr_b16 v[70:71], v244 offset:5632
  s_waitcnt lgkmcnt(6)
  v_mfma_f32_32x32x16_bf16 v[112:127], v[56:59], v[28:31], v[112:127]
  ds_read_b128 v[40:43], v241 offset:32768
  ds_read_b128 v[44:47], v241 offset:36864
  v_mfma_f32_32x32x16_bf16 v[176:191], v[60:63], v[28:31], v[176:191]
  ds_read_b128 v[48:51], v241 offset:40960
  ds_read_b128 v[52:55], v241 offset:45056
  s_waitcnt lgkmcnt(9)
  v_mfma_f32_32x32x16_bf16 v[128:143], v[56:59], v[32:35], v[128:143]
  s_add_u32 m0, s99, 16384
  s_add_u32 s15, s91, 1548288
  buffer_load_dwordx4 v247, s[40:43], s15 offen lds
  buffer_load_dwordx4 v255, s[44:47], s15 offen offset:1024 lds
  v_mfma_f32_32x32x16_bf16 v[192:207], v[60:63], v[32:35], v[192:207]
  s_add_u32 m0, s98, 0
  s_add_u32 s15, s90, 896
  buffer_load_dwordx4 v245, s[36:39], s15 offen offset:0 lds
  buffer_load_dwordx4 v246, s[36:39], s15 offen offset:1024 lds
  buffer_load_dwordx4 v253, s[36:39], s15 offen offset:2048 lds
  buffer_load_dwordx4 v254, s[36:39], s15 offen offset:3072 lds
  s_waitcnt lgkmcnt(8)
  v_mfma_f32_32x32x16_bf16 v[144:159], v[56:59], v[36:39], v[144:159]
  s_add_u32 m0, s98, 4096
  s_add_u32 s15, s90, 41856
  buffer_load_dwordx4 v245, s[36:39], s15 offen offset:0 lds
  buffer_load_dwordx4 v246, s[36:39], s15 offen offset:1024 lds
  buffer_load_dwordx4 v253, s[36:39], s15 offen offset:2048 lds
  buffer_load_dwordx4 v254, s[36:39], s15 offen offset:3072 lds
  v_mfma_f32_32x32x16_bf16 v[208:223], v[60:63], v[36:39], v[208:223]
  s_waitcnt lgkmcnt(0)
  v_mfma_f32_32x32x16_bf16 v[96:111], v[64:67], v[40:43], v[96:111]
  s_waitcnt vmcnt(10)
  s_mov_b64 exec, 1
  ds_add_u32 v92, v90 offset:40
  s_mov_b64 exec, -1
  ds_read_b32 v91, v92 offset:40
  v_mfma_f32_32x32x16_bf16 v[160:175], v[68:71], v[40:43], v[160:175]
  v_mfma_f32_32x32x16_bf16 v[112:127], v[64:67], v[44:47], v[112:127]
  v_mfma_f32_32x32x16_bf16 v[176:191], v[68:71], v[44:47], v[176:191]
  s_waitcnt lgkmcnt(0)
  v_readfirstlane_b32 s12, v91
  s_nop 0
  s_cmp_ge_u32 s12, 56
  s_cbranch_scc1 gated_mix__grouped_kv_mqa__geglu_ffn__prompt_kernel_ck_39
gated_mix__grouped_kv_mqa__geglu_ffn__prompt_kernel_sp_40:
  ds_read_b32 v91, v92 offset:40
  s_waitcnt lgkmcnt(0)
  v_readfirstlane_b32 s12, v91
  s_nop 0
  s_cmp_ge_u32 s12, 56
  s_cbranch_scc1 gated_mix__grouped_kv_mqa__geglu_ffn__prompt_kernel_sp_40_d
  s_sub_u32 s28, s28, 1
  s_cbranch_scc0 gated_mix__grouped_kv_mqa__geglu_ffn__prompt_kernel_sp_40
gated_mix__grouped_kv_mqa__geglu_ffn__prompt_kernel_sp_40_d:
gated_mix__grouped_kv_mqa__geglu_ffn__prompt_kernel_ck_39:
  v_mfma_f32_32x32x16_bf16 v[128:143], v[64:67], v[48:51], v[128:143]
  ds_read_b64_tr_b16 v[72:73], v244 offset:8192
  ds_read_b64_tr_b16 v[74:75], v244 offset:8704
  ds_read_b64_tr_b16 v[76:77], v244 offset:9216
  v_mfma_f32_32x32x16_bf16 v[192:207], v[68:71], v[48:51], v[192:207]
  ds_read_b64_tr_b16 v[78:79], v244 offset:9728
  ds_read_b128 v[24:27], v242 offset:32768
  ds_read_b128 v[28:31], v242 offset:36864
  v_mfma_f32_32x32x16_bf16 v[144:159], v[64:67], v[52:55], v[144:159]
  ds_read_b128 v[32:35], v242 offset:40960
  ds_read_b128 v[36:39], v242 offset:45056
  v_mfma_f32_32x32x16_bf16 v[208:223], v[68:71], v[52:55], v[208:223]
  s_waitcnt lgkmcnt(3)
  v_mfma_f32_32x32x16_bf16 v[96:111], v[72:75], v[24:27], v[96:111]
  ds_read_b64_tr_b16 v[80:81], v244 offset:12288
  ds_read_b64_tr_b16 v[82:83], v244 offset:12800
  v_mfma_f32_32x32x16_bf16 v[160:175], v[76:79], v[24:27], v[160:175]
  ds_read_b64_tr_b16 v[84:85], v244 offset:13312
  ds_read_b64_tr_b16 v[86:87], v244 offset:13824
  s_waitcnt lgkmcnt(6)
  v_mfma_f32_32x32x16_bf16 v[112:127], v[72:75], v[28:31], v[112:127]
  ds_read_b128 v[40:43], v243 offset:32768
  ds_read_b128 v[44:47], v243 offset:36864
  v_mfma_f32_32x32x16_bf16 v[176:191], v[76:79], v[28:31], v[176:191]
  ds_read_b128 v[48:51], v243 offset:40960
  ds_read_b128 v[52:55], v243 offset:45056
  s_waitcnt lgkmcnt(9)
  v_mfma_f32_32x32x16_bf16 v[128:143], v[72:75], v[32:35], v[128:143]
  s_add_u32 m0, s99, 0
  s_add_u32 s15, s91, 1658880
  buffer_load_dwordx4 v247, s[40:43], s15 offen lds
  buffer_load_dwordx4 v255, s[44:47], s15 offen offset:1024 lds
  v_mfma_f32_32x32x16_bf16 v[192:207], v[76:79], v[32:35], v[192:207]
  s_waitcnt lgkmcnt(8)
  v_mfma_f32_32x32x16_bf16 v[144:159], v[72:75], v[36:39], v[144:159]
  v_mfma_f32_32x32x16_bf16 v[208:223], v[76:79], v[36:39], v[208:223]
  s_waitcnt lgkmcnt(0)
  v_mfma_f32_32x32x16_bf16 v[96:111], v[80:83], v[40:43], v[96:111]
  s_waitcnt vmcnt(2)
  s_mov_b64 exec, 1
  ds_add_u32 v92, v90 offset:40
  s_mov_b64 exec, -1
  ds_read_b32 v91, v92 offset:40
  v_mfma_f32_32x32x16_bf16 v[160:175], v[84:87], v[40:43], v[160:175]
  v_mfma_f32_32x32x16_bf16 v[112:127], v[80:83], v[44:47], v[112:127]
  v_mfma_f32_32x32x16_bf16 v[176:191], v[84:87], v[44:47], v[176:191]
  s_waitcnt lgkmcnt(0)
  v_readfirstlane_b32 s12, v91
  s_nop 0
  s_cmp_ge_u32 s12, 60
  s_cbranch_scc1 gated_mix__grouped_kv_mqa__geglu_ffn__prompt_kernel_ck_41
gated_mix__grouped_kv_mqa__geglu_ffn__prompt_kernel_sp_42:
  ds_read_b32 v91, v92 offset:40
  s_waitcnt lgkmcnt(0)
  v_readfirstlane_b32 s12, v91
  s_nop 0
  s_cmp_ge_u32 s12, 60
  s_cbranch_scc1 gated_mix__grouped_kv_mqa__geglu_ffn__prompt_kernel_sp_42_d
  s_sub_u32 s28, s28, 1
  s_cbranch_scc0 gated_mix__grouped_kv_mqa__geglu_ffn__prompt_kernel_sp_42
gated_mix__grouped_kv_mqa__geglu_ffn__prompt_kernel_sp_42_d:
gated_mix__grouped_kv_mqa__geglu_ffn__prompt_kernel_ck_41:
  v_mfma_f32_32x32x16_bf16 v[128:143], v[80:83], v[48:51], v[128:143]
  ds_read_b64_tr_b16 v[56:57], v244 offset:16384
  ds_read_b64_tr_b16 v[58:59], v244 offset:16896
  ds_read_b64_tr_b16 v[60:61], v244 offset:17408
  v_mfma_f32_32x32x16_bf16 v[192:207], v[84:87], v[48:51], v[192:207]
  ds_read_b64_tr_b16 v[62:63], v244 offset:17920
  ds_read_b128 v[24:27], v240 offset:0
  ds_read_b128 v[28:31], v240 offset:4096
  v_mfma_f32_32x32x16_bf16 v[144:159], v[80:83], v[52:55], v[144:159]
  ds_read_b128 v[32:35], v240 offset:8192
  ds_read_b128 v[36:39], v240 offset:12288
  v_mfma_f32_32x32x16_bf16 v[208:223], v[84:87], v[52:55], v[208:223]
  s_waitcnt lgkmcnt(3)
  v_mfma_f32_32x32x16_bf16 v[96:111], v[56:59], v[24:27], v[96:111]
  ds_read_b64_tr_b16 v[64:65], v244 offset:20480
  ds_read_b64_tr_b16 v[66:67], v244 offset:20992
  v_mfma_f32_32x32x16_bf16 v[160:175], v[60:63], v[24:27], v[160:175]
  ds_read_b64_tr_b16 v[68:69], v244 offset:21504
  ds_read_b64_tr_b16 v[70:71], v244 offset:22016
  s_waitcnt lgkmcnt(6)
  v_mfma_f32_32x32x16_bf16 v[112:127], v[56:59], v[28:31], v[112:127]
  ds_read_b128 v[40:43], v241 offset:0
  ds_read_b128 v[44:47], v241 offset:4096
  v_mfma_f32_32x32x16_bf16 v[176:191], v[60:63], v[28:31], v[176:191]
  ds_read_b128 v[48:51], v241 offset:8192
  ds_read_b128 v[52:55], v241 offset:12288
  s_waitcnt lgkmcnt(9)
  v_mfma_f32_32x32x16_bf16 v[128:143], v[56:59], v[32:35], v[128:143]
  s_add_u32 m0, s99, 8192
  s_add_u32 s15, s91, 1769472
  buffer_load_dwordx4 v247, s[40:43], s15 offen lds
  buffer_load_dwordx4 v255, s[44:47], s15 offen offset:1024 lds
  v_mfma_f32_32x32x16_bf16 v[192:207], v[60:63], v[32:35], v[192:207]
  s_add_u32 m0, s98, 32768
  s_add_u32 s15, s90, 1024
  buffer_load_dwordx4 v245, s[36:39], s15 offen offset:0 lds
  buffer_load_dwordx4 v246, s[36:39], s15 offen offset:1024 lds
  buffer_load_dwordx4 v253, s[36:39], s15 offen offset:2048 lds
  buffer_load_dwordx4 v254, s[36:39], s15 offen offset:3072 lds
  s_waitcnt lgkmcnt(8)
  v_mfma_f32_32x32x16_bf16 v[144:159], v[56:59], v[36:39], v[144:159]
  s_add_u32 m0, s98, 36864
  s_add_u32 s15, s90, 41984
  buffer_load_dwordx4 v245, s[36:39], s15 offen offset:0 lds
  buffer_load_dwordx4 v246, s[36:39], s15 offen offset:1024 lds
  buffer_load_dwordx4 v253, s[36:39], s15 offen offset:2048 lds
  buffer_load_dwordx4 v254, s[36:39], s15 offen offset:3072 lds
  v_mfma_f32_32x32x16_bf16 v[208:223], v[60:63], v[36:39], v[208:223]
  s_waitcnt lgkmcnt(0)
  v_mfma_f32_32x32x16_bf16 v[96:111], v[64:67], v[40:43], v[96:111]
  s_waitcnt vmcnt(10)
  s_mov_b64 exec, 1
  ds_add_u32 v92, v90 offset:40
  s_mov_b64 exec, -1
  ds_read_b32 v91, v92 offset:40
  v_mfma_f32_32x32x16_bf16 v[160:175], v[68:71], v[40:43], v[160:175]
  v_mfma_f32_32x32x16_bf16 v[112:127], v[64:67], v[44:47], v[112:127]
  v_mfma_f32_32x32x16_bf16 v[176:191], v[68:71], v[44:47], v[176:191]
  s_waitcnt lgkmcnt(0)
  v_readfirstlane_b32 s12, v91
  s_nop 0
  s_cmp_ge_u32 s12, 64
  s_cbranch_scc1 gated_mix__grouped_kv_mqa__geglu_ffn__prompt_kernel_ck_43
gated_mix__grouped_kv_mqa__geglu_ffn__prompt_kernel_sp_44:
  ds_read_b32 v91, v92 offset:40
  s_waitcnt lgkmcnt(0)
  v_readfirstlane_b32 s12, v91
  s_nop 0
  s_cmp_ge_u32 s12, 64
  s_cbranch_scc1 gated_mix__grouped_kv_mqa__geglu_ffn__prompt_kernel_sp_44_d
  s_sub_u32 s28, s28, 1
  s_cbranch_scc0 gated_mix__grouped_kv_mqa__geglu_ffn__prompt_kernel_sp_44
gated_mix__grouped_kv_mqa__geglu_ffn__prompt_kernel_sp_44_d:
gated_mix__grouped_kv_mqa__geglu_ffn__prompt_kernel_ck_43:
  v_mfma_f32_32x32x16_bf16 v[128:143], v[64:67], v[48:51], v[128:143]
  ds_read_b64_tr_b16 v[72:73], v244 offset:0
  ds_read_b64_tr_b16 v[74:75], v244 offset:512
  ds_read_b64_tr_b16 v[76:77], v244 offset:1024
  v_mfma_f32_32x32x16_bf16 v[192:207], v[68:71], v[48:51], v[192:207]
  ds_read_b64_tr_b16 v[78:79], v244 offset:1536
  ds_read_b128 v[24:27], v242 offset:0
  ds_read_b128 v[28:31], v242 offset:4096
  v_mfma_f32_32x32x16_bf16 v[144:159], v[64:67], v[52:55], v[144:159]
  ds_read_b128 v[32:35], v242 offset:8192
  ds_read_b128 v[36:39], v242 offset:12288
  v_mfma_f32_32x32x16_bf16 v[208:223], v[68:71], v[52:55], v[208:223]
  s_waitcnt lgkmcnt(3)
  v_mfma_f32_32x32x16_bf16 v[96:111], v[72:75], v[24:27], v[96:111]
  ds_read_b64_tr_b16 v[80:81], v244 offset:4096
  ds_read_b64_tr_b16 v[82:83], v244 offset:4608
  v_mfma_f32_32x32x16_bf16 v[160:175], v[76:79], v[24:27], v[160:175]
  ds_read_b64_tr_b16 v[84:85], v244 offset:5120
  ds_read_b64_tr_b16 v[86:87], v244 offset:5632
  s_waitcnt lgkmcnt(6)
  v_mfma_f32_32x32x16_bf16 v[112:127], v[72:75], v[28:31], v[112:127]
  ds_read_b128 v[40:43], v243 offset:0
  ds_read_b128 v[44:47], v243 offset:4096
  v_mfma_f32_32x32x16_bf16 v[176:191], v[76:79], v[28:31], v[176:191]
  ds_read_b128 v[48:51], v243 offset:8192
  ds_read_b128 v[52:55], v243 offset:12288
  s_waitcnt lgkmcnt(9)
  v_mfma_f32_32x32x16_bf16 v[128:143], v[72:75], v[32:35], v[128:143]
  s_add_u32 m0, s99, 16384
  s_add_u32 s15, s91, 1880064
  buffer_load_dwordx4 v247, s[40:43], s15 offen lds
  buffer_load_dwordx4 v255, s[44:47], s15 offen offset:1024 lds
  v_mfma_f32_32x32x16_bf16 v[192:207], v[76:79], v[32:35], v[192:207]
  s_waitcnt lgkmcnt(8)
  v_mfma_f32_32x32x16_bf16 v[144:159], v[72:75], v[36:39], v[144:159]
  v_mfma_f32_32x32x16_bf16 v[208:223], v[76:79], v[36:39], v[208:223]
  s_waitcnt lgkmcnt(0)
  v_mfma_f32_32x32x16_bf16 v[96:111], v[80:83], v[40:43], v[96:111]
  s_waitcnt vmcnt(2)
  s_mov_b64 exec, 1
  ds_add_u32 v92, v90 offset:40
  s_mov_b64 exec, -1
  ds_read_b32 v91, v92 offset:40
  v_mfma_f32_32x32x16_bf16 v[160:175], v[84:87], v[40:43], v[160:175]
  v_mfma_f32_32x32x16_bf16 v[112:127], v[80:83], v[44:47], v[112:127]
  v_mfma_f32_32x32x16_bf16 v[176:191], v[84:87], v[44:47], v[176:191]
  s_waitcnt lgkmcnt(0)
  v_readfirstlane_b32 s12, v91
  s_nop 0
  s_cmp_ge_u32 s12, 68
  s_cbranch_scc1 gated_mix__grouped_kv_mqa__geglu_ffn__prompt_kernel_ck_45
gated_mix__grouped_kv_mqa__geglu_ffn__prompt_kernel_sp_46:
  ds_read_b32 v91, v92 offset:40
  s_waitcnt lgkmcnt(0)
  v_readfirstlane_b32 s12, v91
  s_nop 0
  s_cmp_ge_u32 s12, 68
  s_cbranch_scc1 gated_mix__grouped_kv_mqa__geglu_ffn__prompt_kernel_sp_46_d
  s_sub_u32 s28, s28, 1
  s_cbranch_scc0 gated_mix__grouped_kv_mqa__geglu_ffn__prompt_kernel_sp_46
gated_mix__grouped_kv_mqa__geglu_ffn__prompt_kernel_sp_46_d:
gated_mix__grouped_kv_mqa__geglu_ffn__prompt_kernel_ck_45:
  v_mfma_f32_32x32x16_bf16 v[128:143], v[80:83], v[48:51], v[128:143]
  ds_read_b64_tr_b16 v[56:57], v244 offset:8192
  ds_read_b64_tr_b16 v[58:59], v244 offset:8704
  ds_read_b64_tr_b16 v[60:61], v244 offset:9216
  v_mfma_f32_32x32x16_bf16 v[192:207], v[84:87], v[48:51], v[192:207]
  ds_read_b64_tr_b16 v[62:63], v244 offset:9728
  ds_read_b128 v[24:27], v240 offset:32768
  ds_read_b128 v[28:31], v240 offset:36864
  v_mfma_f32_32x32x16_bf16 v[144:159], v[80:83], v[52:55], v[144:159]
  ds_read_b128 v[32:35], v240 offset:40960
  ds_read_b128 v[36:39], v240 offset:45056
  v_mfma_f32_32x32x16_bf16 v[208:223], v[84:87], v[52:55], v[208:223]
  s_waitcnt lgkmcnt(3)
  v_mfma_f32_32x32x16_bf16 v[96:111], v[56:59], v[24:27], v[96:111]
  ds_read_b64_tr_b16 v[64:65], v244 offset:12288
  ds_read_b64_tr_b16 v[66:67], v244 offset:12800
  v_mfma_f32_32x32x16_bf16 v[160:175], v[60:63], v[24:27], v[160:175]
  ds_read_b64_tr_b16 v[68:69], v244 offset:13312
  ds_read_b64_tr_b16 v[70:71], v244 offset:13824
  s_waitcnt lgkmcnt(6)
  v_mfma_f32_32x32x16_bf16 v[112:127], v[56:59], v[28:31], v[112:127]
  ds_read_b128 v[40:43], v241 offset:32768
  ds_read_b128 v[44:47], v241 offset:36864
  v_mfma_f32_32x32x16_bf16 v[176:191], v[60:63], v[28:31], v[176:191]
  ds_read_b128 v[48:51], v241 offset:40960
  ds_read_b128 v[52:55], v241 offset:45056
  s_waitcnt lgkmcnt(9)
  v_mfma_f32_32x32x16_bf16 v[128:143], v[56:59], v[32:35], v[128:143]
  s_add_u32 m0, s99, 0
  s_add_u32 s15, s91, 1990656
  buffer_load_dwordx4 v247, s[40:43], s15 offen lds
  buffer_load_dwordx4 v255, s[44:47], s15 offen offset:1024 lds
  v_mfma_f32_32x32x16_bf16 v[192:207], v[60:63], v[32:35], v[192:207]
  s_add_u32 m0, s98, 0
  s_add_u32 s15, s90, 1152
  buffer_load_dwordx4 v245, s[36:39], s15 offen offset:0 lds
  buffer_load_dwordx4 v246, s[36:39], s15 offen offset:1024 lds
  buffer_load_dwordx4 v253, s[36:39], s15 offen offset:2048 lds
  buffer_load_dwordx4 v254, s[36:39], s15 offen offset:3072 lds
  s_waitcnt lgkmcnt(8)
  v_mfma_f32_32x32x16_bf16 v[144:159], v[56:59], v[36:39], v[144:159]
  s_add_u32 m0, s98, 4096
  s_add_u32 s15, s90, 42112
  buffer_load_dwordx4 v245, s[36:39], s15 offen offset:0 lds
  buffer_load_dwordx4 v246, s[36:39], s15 offen offset:1024 lds
  buffer_load_dwordx4 v253, s[36:39], s15 offen offset:2048 lds
  buffer_load_dwordx4 v254, s[36:39], s15 offen offset:3072 lds
  v_mfma_f32_32x32x16_bf16 v[208:223], v[60:63], v[36:39], v[208:223]
  s_waitcnt lgkmcnt(0)
  v_mfma_f32_32x32x16_bf16 v[96:111], v[64:67], v[40:43], v[96:111]
  s_waitcnt vmcnt(10)
  s_mov_b64 exec, 1
  ds_add_u32 v92, v90 offset:40
  s_mov_b64 exec, -1
  ds_read_b32 v91, v92 offset:40
  v_mfma_f32_32x32x16_bf16 v[160:175], v[68:71], v[40:43], v[160:175]
  v_mfma_f32_32x32x16_bf16 v[112:127], v[64:67], v[44:47], v[112:127]
  v_mfma_f32_32x32x16_bf16 v[176:191], v[68:71], v[44:47], v[176:191]
  s_waitcnt lgkmcnt(0)
  v_readfirstlane_b32 s12, v91
  s_nop 0
  s_cmp_ge_u32 s12, 72
  s_cbranch_scc1 gated_mix__grouped_kv_mqa__geglu_ffn__prompt_kernel_ck_47
gated_mix__grouped_kv_mqa__geglu_ffn__prompt_kernel_sp_48:
  ds_read_b32 v91, v92 offset:40
  s_waitcnt lgkmcnt(0)
  v_readfirstlane_b32 s12, v91
  s_nop 0
  s_cmp_ge_u32 s12, 72
  s_cbranch_scc1 gated_mix__grouped_kv_mqa__geglu_ffn__prompt_kernel_sp_48_d
  s_sub_u32 s28, s28, 1
  s_cbranch_scc0 gated_mix__grouped_kv_mqa__geglu_ffn__prompt_kernel_sp_48
gated_mix__grouped_kv_mqa__geglu_ffn__prompt_kernel_sp_48_d:
gated_mix__grouped_kv_mqa__geglu_ffn__prompt_kernel_ck_47:
  buffer_load_dword v12, v13, s[8:11], s18 offen sc1
  v_mfma_f32_32x32x16_bf16 v[128:143], v[64:67], v[48:51], v[128:143]
  ds_read_b64_tr_b16 v[72:73], v244 offset:16384
  ds_read_b64_tr_b16 v[74:75], v244 offset:16896
  ds_read_b64_tr_b16 v[76:77], v244 offset:17408
  v_mfma_f32_32x32x16_bf16 v[192:207], v[68:71], v[48:51], v[192:207]
  ds_read_b64_tr_b16 v[78:79], v244 offset:17920
  ds_read_b128 v[24:27], v242 offset:32768
  ds_read_b128 v[28:31], v242 offset:36864
  v_mfma_f32_32x32x16_bf16 v[144:159], v[64:67], v[52:55], v[144:159]
  ds_read_b128 v[32:35], v242 offset:40960
  ds_read_b128 v[36:39], v242 offset:45056
  v_mfma_f32_32x32x16_bf16 v[208:223], v[68:71], v[52:55], v[208:223]
  s_waitcnt lgkmcnt(3)
  v_mfma_f32_32x32x16_bf16 v[96:111], v[72:75], v[24:27], v[96:111]
  ds_read_b64_tr_b16 v[80:81], v244 offset:20480
  ds_read_b64_tr_b16 v[82:83], v244 offset:20992
  v_mfma_f32_32x32x16_bf16 v[160:175], v[76:79], v[24:27], v[160:175]
  ds_read_b64_tr_b16 v[84:85], v244 offset:21504
  ds_read_b64_tr_b16 v[86:87], v244 offset:22016
  s_waitcnt lgkmcnt(6)
  v_mfma_f32_32x32x16_bf16 v[112:127], v[72:75], v[28:31], v[112:127]
  ds_read_b128 v[40:43], v243 offset:32768
  ds_read_b128 v[44:47], v243 offset:36864
  v_mfma_f32_32x32x16_bf16 v[176:191], v[76:79], v[28:31], v[176:191]
  ds_read_b128 v[48:51], v243 offset:40960
  ds_read_b128 v[52:55], v243 offset:45056
  s_waitcnt lgkmcnt(9)
  v_mfma_f32_32x32x16_bf16 v[128:143], v[72:75], v[32:35], v[128:143]
  s_add_u32 m0, s99, 8192
  s_add_u32 s15, s91, 2101248
  buffer_load_dwordx4 v247, s[40:43], s15 offen lds
  buffer_load_dwordx4 v255, s[44:47], s15 offen offset:1024 lds
  v_mfma_f32_32x32x16_bf16 v[192:207], v[76:79], v[32:35], v[192:207]
  s_waitcnt lgkmcnt(8)
  v_mfma_f32_32x32x16_bf16 v[144:159], v[72:75], v[36:39], v[144:159]
  v_mfma_f32_32x32x16_bf16 v[208:223], v[76:79], v[36:39], v[208:223]
  s_waitcnt lgkmcnt(0)
  v_mfma_f32_32x32x16_bf16 v[96:111], v[80:83], v[40:43], v[96:111]
  s_waitcnt vmcnt(3)
  s_mov_b64 exec, 1
  ds_add_u32 v92, v90 offset:40
  s_mov_b64 exec, -1
  ds_read_b32 v91, v92 offset:40
  v_mfma_f32_32x32x16_bf16 v[160:175], v[84:87], v[40:43], v[160:175]
  v_mfma_f32_32x32x16_bf16 v[112:127], v[80:83], v[44:47], v[112:127]
  v_mfma_f32_32x32x16_bf16 v[176:191], v[84:87], v[44:47], v[176:191]
  s_waitcnt lgkmcnt(0)
  v_readfirstlane_b32 s12, v91
  s_nop 0
  s_cmp_ge_u32 s12, 76
  s_cbranch_scc1 gated_mix__grouped_kv_mqa__geglu_ffn__prompt_kernel_ck_49
gated_mix__grouped_kv_mqa__geglu_ffn__prompt_kernel_sp_50:
  ds_read_b32 v91, v92 offset:40
  s_waitcnt lgkmcnt(0)
  v_readfirstlane_b32 s12, v91
  s_nop 0
  s_cmp_ge_u32 s12, 76
  s_cbranch_scc1 gated_mix__grouped_kv_mqa__geglu_ffn__prompt_kernel_sp_50_d
  s_sub_u32 s28, s28, 1
  s_cbranch_scc0 gated_mix__grouped_kv_mqa__geglu_ffn__prompt_kernel_sp_50
gated_mix__grouped_kv_mqa__geglu_ffn__prompt_kernel_sp_50_d:
gated_mix__grouped_kv_mqa__geglu_ffn__prompt_kernel_ck_49:
  v_mfma_f32_32x32x16_bf16 v[128:143], v[80:83], v[48:51], v[128:143]
  ds_read_b64_tr_b16 v[56:57], v244 offset:0
  ds_read_b64_tr_b16 v[58:59], v244 offset:512
  ds_read_b64_tr_b16 v[60:61], v244 offset:1024
  v_mfma_f32_32x32x16_bf16 v[192:207], v[84:87], v[48:51], v[192:207]
  ds_read_b64_tr_b16 v[62:63], v244 offset:1536
  ds_read_b128 v[24:27], v240 offset:0
  ds_read_b128 v[28:31], v240 offset:4096
  v_mfma_f32_32x32x16_bf16 v[144:159], v[80:83], v[52:55], v[144:159]
  ds_read_b128 v[32:35], v240 offset:8192
  ds_read_b128 v[36:39], v240 offset:12288
  v_mfma_f32_32x32x16_bf16 v[208:223], v[84:87], v[52:55], v[208:223]
  s_waitcnt lgkmcnt(3)
  v_mfma_f32_32x32x16_bf16 v[96:111], v[56:59], v[24:27], v[96:111]
  ds_read_b64_tr_b16 v[64:65], v244 offset:4096
  ds_read_b64_tr_b16 v[66:67], v244 offset:4608
  v_mfma_f32_32x32x16_bf16 v[160:175], v[60:63], v[24:27], v[160:175]
  ds_read_b64_tr_b16 v[68:69], v244 offset:5120
  ds_read_b64_tr_b16 v[70:71], v244 offset:5632
  s_waitcnt lgkmcnt(6)
  v_mfma_f32_32x32x16_bf16 v[112:127], v[56:59], v[28:31], v[112:127]
  ds_read_b128 v[40:43], v241 offset:0
  ds_read_b128 v[44:47], v241 offset:4096
  v_mfma_f32_32x32x16_bf16 v[176:191], v[60:63], v[28:31], v[176:191]
  ds_read_b128 v[48:51], v241 offset:8192
  ds_read_b128 v[52:55], v241 offset:12288
  s_waitcnt lgkmcnt(9)
  v_mfma_f32_32x32x16_bf16 v[128:143], v[56:59], v[32:35], v[128:143]
  v_mfma_f32_32x32x16_bf16 v[192:207], v[60:63], v[32:35], v[192:207]
  s_waitcnt lgkmcnt(8)
  v_mfma_f32_32x32x16_bf16 v[144:159], v[56:59], v[36:39], v[144:159]
  v_mfma_f32_32x32x16_bf16 v[208:223], v[60:63], v[36:39], v[208:223]
  s_waitcnt lgkmcnt(0)
  v_mfma_f32_32x32x16_bf16 v[96:111], v[64:67], v[40:43], v[96:111]
  s_waitcnt vmcnt(0)
  s_mov_b64 exec, 1
  ds_add_u32 v92, v90 offset:40
  s_mov_b64 exec, -1
  ds_read_b32 v91, v92 offset:40
  v_mfma_f32_32x32x16_bf16 v[160:175], v[68:71], v[40:43], v[160:175]
  v_mfma_f32_32x32x16_bf16 v[112:127], v[64:67], v[44:47], v[112:127]
  v_mfma_f32_32x32x16_bf16 v[176:191], v[68:71], v[44:47], v[176:191]
  s_waitcnt lgkmcnt(0)
  v_readfirstlane_b32 s12, v91
  s_nop 0
  s_cmp_ge_u32 s12, 80
  s_cbranch_scc1 gated_mix__grouped_kv_mqa__geglu_ffn__prompt_kernel_ck_51
gated_mix__grouped_kv_mqa__geglu_ffn__prompt_kernel_sp_52:
  ds_read_b32 v91, v92 offset:40
  s_waitcnt lgkmcnt(0)
  v_readfirstlane_b32 s12, v91
  s_nop 0
  s_cmp_ge_u32 s12, 80
  s_cbranch_scc1 gated_mix__grouped_kv_mqa__geglu_ffn__prompt_kernel_sp_52_d
  s_sub_u32 s28, s28, 1
  s_cbranch_scc0 gated_mix__grouped_kv_mqa__geglu_ffn__prompt_kernel_sp_52
gated_mix__grouped_kv_mqa__geglu_ffn__prompt_kernel_sp_52_d:
gated_mix__grouped_kv_mqa__geglu_ffn__prompt_kernel_ck_51:
  v_mfma_f32_32x32x16_bf16 v[128:143], v[64:67], v[48:51], v[128:143]
  ds_read_b64_tr_b16 v[72:73], v244 offset:8192
  ds_read_b64_tr_b16 v[74:75], v244 offset:8704
  ds_read_b64_tr_b16 v[76:77], v244 offset:9216
  v_mfma_f32_32x32x16_bf16 v[192:207], v[68:71], v[48:51], v[192:207]
  ds_read_b64_tr_b16 v[78:79], v244 offset:9728
  ds_read_b128 v[24:27], v242 offset:0
  ds_read_b128 v[28:31], v242 offset:4096
  v_mfma_f32_32x32x16_bf16 v[144:159], v[64:67], v[52:55], v[144:159]
  ds_read_b128 v[32:35], v242 offset:8192
  ds_read_b128 v[36:39], v242 offset:12288
  v_mfma_f32_32x32x16_bf16 v[208:223], v[68:71], v[52:55], v[208:223]
  s_waitcnt lgkmcnt(3)
  v_mfma_f32_32x32x16_bf16 v[96:111], v[72:75], v[24:27], v[96:111]
  ds_read_b64_tr_b16 v[80:81], v244 offset:12288
  ds_read_b64_tr_b16 v[82:83], v244 offset:12800
  v_mfma_f32_32x32x16_bf16 v[160:175], v[76:79], v[24:27], v[160:175]
  ds_read_b64_tr_b16 v[84:85], v244 offset:13312
  ds_read_b64_tr_b16 v[86:87], v244 offset:13824
  s_waitcnt lgkmcnt(6)
  v_mfma_f32_32x32x16_bf16 v[112:127], v[72:75], v[28:31], v[112:127]
  ds_read_b128 v[40:43], v243 offset:0
  ds_read_b128 v[44:47], v243 offset:4096
  v_mfma_f32_32x32x16_bf16 v[176:191], v[76:79], v[28:31], v[176:191]
  ds_read_b128 v[48:51], v243 offset:8192
  ds_read_b128 v[52:55], v243 offset:12288
  s_waitcnt lgkmcnt(9)
  v_mfma_f32_32x32x16_bf16 v[128:143], v[72:75], v[32:35], v[128:143]
  v_mfma_f32_32x32x16_bf16 v[192:207], v[76:79], v[32:35], v[192:207]
  s_waitcnt lgkmcnt(8)
  v_mfma_f32_32x32x16_bf16 v[144:159], v[72:75], v[36:39], v[144:159]
  v_mfma_f32_32x32x16_bf16 v[208:223], v[76:79], v[36:39], v[208:223]
  s_waitcnt lgkmcnt(0)
  s_setprio 0
  v_mfma_f32_32x32x16_bf16 v[96:111], v[80:83], v[40:43], v[96:111]
  s_mov_b64 exec, 1
  ds_add_u32 v92, v90 offset:40
  s_mov_b64 exec, -1
  ds_read_b32 v91, v92 offset:40
  v_mfma_f32_32x32x16_bf16 v[160:175], v[84:87], v[40:43], v[160:175]
  v_mfma_f32_32x32x16_bf16 v[112:127], v[80:83], v[44:47], v[112:127]
  v_mfma_f32_32x32x16_bf16 v[176:191], v[84:87], v[44:47], v[176:191]
  s_waitcnt lgkmcnt(0)
  v_readfirstlane_b32 s12, v91
  s_nop 0
  s_cmp_ge_u32 s12, 84
  s_cbranch_scc1 gated_mix__grouped_kv_mqa__geglu_ffn__prompt_kernel_ck_53
gated_mix__grouped_kv_mqa__geglu_ffn__prompt_kernel_sp_54:
  ds_read_b32 v91, v92 offset:40
  s_waitcnt lgkmcnt(0)
  v_readfirstlane_b32 s12, v91
  s_nop 0
  s_cmp_ge_u32 s12, 84
  s_cbranch_scc1 gated_mix__grouped_kv_mqa__geglu_ffn__prompt_kernel_sp_54_d
  s_sub_u32 s28, s28, 1
  s_cbranch_scc0 gated_mix__grouped_kv_mqa__geglu_ffn__prompt_kernel_sp_54
gated_mix__grouped_kv_mqa__geglu_ffn__prompt_kernel_sp_54_d:
gated_mix__grouped_kv_mqa__geglu_ffn__prompt_kernel_ck_53:
  s_add_u32 m0, s20, 69632
  s_add_u32 s14, s21, 69632
  buffer_load_dwordx4 v2, s[24:27], s14 offen sc1 lds
  s_add_u32 m0, s20, 73728
  s_add_u32 s14, s21, 73728
  buffer_load_dwordx4 v2, s[24:27], s14 offen sc1 lds
  s_add_u32 m0, s20, 77824
  s_add_u32 s14, s21, 77824
  buffer_load_dwordx4 v2, s[24:27], s14 offen sc1 lds
  s_add_u32 m0, s20, 81920
  s_add_u32 s14, s21, 81920
  buffer_load_dwordx4 v2, s[24:27], s14 offen sc1 lds
  s_add_u32 m0, s20, 86016
  s_add_u32 s14, s21, 86016
  buffer_load_dwordx4 v2, s[24:27], s14 offen sc1 lds
  s_add_u32 m0, s20, 90112
  s_add_u32 s14, s21, 90112
  buffer_load_dwordx4 v2, s[24:27], s14 offen sc1 lds
  s_add_u32 m0, s20, 94208
  s_add_u32 s14, s21, 94208
  buffer_load_dwordx4 v2, s[24:27], s14 offen sc1 lds
  s_add_u32 m0, s20, 98304
  s_add_u32 s14, s21, 98304
  buffer_load_dwordx4 v2, s[24:27], s14 offen sc1 lds
  v_mfma_f32_32x32x16_bf16 v[128:143], v[80:83], v[48:51], v[128:143]
  v_mfma_f32_32x32x16_bf16 v[192:207], v[84:87], v[48:51], v[192:207]
  v_mfma_f32_32x32x16_bf16 v[144:159], v[80:83], v[52:55], v[144:159]
  v_mfma_f32_32x32x16_bf16 v[208:223], v[84:87], v[52:55], v[208:223]
  s_setprio 2
  v_mov_b32 v248, 0xc0135761
  v_mov_b32 v249, 0xc0135761
  v_mov_b32 v250, 0xbdd2d3e8
  v_mov_b32 v251, 0xbdd2d3e8
  v_mov_b32 v252, 0x3f800000
  v_mov_b32 v253, 0x3f800000
  s_lshl_b32 s12, s88, 3
  s_lshr_b32 s13, s19, 1
  s_lshl_b32 s13, s13, 2
  s_add_u32 s12, s12, s13
  s_mul_i32 s12, s12, 108
  s_lshl_b32 s13, s89, 2
  s_add_u32 s12, s12, s13
  s_and_b32 s13, s19, 1
  s_lshl_b32 s13, s13, 1
  s_add_u32 s12, s12, s13
  s_lshl_b32 s12, s12, 10
  s_add_u32 s15, s12, 0
  v_cmp_ne_u32 vcc, s29, v12
  s_nop 4
  s_cbranch_vccnz gated_mix__grouped_kv_mqa__geglu_ffn__prompt_kernel_npre
  buffer_load_dwordx4 v[20:23], v2, s[8:11], s87 offen offset:0 sc1
  buffer_load_dwordx4 v[24:27], v2, s[8:11], s87 offen offset:1024 sc1
  buffer_load_dwordx4 v[28:31], v2, s[8:11], s87 offen offset:2048 sc1
  buffer_load_dwordx4 v[32:35], v2, s[8:11], s87 offen offset:3072 sc1
  s_add_u32 s12, s87, 4096
  buffer_load_dwordx4 v[36:39], v2, s[8:11], s12 offen sc1
  s_add_u32 s87, s87, 5120
  buffer_load_dwordx4 v[44:47], v2, s[8:11], s87 offen offset:0 sc1
  buffer_load_dwordx4 v[48:51], v2, s[8:11], s87 offen offset:1024 sc1
  buffer_load_dwordx4 v[52:55], v2, s[8:11], s87 offen offset:2048 sc1
  buffer_load_dwordx4 v[56:59], v2, s[8:11], s87 offen offset:3072 sc1
  s_add_u32 s12, s87, 4096
  buffer_load_dwordx4 v[60:63], v2, s[8:11], s12 offen sc1
  s_add_u32 s87, s87, 5120
  buffer_load_dwordx4 v[68:71], v2, s[8:11], s87 offen offset:0 sc1
  buffer_load_dwordx4 v[72:75], v2, s[8:11], s87 offen offset:1024 sc1
  buffer_load_dwordx4 v[76:79], v2, s[8:11], s87 offen offset:2048 sc1
  buffer_load_dwordx4 v[80:83], v2, s[8:11], s87 offen offset:3072 sc1
  s_add_u32 s12, s87, 4096
  buffer_load_dwordx4 v[84:87], v2, s[8:11], s12 offen sc1
  s_add_u32 s87, s87, 5120
  s_mov_b32 s86, 1
gated_mix__grouped_kv_mqa__geglu_ffn__prompt_kernel_npre:
  v_pk_mul_f32 v[224:225], v[96:97], v[96:97]
  v_pk_mul_f32 v[226:227], v[98:99], v[98:99]
  v_pk_mul_f32 v[228:229], v[100:101], v[100:101]
  v_pk_mul_f32 v[230:231], v[102:103], v[102:103]
  v_pk_mul_f32 v[232:233], v[104:105], v[104:105]
  v_pk_mul_f32 v[234:235], v[106:107], v[106:107]
  v_pk_mul_f32 v[236:237], v[108:109], v[108:109]
  v_pk_mul_f32 v[238:239], v[110:111], v[110:111]
  v_pk_fma_f32 v[224:225], v[224:225], v[250:251], v[248:249]
  v_pk_fma_f32 v[226:227], v[226:227], v[250:251], v[248:249]
  v_pk_fma_f32 v[228:229], v[228:229], v[250:251], v[248:249]
  v_pk_fma_f32 v[230:231], v[230:231], v[250:251], v[248:249]
  v_pk_fma_f32 v[232:233], v[232:233], v[250:251], v[248:249]
  v_pk_fma_f32 v[234:235], v[234:235], v[250:251], v[248:249]
  v_pk_fma_f32 v[236:237], v[236:237], v[250:251], v[248:249]
  v_pk_fma_f32 v[238:239], v[238:239], v[250:251], v[248:249]
  v_pk_mul_f32 v[224:225], v[224:225], v[96:97]
  v_pk_mul_f32 v[226:227], v[226:227], v[98:99]
  v_pk_mul_f32 v[228:229], v[228:229], v[100:101]
  v_pk_mul_f32 v[230:231], v[230:231], v[102:103]
  v_pk_mul_f32 v[232:233], v[232:233], v[104:105]
  v_pk_mul_f32 v[234:235], v[234:235], v[106:107]
  v_pk_mul_f32 v[236:237], v[236:237], v[108:109]
  v_pk_mul_f32 v[238:239], v[238:239], v[110:111]
  v_exp_f32 v224, v224
  v_exp_f32 v225, v225
  v_pk_mul_f32 v[160:161], v[160:161], v[96:97]
  v_exp_f32 v226, v226
  v_exp_f32 v227, v227
  v_pk_mul_f32 v[162:163], v[162:163], v[98:99]
  s_add_u32 m0, s20, 102400
  s_add_u32 s14, s21, 102400
  buffer_load_dwordx4 v2, s[24:27], s14 offen sc1 lds
  v_exp_f32 v228, v228
  v_exp_f32 v229, v229
  v_pk_mul_f32 v[164:165], v[164:165], v[100:101]
  v_exp_f32 v230, v230
  v_exp_f32 v231, v231
  v_pk_mul_f32 v[166:167], v[166:167], v[102:103]
  s_add_u32 m0, s20, 106496
  s_add_u32 s14, s21, 106496
  buffer_load_dwordx4 v2, s[24:27], s14 offen sc1 lds
  v_exp_f32 v232, v232
  v_exp_f32 v233, v233
  v_pk_mul_f32 v[168:169], v[168:169], v[104:105]
  v_exp_f32 v234, v234
  v_exp_f32 v235, v235
  v_pk_mul_f32 v[170:171], v[170:171], v[106:107]
  s_add_u32 m0, s20, 110592
  s_add_u32 s14, s21, 110592
  buffer_load_dwordx4 v2, s[24:27], s14 offen sc1 lds
  v_exp_f32 v236, v236
  v_exp_f32 v237, v237
  v_pk_mul_f32 v[172:173], v[172:173], v[108:109]
  v_exp_f32 v238, v238
  v_exp_f32 v239, v239
  v_pk_mul_f32 v[174:175], v[174:175], v[110:111]
  s_add_u32 m0, s20, 114688
  s_add_u32 s14, s21, 114688
  buffer_load_dwordx4 v2, s[24:27], s14 offen sc1 lds
  v_pk_add_f32 v[224:225], v[224:225], v[252:253]
  v_pk_add_f32 v[226:227], v[226:227], v[252:253]
  v_pk_add_f32 v[228:229], v[228:229], v[252:253]
  v_pk_add_f32 v[230:231], v[230:231], v[252:253]
  v_pk_add_f32 v[232:233], v[232:233], v[252:253]
  v_pk_add_f32 v[234:235], v[234:235], v[252:253]
  v_pk_add_f32 v[236:237], v[236:237], v[252:253]
  v_pk_add_f32 v[238:239], v[238:239], v[252:253]
  v_rcp_f32 v224, v224
  v_rcp_f32 v225, v225
  v_rcp_f32 v226, v226
  v_rcp_f32 v227, v227
  s_add_u32 m0, s20, 118784
  s_add_u32 s14, s21, 118784
  buffer_load_dwordx4 v2, s[24:27], s14 offen sc1 lds
  v_rcp_f32 v228, v228
  v_rcp_f32 v229, v229
  v_rcp_f32 v230, v230
  v_rcp_f32 v231, v231
  s_add_u32 m0, s20, 122880
  s_add_u32 s14, s21, 122880
  buffer_load_dwordx4 v2, s[24:27], s14 offen sc1 lds
  v_rcp_f32 v232, v232
  v_rcp_f32 v233, v233
  v_rcp_f32 v234, v234
  v_rcp_f32 v235, v235
  s_add_u32 m0, s20, 126976
  s_add_u32 s14, s21, 126976
  buffer_load_dwordx4 v2, s[24:27], s14 offen sc1 lds
  v_rcp_f32 v236, v236
  v_rcp_f32 v237, v237
  v_rcp_f32 v238, v238
  v_rcp_f32 v239, v239
  s_add_u32 m0, s20, 131072
  s_add_u32 s14, s21, 131072
  buffer_load_dwordx4 v2, s[24:27], s14 offen sc1 lds
  v_pk_mul_f32 v[160:161], v[160:161], v[224:225]
  v_pk_mul_f32 v[162:163], v[162:163], v[226:227]
  v_pk_mul_f32 v[164:165], v[164:165], v[228:229]
  v_pk_mul_f32 v[166:167], v[166:167], v[230:231]
  v_pk_mul_f32 v[168:169], v[168:169], v[232:233]
  v_pk_mul_f32 v[170:171], v[170:171], v[234:235]
  v_pk_mul_f32 v[172:173], v[172:173], v[236:237]
  v_pk_mul_f32 v[174:175], v[174:175], v[238:239]
  v_cvt_pk_bf16_f32 v96, v160, v161
  v_cvt_pk_bf16_f32 v97, v162, v163
  v_cvt_pk_bf16_f32 v98, v164, v165
  v_cvt_pk_bf16_f32 v99, v166, v167
  v_cvt_pk_bf16_f32 v100, v168, v169
  v_cvt_pk_bf16_f32 v101, v170, v171
  v_cvt_pk_bf16_f32 v102, v172, v173
  v_cvt_pk_bf16_f32 v103, v174, v175
  buffer_store_dwordx4 v[96:99], v2, s[8:11], s15 offen offset:0 sc1
  buffer_store_dwordx4 v[100:103], v2, s[8:11], s15 offen offset:1024 sc1
  s_add_u32 s15, s15, 110592
  s_waitcnt vmcnt(10)
  s_mov_b64 exec, 1
  ds_add_u32 v92, v90 offset:12
  s_mov_b64 exec, -1
  v_pk_mul_f32 v[224:225], v[112:113], v[112:113]
  v_pk_mul_f32 v[226:227], v[114:115], v[114:115]
  v_pk_mul_f32 v[228:229], v[116:117], v[116:117]
  v_pk_mul_f32 v[230:231], v[118:119], v[118:119]
  v_pk_mul_f32 v[232:233], v[120:121], v[120:121]
  v_pk_mul_f32 v[234:235], v[122:123], v[122:123]
  v_pk_mul_f32 v[236:237], v[124:125], v[124:125]
  v_pk_mul_f32 v[238:239], v[126:127], v[126:127]
  v_pk_fma_f32 v[224:225], v[224:225], v[250:251], v[248:249]
  v_pk_fma_f32 v[226:227], v[226:227], v[250:251], v[248:249]
  v_pk_fma_f32 v[228:229], v[228:229], v[250:251], v[248:249]
  v_pk_fma_f32 v[230:231], v[230:231], v[250:251], v[248:249]
  v_pk_fma_f32 v[232:233], v[232:233], v[250:251], v[248:249]
  v_pk_fma_f32 v[234:235], v[234:235], v[250:251], v[248:249]
  v_pk_fma_f32 v[236:237], v[236:237], v[250:251], v[248:249]
  v_pk_fma_f32 v[238:239], v[238:239], v[250:251], v[248:249]
  v_pk_mul_f32 v[224:225], v[224:225], v[112:113]
  v_pk_mul_f32 v[226:227], v[226:227], v[114:115]
  v_pk_mul_f32 v[228:229], v[228:229], v[116:117]
  v_pk_mul_f32 v[230:231], v[230:231], v[118:119]
  v_pk_mul_f32 v[232:233], v[232:233], v[120:121]
  v_pk_mul_f32 v[234:235], v[234:235], v[122:123]
  v_pk_mul_f32 v[236:237], v[236:237], v[124:125]
  v_pk_mul_f32 v[238:239], v[238:239], v[126:127]
  v_exp_f32 v224, v224
  v_exp_f32 v225, v225
  v_pk_mul_f32 v[176:177], v[176:177], v[112:113]
  v_exp_f32 v226, v226
  v_exp_f32 v227, v227
  v_pk_mul_f32 v[178:179], v[178:179], v[114:115]
  s_add_u32 m0, s20, 135168
  s_add_u32 s14, s21, 135168
  buffer_load_dwordx4 v2, s[24:27], s14 offen sc1 lds
  v_exp_f32 v228, v228
  v_exp_f32 v229, v229
  v_pk_mul_f32 v[180:181], v[180:181], v[116:117]
  v_exp_f32 v230, v230
  v_exp_f32 v231, v231
  v_pk_mul_f32 v[182:183], v[182:183], v[118:119]
  s_add_u32 m0, s20, 139264
  s_add_u32 s14, s21, 139264
  buffer_load_dwordx4 v2, s[24:27], s14 offen sc1 lds
  v_exp_f32 v232, v232
  v_exp_f32 v233, v233
  v_pk_mul_f32 v[184:185], v[184:185], v[120:121]
  v_exp_f32 v234, v234
  v_exp_f32 v235, v235
  v_pk_mul_f32 v[186:187], v[186:187], v[122:123]
  s_add_u32 m0, s20, 143360
  s_add_u32 s14, s21, 143360
  buffer_load_dwordx4 v2, s[24:27], s14 offen sc1 lds
  v_exp_f32 v236, v236
  v_exp_f32 v237, v237
  v_pk_mul_f32 v[188:189], v[188:189], v[124:125]
  v_exp_f32 v238, v238
  v_exp_f32 v239, v239
  v_pk_mul_f32 v[190:191], v[190:191], v[126:127]
  s_add_u32 m0, s20, 147456
  s_add_u32 s14, s21, 147456
  buffer_load_dwordx4 v2, s[24:27], s14 offen sc1 lds
  v_pk_add_f32 v[224:225], v[224:225], v[252:253]
  v_pk_add_f32 v[226:227], v[226:227], v[252:253]
  v_pk_add_f32 v[228:229], v[228:229], v[252:253]
  v_pk_add_f32 v[230:231], v[230:231], v[252:253]
  v_pk_add_f32 v[232:233], v[232:233], v[252:253]
  v_pk_add_f32 v[234:235], v[234:235], v[252:253]
  v_pk_add_f32 v[236:237], v[236:237], v[252:253]
  v_pk_add_f32 v[238:239], v[238:239], v[252:253]
  v_rcp_f32 v224, v224
  v_rcp_f32 v225, v225
  v_rcp_f32 v226, v226
  v_rcp_f32 v227, v227
  s_add_u32 m0, s20, 151552
  s_add_u32 s14, s21, 151552
  buffer_load_dwordx4 v2, s[24:27], s14 offen sc1 lds
  v_rcp_f32 v228, v228
  v_rcp_f32 v229, v229
  v_rcp_f32 v230, v230
  v_rcp_f32 v231, v231
  s_add_u32 m0, s20, 155648
  s_add_u32 s14, s21, 155648
  buffer_load_dwordx4 v2, s[24:27], s14 offen sc1 lds
  v_rcp_f32 v232, v232
  v_rcp_f32 v233, v233
  v_rcp_f32 v234, v234
  v_rcp_f32 v235, v235
  v_rcp_f32 v236, v236
  v_rcp_f32 v237, v237
  v_rcp_f32 v238, v238
  v_rcp_f32 v239, v239
  v_pk_mul_f32 v[176:177], v[176:177], v[224:225]
  v_pk_mul_f32 v[178:179], v[178:179], v[226:227]
  v_pk_mul_f32 v[180:181], v[180:181], v[228:229]
  v_pk_mul_f32 v[182:183], v[182:183], v[230:231]
  v_pk_mul_f32 v[184:185], v[184:185], v[232:233]
  v_pk_mul_f32 v[186:187], v[186:187], v[234:235]
  v_pk_mul_f32 v[188:189], v[188:189], v[236:237]
  v_pk_mul_f32 v[190:191], v[190:191], v[238:239]
  v_cvt_pk_bf16_f32 v112, v176, v177
  v_cvt_pk_bf16_f32 v113, v178, v179
  v_cvt_pk_bf16_f32 v114, v180, v181
  v_cvt_pk_bf16_f32 v115, v182, v183
  v_cvt_pk_bf16_f32 v116, v184, v185
  v_cvt_pk_bf16_f32 v117, v186, v187
  v_cvt_pk_bf16_f32 v118, v188, v189
  v_cvt_pk_bf16_f32 v119, v190, v191
  buffer_store_dwordx4 v[112:115], v2, s[8:11], s15 offen offset:0 sc1
  buffer_store_dwordx4 v[116:119], v2, s[8:11], s15 offen offset:1024 sc1
  s_add_u32 s15, s15, 110592
  v_pk_mul_f32 v[224:225], v[128:129], v[128:129]
  v_pk_mul_f32 v[226:227], v[130:131], v[130:131]
  v_pk_mul_f32 v[228:229], v[132:133], v[132:133]
  v_pk_mul_f32 v[230:231], v[134:135], v[134:135]
  v_pk_mul_f32 v[232:233], v[136:137], v[136:137]
  v_pk_mul_f32 v[234:235], v[138:139], v[138:139]
  v_pk_mul_f32 v[236:237], v[140:141], v[140:141]
  v_pk_mul_f32 v[238:239], v[142:143], v[142:143]
  v_pk_fma_f32 v[224:225], v[224:225], v[250:251], v[248:249]
  v_pk_fma_f32 v[226:227], v[226:227], v[250:251], v[248:249]
  v_pk_fma_f32 v[228:229], v[228:229], v[250:251], v[248:249]
  v_pk_fma_f32 v[230:231], v[230:231], v[250:251], v[248:249]
  v_pk_fma_f32 v[232:233], v[232:233], v[250:251], v[248:249]
  v_pk_fma_f32 v[234:235], v[234:235], v[250:251], v[248:249]
  v_pk_fma_f32 v[236:237], v[236:237], v[250:251], v[248:249]
  v_pk_fma_f32 v[238:239], v[238:239], v[250:251], v[248:249]
  v_pk_mul_f32 v[224:225], v[224:225], v[128:129]
  v_pk_mul_f32 v[226:227], v[226:227], v[130:131]
  v_pk_mul_f32 v[228:229], v[228:229], v[132:133]
  v_pk_mul_f32 v[230:231], v[230:231], v[134:135]
  v_pk_mul_f32 v[232:233], v[232:233], v[136:137]
  v_pk_mul_f32 v[234:235], v[234:235], v[138:139]
  v_pk_mul_f32 v[236:237], v[236:237], v[140:141]
  v_pk_mul_f32 v[238:239], v[238:239], v[142:143]
  v_exp_f32 v224, v224
  v_exp_f32 v225, v225
  v_pk_mul_f32 v[192:193], v[192:193], v[128:129]
  v_exp_f32 v226, v226
  v_exp_f32 v227, v227
  v_pk_mul_f32 v[194:195], v[194:195], v[130:131]
  v_exp_f32 v228, v228
  v_exp_f32 v229, v229
  v_pk_mul_f32 v[196:197], v[196:197], v[132:133]
  v_exp_f32 v230, v230
  v_exp_f32 v231, v231
  v_pk_mul_f32 v[198:199], v[198:199], v[134:135]
  v_exp_f32 v232, v232
  v_exp_f32 v233, v233
  v_pk_mul_f32 v[200:201], v[200:201], v[136:137]
  v_exp_f32 v234, v234
  v_exp_f32 v235, v235
  v_pk_mul_f32 v[202:203], v[202:203], v[138:139]
  v_exp_f32 v236, v236
  v_exp_f32 v237, v237
  v_pk_mul_f32 v[204:205], v[204:205], v[140:141]
  v_exp_f32 v238, v238
  v_exp_f32 v239, v239
  v_pk_mul_f32 v[206:207], v[206:207], v[142:143]
  v_pk_add_f32 v[224:225], v[224:225], v[252:253]
  v_pk_add_f32 v[226:227], v[226:227], v[252:253]
  v_pk_add_f32 v[228:229], v[228:229], v[252:253]
  v_pk_add_f32 v[230:231], v[230:231], v[252:253]
  v_pk_add_f32 v[232:233], v[232:233], v[252:253]
  v_pk_add_f32 v[234:235], v[234:235], v[252:253]
  v_pk_add_f32 v[236:237], v[236:237], v[252:253]
  v_pk_add_f32 v[238:239], v[238:239], v[252:253]
  v_rcp_f32 v224, v224
  v_rcp_f32 v225, v225
  v_rcp_f32 v226, v226
  v_rcp_f32 v227, v227
  v_rcp_f32 v228, v228
  v_rcp_f32 v229, v229
  v_rcp_f32 v230, v230
  v_rcp_f32 v231, v231
  v_rcp_f32 v232, v232
  v_rcp_f32 v233, v233
  v_rcp_f32 v234, v234
  v_rcp_f32 v235, v235
  v_rcp_f32 v236, v236
  v_rcp_f32 v237, v237
  v_rcp_f32 v238, v238
  v_rcp_f32 v239, v239
  v_pk_mul_f32 v[192:193], v[192:193], v[224:225]
  v_pk_mul_f32 v[194:195], v[194:195], v[226:227]
  v_pk_mul_f32 v[196:197], v[196:197], v[228:229]
  v_pk_mul_f32 v[198:199], v[198:199], v[230:231]
  v_pk_mul_f32 v[200:201], v[200:201], v[232:233]
  v_pk_mul_f32 v[202:203], v[202:203], v[234:235]
  v_pk_mul_f32 v[204:205], v[204:205], v[236:237]
  v_pk_mul_f32 v[206:207], v[206:207], v[238:239]
  v_cvt_pk_bf16_f32 v128, v192, v193
  v_cvt_pk_bf16_f32 v129, v194, v195
  v_cvt_pk_bf16_f32 v130, v196, v197
  v_cvt_pk_bf16_f32 v131, v198, v199
  v_cvt_pk_bf16_f32 v132, v200, v201
  v_cvt_pk_bf16_f32 v133, v202, v203
  v_cvt_pk_bf16_f32 v134, v204, v205
  v_cvt_pk_bf16_f32 v135, v206, v207
  buffer_store_dwordx4 v[128:131], v2, s[8:11], s15 offen offset:0 sc1
  buffer_store_dwordx4 v[132:135], v2, s[8:11], s15 offen offset:1024 sc1
  s_add_u32 s15, s15, 110592
  s_waitcnt vmcnt(4)
  s_mov_b64 exec, 1
  ds_add_u32 v92, v90 offset:60
  s_mov_b64 exec, -1
  v_pk_mul_f32 v[224:225], v[144:145], v[144:145]
  v_pk_mul_f32 v[226:227], v[146:147], v[146:147]
  v_pk_mul_f32 v[228:229], v[148:149], v[148:149]
  v_pk_mul_f32 v[230:231], v[150:151], v[150:151]
  v_pk_mul_f32 v[232:233], v[152:153], v[152:153]
  v_pk_mul_f32 v[234:235], v[154:155], v[154:155]
  v_pk_mul_f32 v[236:237], v[156:157], v[156:157]
  v_pk_mul_f32 v[238:239], v[158:159], v[158:159]
  v_pk_fma_f32 v[224:225], v[224:225], v[250:251], v[248:249]
  v_pk_fma_f32 v[226:227], v[226:227], v[250:251], v[248:249]
  v_pk_fma_f32 v[228:229], v[228:229], v[250:251], v[248:249]
  v_pk_fma_f32 v[230:231], v[230:231], v[250:251], v[248:249]
  v_pk_fma_f32 v[232:233], v[232:233], v[250:251], v[248:249]
  v_pk_fma_f32 v[234:235], v[234:235], v[250:251], v[248:249]
  v_pk_fma_f32 v[236:237], v[236:237], v[250:251], v[248:249]
  v_pk_fma_f32 v[238:239], v[238:239], v[250:251], v[248:249]
  v_pk_mul_f32 v[224:225], v[224:225], v[144:145]
  v_pk_mul_f32 v[226:227], v[226:227], v[146:147]
  v_pk_mul_f32 v[228:229], v[228:229], v[148:149]
  v_pk_mul_f32 v[230:231], v[230:231], v[150:151]
  v_pk_mul_f32 v[232:233], v[232:233], v[152:153]
  v_pk_mul_f32 v[234:235], v[234:235], v[154:155]
  v_pk_mul_f32 v[236:237], v[236:237], v[156:157]
  v_pk_mul_f32 v[238:239], v[238:239], v[158:159]
  v_exp_f32 v224, v224
  v_exp_f32 v225, v225
  v_pk_mul_f32 v[208:209], v[208:209], v[144:145]
  v_exp_f32 v226, v226
  v_exp_f32 v227, v227
  v_pk_mul_f32 v[210:211], v[210:211], v[146:147]
  v_exp_f32 v228, v228
  v_exp_f32 v229, v229
  v_pk_mul_f32 v[212:213], v[212:213], v[148:149]
  v_exp_f32 v230, v230
  v_exp_f32 v231, v231
  v_pk_mul_f32 v[214:215], v[214:215], v[150:151]
  v_exp_f32 v232, v232
  v_exp_f32 v233, v233
  v_pk_mul_f32 v[216:217], v[216:217], v[152:153]
  v_exp_f32 v234, v234
  v_exp_f32 v235, v235
  v_pk_mul_f32 v[218:219], v[218:219], v[154:155]
  v_exp_f32 v236, v236
  v_exp_f32 v237, v237
  v_pk_mul_f32 v[220:221], v[220:221], v[156:157]
  v_exp_f32 v238, v238
  v_exp_f32 v239, v239
  v_pk_mul_f32 v[222:223], v[222:223], v[158:159]
  v_pk_add_f32 v[224:225], v[224:225], v[252:253]
  v_pk_add_f32 v[226:227], v[226:227], v[252:253]
  v_pk_add_f32 v[228:229], v[228:229], v[252:253]
  v_pk_add_f32 v[230:231], v[230:231], v[252:253]
  v_pk_add_f32 v[232:233], v[232:233], v[252:253]
  v_pk_add_f32 v[234:235], v[234:235], v[252:253]
  v_pk_add_f32 v[236:237], v[236:237], v[252:253]
  v_pk_add_f32 v[238:239], v[238:239], v[252:253]
  v_rcp_f32 v224, v224
  v_rcp_f32 v225, v225
  v_rcp_f32 v226, v226
  v_rcp_f32 v227, v227
  v_rcp_f32 v228, v228
  v_rcp_f32 v229, v229
  v_rcp_f32 v230, v230
  v_rcp_f32 v231, v231
  v_rcp_f32 v232, v232
  v_rcp_f32 v233, v233
  v_rcp_f32 v234, v234
  v_rcp_f32 v235, v235
  v_rcp_f32 v236, v236
  v_rcp_f32 v237, v237
  v_rcp_f32 v238, v238
  v_rcp_f32 v239, v239
  v_pk_mul_f32 v[208:209], v[208:209], v[224:225]
  v_pk_mul_f32 v[210:211], v[210:211], v[226:227]
  v_pk_mul_f32 v[212:213], v[212:213], v[228:229]
  v_pk_mul_f32 v[214:215], v[214:215], v[230:231]
  v_pk_mul_f32 v[216:217], v[216:217], v[232:233]
  v_pk_mul_f32 v[218:219], v[218:219], v[234:235]
  v_pk_mul_f32 v[220:221], v[220:221], v[236:237]
  v_pk_mul_f32 v[222:223], v[222:223], v[238:239]
  v_cvt_pk_bf16_f32 v144, v208, v209
  v_cvt_pk_bf16_f32 v145, v210, v211
  v_cvt_pk_bf16_f32 v146, v212, v213
  v_cvt_pk_bf16_f32 v147, v214, v215
  v_cvt_pk_bf16_f32 v148, v216, v217
  v_cvt_pk_bf16_f32 v149, v218, v219
  v_cvt_pk_bf16_f32 v150, v220, v221
  v_cvt_pk_bf16_f32 v151, v222, v223
  buffer_store_dwordx4 v[144:147], v2, s[8:11], s15 offen offset:0 sc1
  buffer_store_dwordx4 v[148:151], v2, s[8:11], s15 offen offset:1024 sc1
  s_setprio 0
  s_branch gated_mix__grouped_kv_mqa__geglu_ffn__prompt_kernel_pubh
gated_mix__grouped_kv_mqa__geglu_ffn__prompt_kernel_R:
  s_add_u32 m0, s20, 12288
  s_add_u32 s14, s21, 12288
  buffer_load_dwordx4 v2, s[24:27], s14 offen sc1 lds
  s_add_u32 m0, s20, 16384
  s_add_u32 s14, s21, 16384
  buffer_load_dwordx4 v2, s[24:27], s14 offen sc1 lds
  s_add_u32 m0, s20, 20480
  s_add_u32 s14, s21, 20480
  buffer_load_dwordx4 v2, s[24:27], s14 offen sc1 lds
  s_add_u32 m0, s20, 24576
  s_add_u32 s14, s21, 24576
  buffer_load_dwordx4 v2, s[24:27], s14 offen sc1 lds
  s_add_u32 m0, s20, 28672
  s_add_u32 s14, s21, 28672
  buffer_load_dwordx4 v2, s[24:27], s14 offen sc1 lds
  s_add_u32 m0, s20, 32768
  s_add_u32 s14, s21, 32768
  buffer_load_dwordx4 v2, s[24:27], s14 offen sc1 lds
  s_add_u32 m0, s20, 36864
  s_add_u32 s14, s21, 36864
  buffer_load_dwordx4 v2, s[24:27], s14 offen sc1 lds
  s_add_u32 m0, s20, 40960
  s_add_u32 s14, s21, 40960
  buffer_load_dwordx4 v2, s[24:27], s14 offen sc1 lds
  s_add_u32 m0, s20, 45056
  s_add_u32 s14, s21, 45056
  buffer_load_dwordx4 v2, s[24:27], s14 offen sc1 lds
  s_add_u32 m0, s20, 49152
  s_add_u32 s14, s21, 49152
  buffer_load_dwordx4 v2, s[24:27], s14 offen sc1 lds
  s_add_u32 m0, s20, 53248
  s_add_u32 s14, s21, 53248
  buffer_load_dwordx4 v2, s[24:27], s14 offen sc1 lds
  s_add_u32 m0, s20, 57344
  s_add_u32 s14, s21, 57344
  buffer_load_dwordx4 v2, s[24:27], s14 offen sc1 lds
  s_add_u32 m0, s20, 61440
  s_add_u32 s14, s21, 61440
  buffer_load_dwordx4 v2, s[24:27], s14 offen sc1 lds
  s_add_u32 m0, s20, 65536
  s_add_u32 s14, s21, 65536
  buffer_load_dwordx4 v2, s[24:27], s14 offen sc1 lds
  s_cmp_eq_u32 s19, 3
  s_cselect_b32 exec_lo, 0xffffff, -1
  s_cselect_b32 exec_hi, 0, -1
  s_add_u32 m0, s20, 69632
  s_add_u32 s14, s21, 69632
  buffer_load_dwordx4 v2, s[24:27], s14 offen sc1 lds
  s_mov_b64 exec, -1
  s_waitcnt vmcnt(15)
  s_mov_b64 exec, 1
  ds_add_u32 v92, v90 offset:0
  s_mov_b64 exec, -1
  s_waitcnt vmcnt(10)
  s_mov_b64 exec, 1
  ds_add_u32 v92, v90 offset:4
  s_mov_b64 exec, -1
  s_add_u32 s30, s83, 0
  s_min_u32 s30, s30, 1479
  s_cmp_ge_u32 s30, 1080
  s_cselect_b32 s56, s68, s76
  s_cselect_b32 s57, s69, s77
  s_mov_b32 s58, 2211840
  s_cselect_b32 s58, 819200, s58
  s_cselect_b32 s31, 40, 108
  s_mov_b32 s84, 12499200
  s_cselect_b32 s84, 14711040, s84
  s_cselect_b32 s12, 1080, 0
  s_and_b32 s57, s57, 0xffff
  s_mov_b32 s59, 0x20000
  s_sub_u32 s30, s30, s12
  s_mul_hi_u32 s85, s30, 429496730
  s_mul_i32 s12, s85, 10
  s_sub_u32 s100, s30, s12
  s_mul_hi_u32 s13, s85, 858993460
  s_mul_i32 s14, s13, 5
  s_sub_u32 s14, s85, s14
  s_mul_i32 s13, s13, 80
  s_mul_i32 s15, s14, 20
  s_cmp_eq_u32 s14, 4
  s_cselect_b32 s15, 16, s15
  s_cselect_b32 s14, 1, 0
  s_add_u32 s13, s13, s15
  s_lshl_b32 s12, s85, 4
  s_cmp_eq_u32 s31, 40
  s_cselect_b32 s12, s13, s12
  s_cselect_b32 s14, s14, 0
  s_mul_i32 s12, s12, 1280
  s_lshl_b32 s13, s100, 7
  s_add_u32 s12, s12, s13
  s_cmp_eq_u32 s14, 1
  s_cselect_b64 s[92:93], -1, 0
  s_mov_b32 s13, 10240
  s_cselect_b32 s13, 25600, s13
  v_cndmask_b32 v252, v248, v251, s[92:93]
  s_add_u32 m0, s101, 73088
  s_add_u32 s13, s12, s13
  buffer_load_dwordx4 v252, s[56:59], s12 offen lds
  s_add_u32 m0, s101, 74112
  s_nop 0
  buffer_load_dwordx4 v252, s[56:59], s13 offen lds
  s_add_u32 s30, s83, 1
  s_min_u32 s30, s30, 1479
  s_cmp_ge_u32 s30, 1080
  s_cselect_b32 s56, s68, s76
  s_cselect_b32 s57, s69, s77
  s_mov_b32 s58, 2211840
  s_cselect_b32 s58, 819200, s58
  s_cselect_b32 s31, 40, 108
  s_mov_b32 s84, 12499200
  s_cselect_b32 s84, 14711040, s84
  s_cselect_b32 s12, 1080, 0
  s_and_b32 s57, s57, 0xffff
  s_mov_b32 s59, 0x20000
  s_sub_u32 s30, s30, s12
  s_mul_hi_u32 s85, s30, 429496730
  s_mul_i32 s12, s85, 10
  s_sub_u32 s100, s30, s12
  s_mul_hi_u32 s13, s85, 858993460
  s_mul_i32 s14, s13, 5
  s_sub_u32 s14, s85, s14
  s_mul_i32 s13, s13, 80
  s_mul_i32 s15, s14, 20
  s_cmp_eq_u32 s14, 4
  s_cselect_b32 s15, 16, s15
  s_cselect_b32 s14, 1, 0
  s_add_u32 s13, s13, s15
  s_lshl_b32 s12, s85, 4
  s_cmp_eq_u32 s31, 40
  s_cselect_b32 s12, s13, s12
  s_cselect_b32 s14, s14, 0
  s_mul_i32 s12, s12, 1280
  s_lshl_b32 s13, s100, 7
  s_add_u32 s12, s12, s13
  s_cmp_eq_u32 s14, 1
  s_cselect_b64 s[92:93], -1, 0
  s_mov_b32 s13, 10240
  s_cselect_b32 s13, 25600, s13
  v_cndmask_b32 v252, v248, v251, s[92:93]
  s_add_u32 m0, s101, 75136
  s_add_u32 s13, s12, s13
  buffer_load_dwordx4 v252, s[56:59], s12 offen lds
  s_add_u32 m0, s101, 76160
  s_nop 0
  buffer_load_dwordx4 v252, s[56:59], s13 offen lds
  s_add_u32 s30, s83, 2
  s_min_u32 s30, s30, 1479
  s_cmp_ge_u32 s30, 1080
  s_cselect_b32 s56, s68, s76
  s_cselect_b32 s57, s69, s77
  s_mov_b32 s58, 2211840
  s_cselect_b32 s58, 819200, s58
  s_cselect_b32 s31, 40, 108
  s_mov_b32 s84, 12499200
  s_cselect_b32 s84, 14711040, s84
  s_cselect_b32 s12, 1080, 0
  s_and_b32 s57, s57, 0xffff
  s_mov_b32 s59, 0x20000
  s_sub_u32 s30, s30, s12
  s_mul_hi_u32 s85, s30, 429496730
  s_mul_i32 s12, s85, 10
  s_sub_u32 s100, s30, s12
  s_mul_hi_u32 s13, s85, 858993460
  s_mul_i32 s14, s13, 5
  s_sub_u32 s14, s85, s14
  s_mul_i32 s13, s13, 80
  s_mul_i32 s15, s14, 20
  s_cmp_eq_u32 s14, 4
  s_cselect_b32 s15, 16, s15
  s_cselect_b32 s14, 1, 0
  s_add_u32 s13, s13, s15
  s_lshl_b32 s12, s85, 4
  s_cmp_eq_u32 s31, 40
  s_cselect_b32 s12, s13, s12
  s_cselect_b32 s14, s14, 0
  s_mul_i32 s12, s12, 1280
  s_lshl_b32 s13, s100, 7
  s_add_u32 s12, s12, s13
  s_cmp_eq_u32 s14, 1
  s_cselect_b64 s[92:93], -1, 0
  s_mov_b32 s13, 10240
  s_cselect_b32 s13, 25600, s13
  v_cndmask_b32 v252, v248, v251, s[92:93]
  s_add_u32 m0, s101, 77184
  s_add_u32 s13, s12, s13
  buffer_load_dwordx4 v252, s[56:59], s12 offen lds
  s_add_u32 m0, s101, 78208
  s_nop 0
  buffer_load_dwordx4 v252, s[56:59], s13 offen lds
  s_add_u32 s30, s83, 3
  s_min_u32 s30, s30, 1479
  s_cmp_ge_u32 s30, 1080
  s_cselect_b32 s56, s68, s76
  s_cselect_b32 s57, s69, s77
  s_mov_b32 s58, 2211840
  s_cselect_b32 s58, 819200, s58
  s_cselect_b32 s31, 40, 108
  s_mov_b32 s84, 12499200
  s_cselect_b32 s84, 14711040, s84
  s_cselect_b32 s12, 1080, 0
  s_and_b32 s57, s57, 0xffff
  s_mov_b32 s59, 0x20000
  s_sub_u32 s30, s30, s12
  s_mul_hi_u32 s85, s30, 429496730
  s_mul_i32 s12, s85, 10
  s_sub_u32 s100, s30, s12
  s_mul_hi_u32 s13, s85, 858993460
  s_mul_i32 s14, s13, 5
  s_sub_u32 s14, s85, s14
  s_mul_i32 s13, s13, 80
  s_mul_i32 s15, s14, 20
  s_cmp_eq_u32 s14, 4
  s_cselect_b32 s15, 16, s15
  s_cselect_b32 s14, 1, 0
  s_add_u32 s13, s13, s15
  s_lshl_b32 s12, s85, 4
  s_cmp_eq_u32 s31, 40
  s_cselect_b32 s12, s13, s12
  s_cselect_b32 s14, s14, 0
  s_mul_i32 s12, s12, 1280
  s_lshl_b32 s13, s100, 7
  s_add_u32 s12, s12, s13
  s_cmp_eq_u32 s14, 1
  s_cselect_b64 s[92:93], -1, 0
  s_mov_b32 s13, 10240
  s_cselect_b32 s13, 25600, s13
  v_cndmask_b32 v252, v248, v251, s[92:93]
  s_add_u32 m0, s101, 79232
  s_add_u32 s13, s12, s13
  buffer_load_dwordx4 v252, s[56:59], s12 offen lds
  s_add_u32 m0, s101, 80256
  s_nop 0
  buffer_load_dwordx4 v252, s[56:59], s13 offen lds
  s_add_u32 s30, s83, 4
  s_min_u32 s30, s30, 1479
  s_cmp_ge_u32 s30, 1080
  s_cselect_b32 s56, s68, s76
  s_cselect_b32 s57, s69, s77
  s_mov_b32 s58, 2211840
  s_cselect_b32 s58, 819200, s58
  s_cselect_b32 s31, 40, 108
  s_mov_b32 s84, 12499200
  s_cselect_b32 s84, 14711040, s84
  s_cselect_b32 s12, 1080, 0
  s_and_b32 s57, s57, 0xffff
  s_mov_b32 s59, 0x20000
  s_sub_u32 s30, s30, s12
  s_mul_hi_u32 s85, s30, 429496730
  s_mul_i32 s12, s85, 10
  s_sub_u32 s100, s30, s12
  s_mul_hi_u32 s13, s85, 858993460
  s_mul_i32 s14, s13, 5
  s_sub_u32 s14, s85, s14
  s_mul_i32 s13, s13, 80
  s_mul_i32 s15, s14, 20
  s_cmp_eq_u32 s14, 4
  s_cselect_b32 s15, 16, s15
  s_cselect_b32 s14, 1, 0
  s_add_u32 s13, s13, s15
  s_lshl_b32 s12, s85, 4
  s_cmp_eq_u32 s31, 40
  s_cselect_b32 s12, s13, s12
  s_cselect_b32 s14, s14, 0
  s_mul_i32 s12, s12, 1280
  s_lshl_b32 s13, s100, 7
  s_add_u32 s12, s12, s13
  s_cmp_eq_u32 s14, 1
  s_cselect_b64 s[92:93], -1, 0
  s_mov_b32 s13, 10240
  s_cselect_b32 s13, 25600, s13
  v_cndmask_b32 v252, v248, v251, s[92:93]
  s_add_u32 m0, s101, 81280
  s_add_u32 s13, s12, s13
  buffer_load_dwordx4 v252, s[56:59], s12 offen lds
  s_add_u32 m0, s101, 82304
  s_nop 0
  buffer_load_dwordx4 v252, s[56:59], s13 offen lds
  s_add_u32 s30, s83, 5
  s_min_u32 s30, s30, 1479
  s_cmp_ge_u32 s30, 1080
  s_cselect_b32 s56, s68, s76
  s_cselect_b32 s57, s69, s77
  s_mov_b32 s58, 2211840
  s_cselect_b32 s58, 819200, s58
  s_cselect_b32 s31, 40, 108
  s_mov_b32 s84, 12499200
  s_cselect_b32 s84, 14711040, s84
  s_cselect_b32 s12, 1080, 0
  s_and_b32 s57, s57, 0xffff
  s_mov_b32 s59, 0x20000
  s_sub_u32 s30, s30, s12
  s_mul_hi_u32 s85, s30, 429496730
  s_mul_i32 s12, s85, 10
  s_sub_u32 s100, s30, s12
  s_mul_hi_u32 s13, s85, 858993460
  s_mul_i32 s14, s13, 5
  s_sub_u32 s14, s85, s14
  s_mul_i32 s13, s13, 80
  s_mul_i32 s15, s14, 20
  s_cmp_eq_u32 s14, 4
  s_cselect_b32 s15, 16, s15
  s_cselect_b32 s14, 1, 0
  s_add_u32 s13, s13, s15
  s_lshl_b32 s12, s85, 4
  s_cmp_eq_u32 s31, 40
  s_cselect_b32 s12, s13, s12
  s_cselect_b32 s14, s14, 0
  s_mul_i32 s12, s12, 1280
  s_lshl_b32 s13, s100, 7
  s_add_u32 s12, s12, s13
  s_cmp_eq_u32 s14, 1
  s_cselect_b64 s[92:93], -1, 0
  s_mov_b32 s13, 10240
  s_cselect_b32 s13, 25600, s13
  v_cndmask_b32 v252, v248, v251, s[92:93]
  s_add_u32 m0, s101, 83328
  s_add_u32 s13, s12, s13
  buffer_load_dwordx4 v252, s[56:59], s12 offen lds
  s_add_u32 m0, s101, 84352
  s_nop 0
  buffer_load_dwordx4 v252, s[56:59], s13 offen lds
  s_add_u32 s30, s83, 6
  s_min_u32 s30, s30, 1479
  s_cmp_ge_u32 s30, 1080
  s_cselect_b32 s56, s68, s76
  s_cselect_b32 s57, s69, s77
  s_mov_b32 s58, 2211840
  s_cselect_b32 s58, 819200, s58
  s_cselect_b32 s31, 40, 108
  s_mov_b32 s84, 12499200
  s_cselect_b32 s84, 14711040, s84
  s_cselect_b32 s12, 1080, 0
  s_and_b32 s57, s57, 0xffff
  s_mov_b32 s59, 0x20000
  s_sub_u32 s30, s30, s12
  s_mul_hi_u32 s85, s30, 429496730
  s_mul_i32 s12, s85, 10
  s_sub_u32 s100, s30, s12
  s_mul_hi_u32 s13, s85, 858993460
  s_mul_i32 s14, s13, 5
  s_sub_u32 s14, s85, s14
  s_mul_i32 s13, s13, 80
  s_mul_i32 s15, s14, 20
  s_cmp_eq_u32 s14, 4
  s_cselect_b32 s15, 16, s15
  s_cselect_b32 s14, 1, 0
  s_add_u32 s13, s13, s15
  s_lshl_b32 s12, s85, 4
  s_cmp_eq_u32 s31, 40
  s_cselect_b32 s12, s13, s12
  s_cselect_b32 s14, s14, 0
  s_mul_i32 s12, s12, 1280
  s_lshl_b32 s13, s100, 7
  s_add_u32 s12, s12, s13
  s_cmp_eq_u32 s14, 1
  s_cselect_b64 s[92:93], -1, 0
  s_mov_b32 s13, 10240
  s_cselect_b32 s13, 25600, s13
  v_cndmask_b32 v252, v248, v251, s[92:93]
  s_add_u32 m0, s101, 85376
  s_add_u32 s13, s12, s13
  buffer_load_dwordx4 v252, s[56:59], s12 offen lds
  s_add_u32 m0, s101, 86400
  s_nop 0
  buffer_load_dwordx4 v252, s[56:59], s13 offen lds
  s_add_u32 s30, s83, 7
  s_min_u32 s30, s30, 1479
  s_cmp_ge_u32 s30, 1080
  s_cselect_b32 s56, s68, s76
  s_cselect_b32 s57, s69, s77
  s_mov_b32 s58, 2211840
  s_cselect_b32 s58, 819200, s58
  s_cselect_b32 s31, 40, 108
  s_mov_b32 s84, 12499200
  s_cselect_b32 s84, 14711040, s84
  s_cselect_b32 s12, 1080, 0
  s_and_b32 s57, s57, 0xffff
  s_mov_b32 s59, 0x20000
  s_sub_u32 s30, s30, s12
  s_mul_hi_u32 s85, s30, 429496730
  s_mul_i32 s12, s85, 10
  s_sub_u32 s100, s30, s12
  s_mul_hi_u32 s13, s85, 858993460
  s_mul_i32 s14, s13, 5
  s_sub_u32 s14, s85, s14
  s_mul_i32 s13, s13, 80
  s_mul_i32 s15, s14, 20
  s_cmp_eq_u32 s14, 4
  s_cselect_b32 s15, 16, s15
  s_cselect_b32 s14, 1, 0
  s_add_u32 s13, s13, s15
  s_lshl_b32 s12, s85, 4
  s_cmp_eq_u32 s31, 40
  s_cselect_b32 s12, s13, s12
  s_cselect_b32 s14, s14, 0
  s_mul_i32 s12, s12, 1280
  s_lshl_b32 s13, s100, 7
  s_add_u32 s12, s12, s13
  s_cmp_eq_u32 s14, 1
  s_cselect_b64 s[92:93], -1, 0
  s_mov_b32 s13, 10240
  s_cselect_b32 s13, 25600, s13
  v_cndmask_b32 v252, v248, v251, s[92:93]
  s_add_u32 m0, s101, 87424
  s_add_u32 s13, s12, s13
  buffer_load_dwordx4 v252, s[56:59], s12 offen lds
  s_add_u32 m0, s101, 88448
  s_nop 0
  buffer_load_dwordx4 v252, s[56:59], s13 offen lds
  s_add_u32 s30, s83, 8
  s_min_u32 s30, s30, 1479
  s_cmp_ge_u32 s30, 1080
  s_cselect_b32 s56, s68, s76
  s_cselect_b32 s57, s69, s77
  s_mov_b32 s58, 2211840
  s_cselect_b32 s58, 819200, s58
  s_cselect_b32 s31, 40, 108
  s_mov_b32 s84, 12499200
  s_cselect_b32 s84, 14711040, s84
  s_cselect_b32 s12, 1080, 0
  s_and_b32 s57, s57, 0xffff
  s_mov_b32 s59, 0x20000
  s_sub_u32 s30, s30, s12
  s_mul_hi_u32 s85, s30, 429496730
  s_mul_i32 s12, s85, 10
  s_sub_u32 s100, s30, s12
  s_mul_hi_u32 s13, s85, 858993460
  s_mul_i32 s14, s13, 5
  s_sub_u32 s14, s85, s14
  s_mul_i32 s13, s13, 80
  s_mul_i32 s15, s14, 20
  s_cmp_eq_u32 s14, 4
  s_cselect_b32 s15, 16, s15
  s_cselect_b32 s14, 1, 0
  s_add_u32 s13, s13, s15
  s_lshl_b32 s12, s85, 4
  s_cmp_eq_u32 s31, 40
  s_cselect_b32 s12, s13, s12
  s_cselect_b32 s14, s14, 0
  s_mul_i32 s12, s12, 1280
  s_lshl_b32 s13, s100, 7
  s_add_u32 s12, s12, s13
  s_cmp_eq_u32 s14, 1
  s_cselect_b64 s[92:93], -1, 0
  s_mov_b32 s13, 10240
  s_cselect_b32 s13, 25600, s13
  v_cndmask_b32 v252, v248, v251, s[92:93]
  s_add_u32 m0, s101, 89472
  s_add_u32 s13, s12, s13
  buffer_load_dwordx4 v252, s[56:59], s12 offen lds
  s_add_u32 m0, s101, 90496
  s_nop 0
  buffer_load_dwordx4 v252, s[56:59], s13 offen lds
  s_add_u32 s30, s83, 9
  s_min_u32 s30, s30, 1479
  s_cmp_ge_u32 s30, 1080
  s_cselect_b32 s56, s68, s76
  s_cselect_b32 s57, s69, s77
  s_mov_b32 s58, 2211840
  s_cselect_b32 s58, 819200, s58
  s_cselect_b32 s31, 40, 108
  s_mov_b32 s84, 12499200
  s_cselect_b32 s84, 14711040, s84
  s_cselect_b32 s12, 1080, 0
  s_and_b32 s57, s57, 0xffff
  s_mov_b32 s59, 0x20000
  s_sub_u32 s30, s30, s12
  s_mul_hi_u32 s85, s30, 429496730
  s_mul_i32 s12, s85, 10
  s_sub_u32 s100, s30, s12
  s_mul_hi_u32 s13, s85, 858993460
  s_mul_i32 s14, s13, 5
  s_sub_u32 s14, s85, s14
  s_mul_i32 s13, s13, 80
  s_mul_i32 s15, s14, 20
  s_cmp_eq_u32 s14, 4
  s_cselect_b32 s15, 16, s15
  s_cselect_b32 s14, 1, 0
  s_add_u32 s13, s13, s15
  s_lshl_b32 s12, s85, 4
  s_cmp_eq_u32 s31, 40
  s_cselect_b32 s12, s13, s12
  s_cselect_b32 s14, s14, 0
  s_mul_i32 s12, s12, 1280
  s_lshl_b32 s13, s100, 7
  s_add_u32 s12, s12, s13
  s_cmp_eq_u32 s14, 1
  s_cselect_b64 s[92:93], -1, 0
  s_mov_b32 s13, 10240
  s_cselect_b32 s13, 25600, s13
  v_cndmask_b32 v252, v248, v251, s[92:93]
  s_add_u32 m0, s101, 91520
  s_add_u32 s13, s12, s13
  buffer_load_dwordx4 v252, s[56:59], s12 offen lds
  s_add_u32 m0, s101, 92544
  s_nop 0
  buffer_load_dwordx4 v252, s[56:59], s13 offen lds
  s_waitcnt vmcnt(20)
  s_mov_b64 exec, 1
  ds_add_u32 v92, v90 offset:8
  s_mov_b64 exec, -1
  s_waitcnt vmcnt(18)
  ds_read_b64_tr_b16 v[96:97], v249 offset:0
  ds_read_b64_tr_b16 v[98:99], v249 offset:1024
  ds_read_b64_tr_b16 v[100:101], v250 offset:0
  ds_read_b64_tr_b16 v[102:103], v250 offset:1024
  s_add_u32 s30, s83, 0
  s_min_u32 s30, s30, 1479
  s_cmp_ge_u32 s30, 1080
  s_cselect_b32 s56, s68, s76
  s_cselect_b32 s57, s69, s77
  s_mov_b32 s58, 2211840
  s_cselect_b32 s58, 819200, s58
  s_cselect_b32 s31, 40, 108
  s_mov_b32 s84, 12499200
  s_cselect_b32 s84, 14711040, s84
  s_cselect_b32 s12, 1080, 0
  s_and_b32 s57, s57, 0xffff
  s_mov_b32 s59, 0x20000
  s_sub_u32 s30, s30, s12
  s_mul_hi_u32 s85, s30, 429496730
  s_mul_i32 s12, s85, 10
  s_sub_u32 s100, s30, s12
  s_waitcnt lgkmcnt(0)
  s_lshl_b32 s12, s100, 1
  s_mul_hi_u32 s13, s12, 858993460
  s_mul_i32 s14, s13, 5
  s_sub_u32 s14, s12, s14
  s_mul_i32 s13, s13, s31
  s_add_u32 s13, s13, s85
  s_mul_i32 s13, s13, 5120
  s_lshl_b32 s14, s14, 10
  s_add_u32 s13, s13, s14
  s_add_u32 s13, s13, s84
  buffer_store_dwordx4 v[96:99], v2, s[8:11], s13 offen sc1
  s_lshl_b32 s12, s100, 1
  s_add_u32 s12, s12, 1
  s_mul_hi_u32 s13, s12, 858993460
  s_mul_i32 s14, s13, 5
  s_sub_u32 s14, s12, s14
  s_mul_i32 s13, s13, s31
  s_add_u32 s13, s13, s85
  s_mul_i32 s13, s13, 5120
  s_lshl_b32 s14, s14, 10
  s_add_u32 s13, s13, s14
  s_add_u32 s13, s13, s84
  buffer_store_dwordx4 v[100:103], v2, s[8:11], s13 offen sc1
  s_waitcnt vmcnt(18)
  ds_read_b64_tr_b16 v[104:105], v249 offset:2048
  ds_read_b64_tr_b16 v[106:107], v249 offset:3072
  ds_read_b64_tr_b16 v[108:109], v250 offset:2048
  ds_read_b64_tr_b16 v[110:111], v250 offset:3072
  s_add_u32 s30, s83, 1
  s_min_u32 s30, s30, 1479
  s_cmp_ge_u32 s30, 1080
  s_cselect_b32 s56, s68, s76
  s_cselect_b32 s57, s69, s77
  s_mov_b32 s58, 2211840
  s_cselect_b32 s58, 819200, s58
  s_cselect_b32 s31, 40, 108
  s_mov_b32 s84, 12499200
  s_cselect_b32 s84, 14711040, s84
  s_cselect_b32 s12, 1080, 0
  s_and_b32 s57, s57, 0xffff
  s_mov_b32 s59, 0x20000
  s_sub_u32 s30, s30, s12
  s_mul_hi_u32 s85, s30, 429496730
  s_mul_i32 s12, s85, 10
  s_sub_u32 s100, s30, s12
  s_waitcnt lgkmcnt(0)
  s_lshl_b32 s12, s100, 1
  s_mul_hi_u32 s13, s12, 858993460
  s_mul_i32 s14, s13, 5
  s_sub_u32 s14, s12, s14
  s_mul_i32 s13, s13, s31
  s_add_u32 s13, s13, s85
  s_mul_i32 s13, s13, 5120
  s_lshl_b32 s14, s14, 10
  s_add_u32 s13, s13, s14
  s_add_u32 s13, s13, s84
  buffer_store_dwordx4 v[104:107], v2, s[8:11], s13 offen sc1
  s_lshl_b32 s12, s100, 1
  s_add_u32 s12, s12, 1
  s_mul_hi_u32 s13, s12, 858993460
  s_mul_i32 s14, s13, 5
  s_sub_u32 s14, s12, s14
  s_mul_i32 s13, s13, s31
  s_add_u32 s13, s13, s85
  s_mul_i32 s13, s13, 5120
  s_lshl_b32 s14, s14, 10
  s_add_u32 s13, s13, s14
  s_add_u32 s13, s13, s84
  buffer_store_dwordx4 v[108:111], v2, s[8:11], s13 offen sc1
  s_waitcnt vmcnt(18)
  ds_read_b64_tr_b16 v[112:113], v249 offset:4096
  ds_read_b64_tr_b16 v[114:115], v249 offset:5120
  ds_read_b64_tr_b16 v[116:117], v250 offset:4096
  ds_read_b64_tr_b16 v[118:119], v250 offset:5120
  s_add_u32 s30, s83, 2
  s_min_u32 s30, s30, 1479
  s_cmp_ge_u32 s30, 1080
  s_cselect_b32 s56, s68, s76
  s_cselect_b32 s57, s69, s77
  s_mov_b32 s58, 2211840
  s_cselect_b32 s58, 819200, s58
  s_cselect_b32 s31, 40, 108
  s_mov_b32 s84, 12499200
  s_cselect_b32 s84, 14711040, s84
  s_cselect_b32 s12, 1080, 0
  s_and_b32 s57, s57, 0xffff
  s_mov_b32 s59, 0x20000
  s_sub_u32 s30, s30, s12
  s_mul_hi_u32 s85, s30, 429496730
  s_mul_i32 s12, s85, 10
  s_sub_u32 s100, s30, s12
  s_waitcnt lgkmcnt(0)
  s_lshl_b32 s12, s100, 1
  s_mul_hi_u32 s13, s12, 858993460
  s_mul_i32 s14, s13, 5
  s_sub_u32 s14, s12, s14
  s_mul_i32 s13, s13, s31
  s_add_u32 s13, s13, s85
  s_mul_i32 s13, s13, 5120
  s_lshl_b32 s14, s14, 10
  s_add_u32 s13, s13, s14
  s_add_u32 s13, s13, s84
  buffer_store_dwordx4 v[112:115], v2, s[8:11], s13 offen sc1
  s_lshl_b32 s12, s100, 1
  s_add_u32 s12, s12, 1
  s_mul_hi_u32 s13, s12, 858993460
  s_mul_i32 s14, s13, 5
  s_sub_u32 s14, s12, s14
  s_mul_i32 s13, s13, s31
  s_add_u32 s13, s13, s85
  s_mul_i32 s13, s13, 5120
  s_lshl_b32 s14, s14, 10
  s_add_u32 s13, s13, s14
  s_add_u32 s13, s13, s84
  buffer_store_dwordx4 v[116:119], v2, s[8:11], s13 offen sc1
  s_waitcnt vmcnt(18)
  ds_read_b64_tr_b16 v[120:121], v249 offset:6144
  ds_read_b64_tr_b16 v[122:123], v249 offset:7168
  ds_read_b64_tr_b16 v[124:125], v250 offset:6144
  ds_read_b64_tr_b16 v[126:127], v250 offset:7168
  s_add_u32 s30, s83, 3
  s_min_u32 s30, s30, 1479
  s_cmp_ge_u32 s30, 1080
  s_cselect_b32 s56, s68, s76
  s_cselect_b32 s57, s69, s77
  s_mov_b32 s58, 2211840
  s_cselect_b32 s58, 819200, s58
  s_cselect_b32 s31, 40, 108
  s_mov_b32 s84, 12499200
  s_cselect_b32 s84, 14711040, s84
  s_cselect_b32 s12, 1080, 0
  s_and_b32 s57, s57, 0xffff
  s_mov_b32 s59, 0x20000
  s_sub_u32 s30, s30, s12
  s_mul_hi_u32 s85, s30, 429496730
  s_mul_i32 s12, s85, 10
  s_sub_u32 s100, s30, s12
  s_waitcnt lgkmcnt(0)
  s_lshl_b32 s12, s100, 1
  s_mul_hi_u32 s13, s12, 858993460
  s_mul_i32 s14, s13, 5
  s_sub_u32 s14, s12, s14
  s_mul_i32 s13, s13, s31
  s_add_u32 s13, s13, s85
  s_mul_i32 s13, s13, 5120
  s_lshl_b32 s14, s14, 10
  s_add_u32 s13, s13, s14
  s_add_u32 s13, s13, s84
  buffer_store_dwordx4 v[120:123], v2, s[8:11], s13 offen sc1
  s_lshl_b32 s12, s100, 1
  s_add_u32 s12, s12, 1
  s_mul_hi_u32 s13, s12, 858993460
  s_mul_i32 s14, s13, 5
  s_sub_u32 s14, s12, s14
  s_mul_i32 s13, s13, s31
  s_add_u32 s13, s13, s85
  s_mul_i32 s13, s13, 5120
  s_lshl_b32 s14, s14, 10
  s_add_u32 s13, s13, s14
  s_add_u32 s13, s13, s84
  buffer_store_dwordx4 v[124:127], v2, s[8:11], s13 offen sc1
  s_waitcnt vmcnt(18)
  ds_read_b64_tr_b16 v[128:129], v249 offset:8192
  ds_read_b64_tr_b16 v[130:131], v249 offset:9216
  ds_read_b64_tr_b16 v[132:133], v250 offset:8192
  ds_read_b64_tr_b16 v[134:135], v250 offset:9216
  s_add_u32 s30, s83, 4
  s_min_u32 s30, s30, 1479
  s_cmp_ge_u32 s30, 1080
  s_cselect_b32 s56, s68, s76
  s_cselect_b32 s57, s69, s77
  s_mov_b32 s58, 2211840
  s_cselect_b32 s58, 819200, s58
  s_cselect_b32 s31, 40, 108
  s_mov_b32 s84, 12499200
  s_cselect_b32 s84, 14711040, s84
  s_cselect_b32 s12, 1080, 0
  s_and_b32 s57, s57, 0xffff
  s_mov_b32 s59, 0x20000
  s_sub_u32 s30, s30, s12
  s_mul_hi_u32 s85, s30, 429496730
  s_mul_i32 s12, s85, 10
  s_sub_u32 s100, s30, s12
  s_waitcnt lgkmcnt(0)
  s_lshl_b32 s12, s100, 1
  s_mul_hi_u32 s13, s12, 858993460
  s_mul_i32 s14, s13, 5
  s_sub_u32 s14, s12, s14
  s_mul_i32 s13, s13, s31
  s_add_u32 s13, s13, s85
  s_mul_i32 s13, s13, 5120
  s_lshl_b32 s14, s14, 10
  s_add_u32 s13, s13, s14
  s_add_u32 s13, s13, s84
  buffer_store_dwordx4 v[128:131], v2, s[8:11], s13 offen sc1
  s_lshl_b32 s12, s100, 1
  s_add_u32 s12, s12, 1
  s_mul_hi_u32 s13, s12, 858993460
  s_mul_i32 s14, s13, 5
  s_sub_u32 s14, s12, s14
  s_mul_i32 s13, s13, s31
  s_add_u32 s13, s13, s85
  s_mul_i32 s13, s13, 5120
  s_lshl_b32 s14, s14, 10
  s_add_u32 s13, s13, s14
  s_add_u32 s13, s13, s84
  buffer_store_dwordx4 v[132:135], v2, s[8:11], s13 offen sc1
  s_waitcnt vmcnt(18)
  ds_read_b64_tr_b16 v[136:137], v249 offset:10240
  ds_read_b64_tr_b16 v[138:139], v249 offset:11264
  ds_read_b64_tr_b16 v[140:141], v250 offset:10240
  ds_read_b64_tr_b16 v[142:143], v250 offset:11264
  s_add_u32 s30, s83, 5
  s_min_u32 s30, s30, 1479
  s_cmp_ge_u32 s30, 1080
  s_cselect_b32 s56, s68, s76
  s_cselect_b32 s57, s69, s77
  s_mov_b32 s58, 2211840
  s_cselect_b32 s58, 819200, s58
  s_cselect_b32 s31, 40, 108
  s_mov_b32 s84, 12499200
  s_cselect_b32 s84, 14711040, s84
  s_cselect_b32 s12, 1080, 0
  s_and_b32 s57, s57, 0xffff
  s_mov_b32 s59, 0x20000
  s_sub_u32 s30, s30, s12
  s_mul_hi_u32 s85, s30, 429496730
  s_mul_i32 s12, s85, 10
  s_sub_u32 s100, s30, s12
  s_waitcnt lgkmcnt(0)
  s_lshl_b32 s12, s100, 1
  s_mul_hi_u32 s13, s12, 858993460
  s_mul_i32 s14, s13, 5
  s_sub_u32 s14, s12, s14
  s_mul_i32 s13, s13, s31
  s_add_u32 s13, s13, s85
  s_mul_i32 s13, s13, 5120
  s_lshl_b32 s14, s14, 10
  s_add_u32 s13, s13, s14
  s_add_u32 s13, s13, s84
  buffer_store_dwordx4 v[136:139], v2, s[8:11], s13 offen sc1
  s_lshl_b32 s12, s100, 1
  s_add_u32 s12, s12, 1
  s_mul_hi_u32 s13, s12, 858993460
  s_mul_i32 s14, s13, 5
  s_sub_u32 s14, s12, s14
  s_mul_i32 s13, s13, s31
  s_add_u32 s13, s13, s85
  s_mul_i32 s13, s13, 5120
  s_lshl_b32 s14, s14, 10
  s_add_u32 s13, s13, s14
  s_add_u32 s13, s13, s84
  buffer_store_dwordx4 v[140:143], v2, s[8:11], s13 offen sc1
  s_waitcnt vmcnt(18)
  ds_read_b64_tr_b16 v[144:145], v249 offset:12288
  ds_read_b64_tr_b16 v[146:147], v249 offset:13312
  ds_read_b64_tr_b16 v[148:149], v250 offset:12288
  ds_read_b64_tr_b16 v[150:151], v250 offset:13312
  s_add_u32 s30, s83, 6
  s_min_u32 s30, s30, 1479
  s_cmp_ge_u32 s30, 1080
  s_cselect_b32 s56, s68, s76
  s_cselect_b32 s57, s69, s77
  s_mov_b32 s58, 2211840
  s_cselect_b32 s58, 819200, s58
  s_cselect_b32 s31, 40, 108
  s_mov_b32 s84, 12499200
  s_cselect_b32 s84, 14711040, s84
  s_cselect_b32 s12, 1080, 0
  s_and_b32 s57, s57, 0xffff
  s_mov_b32 s59, 0x20000
  s_sub_u32 s30, s30, s12
  s_mul_hi_u32 s85, s30, 429496730
  s_mul_i32 s12, s85, 10
  s_sub_u32 s100, s30, s12
  s_waitcnt lgkmcnt(0)
  s_lshl_b32 s12, s100, 1
  s_mul_hi_u32 s13, s12, 858993460
  s_mul_i32 s14, s13, 5
  s_sub_u32 s14, s12, s14
  s_mul_i32 s13, s13, s31
  s_add_u32 s13, s13, s85
  s_mul_i32 s13, s13, 5120
  s_lshl_b32 s14, s14, 10
  s_add_u32 s13, s13, s14
  s_add_u32 s13, s13, s84
  buffer_store_dwordx4 v[144:147], v2, s[8:11], s13 offen sc1
  s_lshl_b32 s12, s100, 1
  s_add_u32 s12, s12, 1
  s_mul_hi_u32 s13, s12, 858993460
  s_mul_i32 s14, s13, 5
  s_sub_u32 s14, s12, s14
  s_mul_i32 s13, s13, s31
  s_add_u32 s13, s13, s85
  s_mul_i32 s13, s13, 5120
  s_lshl_b32 s14, s14, 10
  s_add_u32 s13, s13, s14
  s_add_u32 s13, s13, s84
  buffer_store_dwordx4 v[148:151], v2, s[8:11], s13 offen sc1
  s_waitcnt vmcnt(18)
  ds_read_b64_tr_b16 v[152:153], v249 offset:14336
  ds_read_b64_tr_b16 v[154:155], v249 offset:15360
  ds_read_b64_tr_b16 v[156:157], v250 offset:14336
  ds_read_b64_tr_b16 v[158:159], v250 offset:15360
  s_add_u32 s30, s83, 7
  s_min_u32 s30, s30, 1479
  s_cmp_ge_u32 s30, 1080
  s_cselect_b32 s56, s68, s76
  s_cselect_b32 s57, s69, s77
  s_mov_b32 s58, 2211840
  s_cselect_b32 s58, 819200, s58
  s_cselect_b32 s31, 40, 108
  s_mov_b32 s84, 12499200
  s_cselect_b32 s84, 14711040, s84
  s_cselect_b32 s12, 1080, 0
  s_and_b32 s57, s57, 0xffff
  s_mov_b32 s59, 0x20000
  s_sub_u32 s30, s30, s12
  s_mul_hi_u32 s85, s30, 429496730
  s_mul_i32 s12, s85, 10
  s_sub_u32 s100, s30, s12
  s_waitcnt lgkmcnt(0)
  s_lshl_b32 s12, s100, 1
  s_mul_hi_u32 s13, s12, 858993460
  s_mul_i32 s14, s13, 5
  s_sub_u32 s14, s12, s14
  s_mul_i32 s13, s13, s31
  s_add_u32 s13, s13, s85
  s_mul_i32 s13, s13, 5120
  s_lshl_b32 s14, s14, 10
  s_add_u32 s13, s13, s14
  s_add_u32 s13, s13, s84
  buffer_store_dwordx4 v[152:155], v2, s[8:11], s13 offen sc1
  s_lshl_b32 s12, s100, 1
  s_add_u32 s12, s12, 1
  s_mul_hi_u32 s13, s12, 858993460
  s_mul_i32 s14, s13, 5
  s_sub_u32 s14, s12, s14
  s_mul_i32 s13, s13, s31
  s_add_u32 s13, s13, s85
  s_mul_i32 s13, s13, 5120
  s_lshl_b32 s14, s14, 10
  s_add_u32 s13, s13, s14
  s_add_u32 s13, s13, s84
  buffer_store_dwordx4 v[156:159], v2, s[8:11], s13 offen sc1
  s_waitcnt vmcnt(18)
  ds_read_b64_tr_b16 v[160:161], v249 offset:16384
  ds_read_b64_tr_b16 v[162:163], v249 offset:17408
  ds_read_b64_tr_b16 v[164:165], v250 offset:16384
  ds_read_b64_tr_b16 v[166:167], v250 offset:17408
  s_add_u32 s30, s83, 8
  s_min_u32 s30, s30, 1479
  s_cmp_ge_u32 s30, 1080
  s_cselect_b32 s56, s68, s76
  s_cselect_b32 s57, s69, s77
  s_mov_b32 s58, 2211840
  s_cselect_b32 s58, 819200, s58
  s_cselect_b32 s31, 40, 108
  s_mov_b32 s84, 12499200
  s_cselect_b32 s84, 14711040, s84
  s_cselect_b32 s12, 1080, 0
  s_and_b32 s57, s57, 0xffff
  s_mov_b32 s59, 0x20000
  s_sub_u32 s30, s30, s12
  s_mul_hi_u32 s85, s30, 429496730
  s_mul_i32 s12, s85, 10
  s_sub_u32 s100, s30, s12
  s_waitcnt lgkmcnt(0)
  s_lshl_b32 s12, s100, 1
  s_mul_hi_u32 s13, s12, 858993460
  s_mul_i32 s14, s13, 5
  s_sub_u32 s14, s12, s14
  s_mul_i32 s13, s13, s31
  s_add_u32 s13, s13, s85
  s_mul_i32 s13, s13, 5120
  s_lshl_b32 s14, s14, 10
  s_add_u32 s13, s13, s14
  s_add_u32 s13, s13, s84
  buffer_store_dwordx4 v[160:163], v2, s[8:11], s13 offen sc1
  s_lshl_b32 s12, s100, 1
  s_add_u32 s12, s12, 1
  s_mul_hi_u32 s13, s12, 858993460
  s_mul_i32 s14, s13, 5
  s_sub_u32 s14, s12, s14
  s_mul_i32 s13, s13, s31
  s_add_u32 s13, s13, s85
  s_mul_i32 s13, s13, 5120
  s_lshl_b32 s14, s14, 10
  s_add_u32 s13, s13, s14
  s_add_u32 s13, s13, s84
  buffer_store_dwordx4 v[164:167], v2, s[8:11], s13 offen sc1
  s_waitcnt vmcnt(18)
  ds_read_b64_tr_b16 v[168:169], v249 offset:18432
  ds_read_b64_tr_b16 v[170:171], v249 offset:19456
  ds_read_b64_tr_b16 v[172:173], v250 offset:18432
  ds_read_b64_tr_b16 v[174:175], v250 offset:19456
  s_add_u32 s30, s83, 9
  s_min_u32 s30, s30, 1479
  s_cmp_ge_u32 s30, 1080
  s_cselect_b32 s56, s68, s76
  s_cselect_b32 s57, s69, s77
  s_mov_b32 s58, 2211840
  s_cselect_b32 s58, 819200, s58
  s_cselect_b32 s31, 40, 108
  s_mov_b32 s84, 12499200
  s_cselect_b32 s84, 14711040, s84
  s_cselect_b32 s12, 1080, 0
  s_and_b32 s57, s57, 0xffff
  s_mov_b32 s59, 0x20000
  s_sub_u32 s30, s30, s12
  s_mul_hi_u32 s85, s30, 429496730
  s_mul_i32 s12, s85, 10
  s_sub_u32 s100, s30, s12
  s_waitcnt lgkmcnt(0)
  s_lshl_b32 s12, s100, 1
  s_mul_hi_u32 s13, s12, 858993460
  s_mul_i32 s14, s13, 5
  s_sub_u32 s14, s12, s14
  s_mul_i32 s13, s13, s31
  s_add_u32 s13, s13, s85
  s_mul_i32 s13, s13, 5120
  s_lshl_b32 s14, s14, 10
  s_add_u32 s13, s13, s14
  s_add_u32 s13, s13, s84
  buffer_store_dwordx4 v[168:171], v2, s[8:11], s13 offen sc1
  s_lshl_b32 s12, s100, 1
  s_add_u32 s12, s12, 1
  s_mul_hi_u32 s13, s12, 858993460
  s_mul_i32 s14, s13, 5
  s_sub_u32 s14, s12, s14
  s_mul_i32 s13, s13, s31
  s_add_u32 s13, s13, s85
  s_mul_i32 s13, s13, 5120
  s_lshl_b32 s14, s14, 10
  s_add_u32 s13, s13, s14
  s_add_u32 s13, s13, s84
  buffer_store_dwordx4 v[172:175], v2, s[8:11], s13 offen sc1
  s_mov_b64 exec, 1
  ds_add_u32 v92, v90 offset:40
  s_mov_b64 exec, -1
gated_mix__grouped_kv_mqa__geglu_ffn__prompt_kernel_sp_55:
  ds_read_b32 v91, v92 offset:40
  s_waitcnt lgkmcnt(0)
  v_readfirstlane_b32 s12, v91
  s_nop 0
  s_cmp_ge_u32 s12, 4
  s_cbranch_scc1 gated_mix__grouped_kv_mqa__geglu_ffn__prompt_kernel_sp_55_d
  s_sub_u32 s28, s28, 1
  s_cbranch_scc0 gated_mix__grouped_kv_mqa__geglu_ffn__prompt_kernel_sp_55
gated_mix__grouped_kv_mqa__geglu_ffn__prompt_kernel_sp_55_d:
  s_add_u32 m0, s20, 69632
  s_add_u32 s14, s21, 69632
  buffer_load_dwordx4 v2, s[24:27], s14 offen sc1 lds
  s_add_u32 m0, s20, 73728
  s_add_u32 s14, s21, 73728
  buffer_load_dwordx4 v2, s[24:27], s14 offen sc1 lds
  s_add_u32 m0, s20, 77824
  s_add_u32 s14, s21, 77824
  buffer_load_dwordx4 v2, s[24:27], s14 offen sc1 lds
  s_add_u32 m0, s20, 81920
  s_add_u32 s14, s21, 81920
  buffer_load_dwordx4 v2, s[24:27], s14 offen sc1 lds
  s_add_u32 m0, s20, 86016
  s_add_u32 s14, s21, 86016
  buffer_load_dwordx4 v2, s[24:27], s14 offen sc1 lds
  s_add_u32 m0, s20, 90112
  s_add_u32 s14, s21, 90112
  buffer_load_dwordx4 v2, s[24:27], s14 offen sc1 lds
  s_add_u32 m0, s20, 94208
  s_add_u32 s14, s21, 94208
  buffer_load_dwordx4 v2, s[24:27], s14 offen sc1 lds
  s_add_u32 m0, s20, 98304
  s_add_u32 s14, s21, 98304
  buffer_load_dwordx4 v2, s[24:27], s14 offen sc1 lds
  s_add_u32 m0, s20, 102400
  s_add_u32 s14, s21, 102400
  buffer_load_dwordx4 v2, s[24:27], s14 offen sc1 lds
  s_add_u32 m0, s20, 106496
  s_add_u32 s14, s21, 106496
  buffer_load_dwordx4 v2, s[24:27], s14 offen sc1 lds
  s_add_u32 m0, s20, 110592
  s_add_u32 s14, s21, 110592
  buffer_load_dwordx4 v2, s[24:27], s14 offen sc1 lds
  s_add_u32 m0, s20, 114688
  s_add_u32 s14, s21, 114688
  buffer_load_dwordx4 v2, s[24:27], s14 offen sc1 lds
  s_add_u32 m0, s20, 118784
  s_add_u32 s14, s21, 118784
  buffer_load_dwordx4 v2, s[24:27], s14 offen sc1 lds
  s_add_u32 m0, s20, 122880
  s_add_u32 s14, s21, 122880
  buffer_load_dwordx4 v2, s[24:27], s14 offen sc1 lds
  s_add_u32 m0, s20, 126976
  s_add_u32 s14, s21, 126976
  buffer_load_dwordx4 v2, s[24:27], s14 offen sc1 lds
  s_add_u32 m0, s20, 131072
  s_add_u32 s14, s21, 131072
  buffer_load_dwordx4 v2, s[24:27], s14 offen sc1 lds
  s_add_u32 m0, s20, 135168
  s_add_u32 s14, s21, 135168
  buffer_load_dwordx4 v2, s[24:27], s14 offen sc1 lds
  s_add_u32 m0, s20, 139264
  s_add_u32 s14, s21, 139264
  buffer_load_dwordx4 v2, s[24:27], s14 offen sc1 lds
  s_add_u32 m0, s20, 143360
  s_add_u32 s14, s21, 143360
  buffer_load_dwordx4 v2, s[24:27], s14 offen sc1 lds
  s_add_u32 m0, s20, 147456
  s_add_u32 s14, s21, 147456
  buffer_load_dwordx4 v2, s[24:27], s14 offen sc1 lds
  s_add_u32 m0, s20, 151552
  s_add_u32 s14, s21, 151552
  buffer_load_dwordx4 v2, s[24:27], s14 offen sc1 lds
  s_add_u32 m0, s20, 155648
  s_add_u32 s14, s21, 155648
  buffer_load_dwordx4 v2, s[24:27], s14 offen sc1 lds
  s_waitcnt vmcnt(0)
  s_mov_b64 exec, 1
  ds_add_u32 v92, v90 offset:12
  s_mov_b64 exec, -1
  s_mov_b64 exec, 1
  ds_add_u32 v92, v90 offset:60
  s_mov_b64 exec, -1
gated_mix__grouped_kv_mqa__geglu_ffn__prompt_kernel_pubh:
  s_mul_i32 s12, s19, 27
  s_lshr_b32 s12, s12, 2
  v_and_b32 v10, 7, v1
  v_add_u32 v10, s12, v10
  v_min_u32 v10, 26, v10
  v_lshlrev_b32 v11, 2, v10
  s_lshr_b32 s13, s4, 3
  s_lshl_b32 s13, s13, 7
  s_add_u32 s13, s13, s5
  s_add_u32 s13, s13, 20805888
  s_mul_i32 s12, s19, 27
  s_mul_i32 s21, s4, 108
  s_add_u32 s21, s21, s12
  s_lshl_b32 s21, s21, 10
  s_add_u32 s21, s21, 0
  s_mov_b32 s16, s13
  v_mov_b32 v15, v11
  buffer_load_dword v12, v13, s[8:11], s18 offen sc1
  s_waitcnt vmcnt(0)
  s_mov_b64 exec, 1
  ds_add_rtn_u32 v10, v92, v90 offset:44
  s_mov_b64 exec, -1
  s_lshl_b32 s13, s88, 5
  s_add_u32 s13, s13, s89
  s_lshl_b32 s13, s13, 2
  s_add_u32 s13, s13, 20805888
  s_lshl_b32 s14, s89, 2
  s_add_u32 s14, s14, 20807828
  s_cmp_ge_u32 s89, 27
  s_cselect_b32 s13, s14, s13
  v_mov_b32 v11, s29
  s_waitcnt lgkmcnt(0)
  v_readfirstlane_b32 s12, v10
  s_nop 0
  s_cmp_lg_u32 s12, 3
  s_cbranch_scc1 gated_mix__grouped_kv_mqa__geglu_ffn__prompt_kernel_ph1
  s_mov_b64 exec, 0xff
  buffer_store_dword v11, v95, s[8:11], s13 offen sc1
  s_mov_b64 exec, -1
gated_mix__grouped_kv_mqa__geglu_ffn__prompt_kernel_ph1:
  v_cmp_ne_u32 vcc, s29, v12
  s_nop 4
  s_cbranch_vccz gated_mix__grouped_kv_mqa__geglu_ffn__prompt_kernel_rpd
gated_mix__grouped_kv_mqa__geglu_ffn__prompt_kernel_rp:
  buffer_load_dword v12, v13, s[8:11], s18 offen sc1
  s_waitcnt vmcnt(0)
  v_cmp_ne_u32 vcc, s29, v12
  s_nop 4
  s_cbranch_vccz gated_mix__grouped_kv_mqa__geglu_ffn__prompt_kernel_rpd
  s_sleep 6
  s_sub_u32 s28, s28, 1
  s_cbranch_scc0 gated_mix__grouped_kv_mqa__geglu_ffn__prompt_kernel_rp
gated_mix__grouped_kv_mqa__geglu_ffn__prompt_kernel_rpd:
  s_mov_b32 s13, s16
  v_mov_b32 v11, v15
  v_lshlrev_b32 v10, 2, v4
  s_lshl_b32 s14, s4, 7
  s_add_u32 s14, s14, 9869568
  buffer_load_dword v6, v10, s[8:11], s14 offen sc1
  s_cmp_lg_u32 s86, 0
  s_cbranch_scc1 gated_mix__grouped_kv_mqa__geglu_ffn__prompt_kernel_pre1
  buffer_load_dwordx4 v[20:23], v2, s[8:11], s87 offen offset:0 sc1
  buffer_load_dwordx4 v[24:27], v2, s[8:11], s87 offen offset:1024 sc1
  buffer_load_dwordx4 v[28:31], v2, s[8:11], s87 offen offset:2048 sc1
  buffer_load_dwordx4 v[32:35], v2, s[8:11], s87 offen offset:3072 sc1
  s_add_u32 s12, s87, 4096
  buffer_load_dwordx4 v[36:39], v2, s[8:11], s12 offen sc1
  s_add_u32 s87, s87, 5120
  buffer_load_dwordx4 v[44:47], v2, s[8:11], s87 offen offset:0 sc1
  buffer_load_dwordx4 v[48:51], v2, s[8:11], s87 offen offset:1024 sc1
  buffer_load_dwordx4 v[52:55], v2, s[8:11], s87 offen offset:2048 sc1
  buffer_load_dwordx4 v[56:59], v2, s[8:11], s87 offen offset:3072 sc1
  s_add_u32 s12, s87, 4096
  buffer_load_dwordx4 v[60:63], v2, s[8:11], s12 offen sc1
  s_add_u32 s87, s87, 5120
  buffer_load_dwordx4 v[68:71], v2, s[8:11], s87 offen offset:0 sc1
  buffer_load_dwordx4 v[72:75], v2, s[8:11], s87 offen offset:1024 sc1
  buffer_load_dwordx4 v[76:79], v2, s[8:11], s87 offen offset:2048 sc1
  buffer_load_dwordx4 v[80:83], v2, s[8:11], s87 offen offset:3072 sc1
  s_add_u32 s12, s87, 4096
  buffer_load_dwordx4 v[84:87], v2, s[8:11], s12 offen sc1
  s_add_u32 s87, s87, 5120
gated_mix__grouped_kv_mqa__geglu_ffn__prompt_kernel_pre1:
  buffer_load_dwordx4 v[180:183], v2, s[8:11], s87 offen offset:0 sc1
  buffer_load_dwordx4 v[184:187], v2, s[8:11], s87 offen offset:1024 sc1
  buffer_load_dwordx4 v[188:191], v2, s[8:11], s87 offen offset:2048 sc1
  buffer_load_dwordx4 v[192:195], v2, s[8:11], s87 offen offset:3072 sc1
  s_add_u32 s12, s87, 4096
  buffer_load_dwordx4 v[196:199], v2, s[8:11], s12 offen sc1
  s_add_u32 s87, s87, 5120
  buffer_load_dwordx4 v[204:207], v2, s[8:11], s87 offen offset:0 sc1
  buffer_load_dwordx4 v[208:211], v2, s[8:11], s87 offen offset:1024 sc1
  buffer_load_dwordx4 v[212:215], v2, s[8:11], s87 offen offset:2048 sc1
  buffer_load_dwordx4 v[216:219], v2, s[8:11], s87 offen offset:3072 sc1
  s_add_u32 s12, s87, 4096
  buffer_load_dwordx4 v[220:223], v2, s[8:11], s12 offen sc1
  s_add_u32 s87, s87, 5120
  buffer_load_dwordx4 v[228:231], v2, s[8:11], s87 offen offset:0 sc1
  buffer_load_dwordx4 v[232:235], v2, s[8:11], s87 offen offset:1024 sc1
  buffer_load_dwordx4 v[236:239], v2, s[8:11], s87 offen offset:2048 sc1
  buffer_load_dwordx4 v[240:243], v2, s[8:11], s87 offen offset:3072 sc1
  s_add_u32 s12, s87, 4096
  buffer_load_dwordx4 v[244:247], v2, s[8:11], s12 offen sc1
  s_add_u32 s87, s87, 5120
  s_mul_i32 s12, s19, 10
  s_mul_i32 s90, s22, 40
  s_add_u32 s90, s90, s12
  s_mul_i32 s90, s90, 5120
  s_add_u32 s90, s90, 14711040
  s_mul_i32 s91, s4, 40
  s_add_u32 s91, s91, s12
  s_lshl_b32 s91, s91, 10
  s_add_u32 s91, s91, 9877760
  v_and_b32 v10, 3, v1
  v_lshlrev_b32 v10, 2, v10
  v_add_u32 v10, 163776, v10
  v_mov_b32 v12, 84992
gated_mix__grouped_kv_mqa__geglu_ffn__prompt_kernel_pw_56:
  ds_read_b32 v14, v10
  s_waitcnt lgkmcnt(0)
  v_cmp_lt_u32 vcc, v14, v12
  s_nop 4
  s_cbranch_vccz gated_mix__grouped_kv_mqa__geglu_ffn__prompt_kernel_pw_56_d
  s_sleep 8
  s_sub_u32 s28, s28, 1
  s_cbranch_scc0 gated_mix__grouped_kv_mqa__geglu_ffn__prompt_kernel_pw_56
gated_mix__grouped_kv_mqa__geglu_ffn__prompt_kernel_pw_56_d:
  s_mul_i32 s14, s19, 20480
  s_add_u32 m0, s14, 0
  s_add_u32 s12, s90, 30720
  buffer_load_dwordx4 v2, s[8:11], s12 offen offset:0 sc1 lds
  buffer_load_dwordx4 v2, s[8:11], s12 offen offset:1024 sc1 lds
  buffer_load_dwordx4 v2, s[8:11], s12 offen offset:2048 sc1 lds
  buffer_load_dwordx4 v2, s[8:11], s12 offen offset:3072 sc1 lds
  s_add_u32 m0, s14, 4096
  s_add_u32 s12, s90, 34816
  buffer_load_dwordx4 v2, s[8:11], s12 offen offset:0 sc1 lds
  buffer_load_dwordx4 v2, s[8:11], s12 offen offset:1024 sc1 lds
  buffer_load_dwordx4 v2, s[8:11], s12 offen offset:2048 sc1 lds
  buffer_load_dwordx4 v2, s[8:11], s12 offen offset:3072 sc1 lds
  s_add_u32 m0, s14, 8192
  s_add_u32 s12, s90, 38912
  buffer_load_dwordx4 v2, s[8:11], s12 offen offset:0 sc1 lds
  buffer_load_dwordx4 v2, s[8:11], s12 offen offset:1024 sc1 lds
  buffer_load_dwordx4 v2, s[8:11], s12 offen offset:2048 sc1 lds
  buffer_load_dwordx4 v2, s[8:11], s12 offen offset:3072 sc1 lds
  s_add_u32 m0, s14, 12288
  s_add_u32 s12, s90, 43008
  buffer_load_dwordx4 v2, s[8:11], s12 offen offset:0 sc1 lds
  buffer_load_dwordx4 v2, s[8:11], s12 offen offset:1024 sc1 lds
  buffer_load_dwordx4 v2, s[8:11], s12 offen offset:2048 sc1 lds
  buffer_load_dwordx4 v2, s[8:11], s12 offen offset:3072 sc1 lds
  s_add_u32 m0, s14, 16384
  s_add_u32 s12, s90, 47104
  buffer_load_dwordx4 v2, s[8:11], s12 offen offset:0 sc1 lds
  buffer_load_dwordx4 v2, s[8:11], s12 offen offset:1024 sc1 lds
  buffer_load_dwordx4 v2, s[8:11], s12 offen offset:2048 sc1 lds
  buffer_load_dwordx4 v2, s[8:11], s12 offen offset:3072 sc1 lds
  s_mul_i32 s14, s19, 20480
  v_add_u32 v13, s14, v2
  s_mov_b32 s100, s13
  s_mul_i32 s99, s19, 27
  s_and_b32 s99, s99, 3
  s_mov_b32 s98, 0
  s_mov_b32 s14, 0xff
gated_mix__grouped_kv_mqa__geglu_ffn__prompt_kernel_nd_57:
  s_andn2_b32 s15, s14, s98
  s_cbranch_scc0 gated_mix__grouped_kv_mqa__geglu_ffn__prompt_kernel_nd_57d
  buffer_load_dword v12, v11, s[8:11], s100 offen sc1
  s_waitcnt vmcnt(0)
  v_cmp_eq_u32 vcc, s29, v12
  s_nop 1
  s_and_b32 s98, vcc_lo, 0xff
  s_andn2_b32 s15, s14, s98
  s_cbranch_scc0 gated_mix__grouped_kv_mqa__geglu_ffn__prompt_kernel_nd_57d
  s_sleep 4
  s_sub_u32 s28, s28, 1
  s_cbranch_scc0 gated_mix__grouped_kv_mqa__geglu_ffn__prompt_kernel_nd_57
gated_mix__grouped_kv_mqa__geglu_ffn__prompt_kernel_nd_57d:
  buffer_load_dwordx4 v[16:19], v2, s[8:11], s21 offen sc1
  s_add_u32 s21, s21, 1024
  buffer_load_dwordx4 v[40:43], v2, s[8:11], s21 offen sc1
  s_add_u32 s21, s21, 1024
  buffer_load_dwordx4 v[64:67], v2, s[8:11], s21 offen sc1
  s_add_u32 s21, s21, 1024
  buffer_load_dwordx4 v[176:179], v2, s[8:11], s21 offen sc1
  s_add_u32 s21, s21, 1024
  buffer_load_dwordx4 v[200:203], v2, s[8:11], s21 offen sc1
  s_add_u32 s21, s21, 1024
  buffer_load_dwordx4 v[224:227], v2, s[8:11], s21 offen sc1
  s_add_u32 s21, s21, 1024
  s_waitcnt vmcnt(5)
  v_mfma_f32_32x32x16_bf16 v[96:111], v[20:23], v[16:19], 0
  v_mfma_f32_32x32x16_bf16 v[112:127], v[24:27], v[16:19], 0
  v_mfma_f32_32x32x16_bf16 v[128:143], v[28:31], v[16:19], 0
  v_mfma_f32_32x32x16_bf16 v[144:159], v[32:35], v[16:19], 0
  v_mfma_f32_32x32x16_bf16 v[160:175], v[36:39], v[16:19], 0
  buffer_load_dwordx4 v[20:23], v2, s[8:11], s87 offen offset:0 sc1
  buffer_load_dwordx4 v[24:27], v2, s[8:11], s87 offen offset:1024 sc1
  buffer_load_dwordx4 v[28:31], v2, s[8:11], s87 offen offset:2048 sc1
  buffer_load_dwordx4 v[32:35], v2, s[8:11], s87 offen offset:3072 sc1
  s_add_u32 s12, s87, 4096
  buffer_load_dwordx4 v[36:39], v2, s[8:11], s12 offen sc1
  s_add_u32 s87, s87, 5120
  buffer_load_dwordx4 v[16:19], v2, s[8:11], s21 offen sc1
  s_add_u32 s21, s21, 1024
  s_waitcnt vmcnt(10)
  v_mfma_f32_32x32x16_bf16 v[96:111], v[44:47], v[40:43], v[96:111]
  v_mfma_f32_32x32x16_bf16 v[112:127], v[48:51], v[40:43], v[112:127]
  v_mfma_f32_32x32x16_bf16 v[128:143], v[52:55], v[40:43], v[128:143]
  v_mfma_f32_32x32x16_bf16 v[144:159], v[56:59], v[40:43], v[144:159]
  v_mfma_f32_32x32x16_bf16 v[160:175], v[60:63], v[40:43], v[160:175]
  buffer_load_dwordx4 v[44:47], v2, s[8:11], s87 offen offset:0 sc1
  buffer_load_dwordx4 v[48:51], v2, s[8:11], s87 offen offset:1024 sc1
  buffer_load_dwordx4 v[52:55], v2, s[8:11], s87 offen offset:2048 sc1
  buffer_load_dwordx4 v[56:59], v2, s[8:11], s87 offen offset:3072 sc1
  s_add_u32 s12, s87, 4096
  buffer_load_dwordx4 v[60:63], v2, s[8:11], s12 offen sc1
  s_add_u32 s87, s87, 5120
  buffer_load_dwordx4 v[40:43], v2, s[8:11], s21 offen sc1
  s_add_u32 s21, s21, 1024
  s_waitcnt vmcnt(15)
  v_mfma_f32_32x32x16_bf16 v[96:111], v[68:71], v[64:67], v[96:111]
  v_mfma_f32_32x32x16_bf16 v[112:127], v[72:75], v[64:67], v[112:127]
  v_mfma_f32_32x32x16_bf16 v[128:143], v[76:79], v[64:67], v[128:143]
  v_mfma_f32_32x32x16_bf16 v[144:159], v[80:83], v[64:67], v[144:159]
  v_mfma_f32_32x32x16_bf16 v[160:175], v[84:87], v[64:67], v[160:175]
  buffer_load_dwordx4 v[68:71], v2, s[8:11], s87 offen offset:0 sc1
  buffer_load_dwordx4 v[72:75], v2, s[8:11], s87 offen offset:1024 sc1
  buffer_load_dwordx4 v[76:79], v2, s[8:11], s87 offen offset:2048 sc1
  buffer_load_dwordx4 v[80:83], v2, s[8:11], s87 offen offset:3072 sc1
  s_add_u32 s12, s87, 4096
  buffer_load_dwordx4 v[84:87], v2, s[8:11], s12 offen sc1
  s_add_u32 s87, s87, 5120
  buffer_load_dwordx4 v[64:67], v2, s[8:11], s21 offen sc1
  s_add_u32 s21, s21, 1024
  s_waitcnt vmcnt(20)
  v_mfma_f32_32x32x16_bf16 v[96:111], v[180:183], v[176:179], v[96:111]
  v_mfma_f32_32x32x16_bf16 v[112:127], v[184:187], v[176:179], v[112:127]
  v_mfma_f32_32x32x16_bf16 v[128:143], v[188:191], v[176:179], v[128:143]
  v_mfma_f32_32x32x16_bf16 v[144:159], v[192:195], v[176:179], v[144:159]
  v_mfma_f32_32x32x16_bf16 v[160:175], v[196:199], v[176:179], v[160:175]
  buffer_load_dwordx4 v[180:183], v2, s[8:11], s87 offen offset:0 sc1
  buffer_load_dwordx4 v[184:187], v2, s[8:11], s87 offen offset:1024 sc1
  buffer_load_dwordx4 v[188:191], v2, s[8:11], s87 offen offset:2048 sc1
  buffer_load_dwordx4 v[192:195], v2, s[8:11], s87 offen offset:3072 sc1
  s_add_u32 s12, s87, 4096
  buffer_load_dwordx4 v[196:199], v2, s[8:11], s12 offen sc1
  s_add_u32 s87, s87, 5120
  buffer_load_dwordx4 v[176:179], v2, s[8:11], s21 offen sc1
  s_add_u32 s21, s21, 1024
  s_waitcnt vmcnt(25)
  v_mfma_f32_32x32x16_bf16 v[96:111], v[204:207], v[200:203], v[96:111]
  v_mfma_f32_32x32x16_bf16 v[112:127], v[208:211], v[200:203], v[112:127]
  v_mfma_f32_32x32x16_bf16 v[128:143], v[212:215], v[200:203], v[128:143]
  v_mfma_f32_32x32x16_bf16 v[144:159], v[216:219], v[200:203], v[144:159]
  v_mfma_f32_32x32x16_bf16 v[160:175], v[220:223], v[200:203], v[160:175]
  buffer_load_dwordx4 v[204:207], v2, s[8:11], s87 offen offset:0 sc1
  buffer_load_dwordx4 v[208:211], v2, s[8:11], s87 offen offset:1024 sc1
  buffer_load_dwordx4 v[212:215], v2, s[8:11], s87 offen offset:2048 sc1
  buffer_load_dwordx4 v[216:219], v2, s[8:11], s87 offen offset:3072 sc1
  s_add_u32 s12, s87, 4096
  buffer_load_dwordx4 v[220:223], v2, s[8:11], s12 offen sc1
  s_add_u32 s87, s87, 5120
  buffer_load_dwordx4 v[200:203], v2, s[8:11], s21 offen sc1
  s_add_u32 s21, s21, 1024
  s_waitcnt vmcnt(30)
  v_mfma_f32_32x32x16_bf16 v[96:111], v[228:231], v[224:227], v[96:111]
  v_mfma_f32_32x32x16_bf16 v[112:127], v[232:235], v[224:227], v[112:127]
  v_mfma_f32_32x32x16_bf16 v[128:143], v[236:239], v[224:227], v[128:143]
  v_mfma_f32_32x32x16_bf16 v[144:159], v[240:243], v[224:227], v[144:159]
  v_mfma_f32_32x32x16_bf16 v[160:175], v[244:247], v[224:227], v[160:175]
  buffer_load_dwordx4 v[228:231], v2, s[8:11], s87 offen offset:0 sc1
  buffer_load_dwordx4 v[232:235], v2, s[8:11], s87 offen offset:1024 sc1
  buffer_load_dwordx4 v[236:239], v2, s[8:11], s87 offen offset:2048 sc1
  buffer_load_dwordx4 v[240:243], v2, s[8:11], s87 offen offset:3072 sc1
  s_add_u32 s12, s87, 4096
  buffer_load_dwordx4 v[244:247], v2, s[8:11], s12 offen sc1
  s_add_u32 s87, s87, 5120
  buffer_load_dwordx4 v[224:227], v2, s[8:11], s21 offen sc1
  s_add_u32 s21, s21, 1024
  s_waitcnt vmcnt(30)
  v_mfma_f32_32x32x16_bf16 v[96:111], v[20:23], v[16:19], v[96:111]
  v_mfma_f32_32x32x16_bf16 v[112:127], v[24:27], v[16:19], v[112:127]
  v_mfma_f32_32x32x16_bf16 v[128:143], v[28:31], v[16:19], v[128:143]
  v_mfma_f32_32x32x16_bf16 v[144:159], v[32:35], v[16:19], v[144:159]
  v_mfma_f32_32x32x16_bf16 v[160:175], v[36:39], v[16:19], v[160:175]
  buffer_load_dwordx4 v[20:23], v2, s[8:11], s87 offen offset:0 sc1
  buffer_load_dwordx4 v[24:27], v2, s[8:11], s87 offen offset:1024 sc1
  buffer_load_dwordx4 v[28:31], v2, s[8:11], s87 offen offset:2048 sc1
  buffer_load_dwordx4 v[32:35], v2, s[8:11], s87 offen offset:3072 sc1
  s_add_u32 s12, s87, 4096
  buffer_load_dwordx4 v[36:39], v2, s[8:11], s12 offen sc1
  s_add_u32 s87, s87, 5120
  buffer_load_dwordx4 v[16:19], v2, s[8:11], s21 offen sc1
  s_add_u32 s21, s21, 1024
  s_waitcnt vmcnt(30)
  v_mfma_f32_32x32x16_bf16 v[96:111], v[44:47], v[40:43], v[96:111]
  v_mfma_f32_32x32x16_bf16 v[112:127], v[48:51], v[40:43], v[112:127]
  v_mfma_f32_32x32x16_bf16 v[128:143], v[52:55], v[40:43], v[128:143]
  v_mfma_f32_32x32x16_bf16 v[144:159], v[56:59], v[40:43], v[144:159]
  v_mfma_f32_32x32x16_bf16 v[160:175], v[60:63], v[40:43], v[160:175]
  buffer_load_dwordx4 v[44:47], v2, s[8:11], s87 offen offset:0 sc1
  buffer_load_dwordx4 v[48:51], v2, s[8:11], s87 offen offset:1024 sc1
  buffer_load_dwordx4 v[52:55], v2, s[8:11], s87 offen offset:2048 sc1
  buffer_load_dwordx4 v[56:59], v2, s[8:11], s87 offen offset:3072 sc1
  s_add_u32 s12, s87, 4096
  buffer_load_dwordx4 v[60:63], v2, s[8:11], s12 offen sc1
  s_add_u32 s87, s87, 5120
  buffer_load_dwordx4 v[40:43], v2, s[8:11], s21 offen sc1
  s_add_u32 s21, s21, 1024
  s_waitcnt vmcnt(30)
  v_mfma_f32_32x32x16_bf16 v[96:111], v[68:71], v[64:67], v[96:111]
  v_mfma_f32_32x32x16_bf16 v[112:127], v[72:75], v[64:67], v[112:127]
  v_mfma_f32_32x32x16_bf16 v[128:143], v[76:79], v[64:67], v[128:143]
  v_mfma_f32_32x32x16_bf16 v[144:159], v[80:83], v[64:67], v[144:159]
  v_mfma_f32_32x32x16_bf16 v[160:175], v[84:87], v[64:67], v[160:175]
  buffer_load_dwordx4 v[68:71], v2, s[8:11], s87 offen offset:0 sc1
  buffer_load_dwordx4 v[72:75], v2, s[8:11], s87 offen offset:1024 sc1
  buffer_load_dwordx4 v[76:79], v2, s[8:11], s87 offen offset:2048 sc1
  buffer_load_dwordx4 v[80:83], v2, s[8:11], s87 offen offset:3072 sc1
  s_add_u32 s12, s87, 4096
  buffer_load_dwordx4 v[84:87], v2, s[8:11], s12 offen sc1
  s_add_u32 s87, s87, 5120
  buffer_load_dwordx4 v[64:67], v2, s[8:11], s21 offen sc1
  s_add_u32 s21, s21, 1024
  s_waitcnt vmcnt(30)
  v_mfma_f32_32x32x16_bf16 v[96:111], v[180:183], v[176:179], v[96:111]
  v_mfma_f32_32x32x16_bf16 v[112:127], v[184:187], v[176:179], v[112:127]
  v_mfma_f32_32x32x16_bf16 v[128:143], v[188:191], v[176:179], v[128:143]
  v_mfma_f32_32x32x16_bf16 v[144:159], v[192:195], v[176:179], v[144:159]
  v_mfma_f32_32x32x16_bf16 v[160:175], v[196:199], v[176:179], v[160:175]
  buffer_load_dwordx4 v[180:183], v2, s[8:11], s87 offen offset:0 sc1
  buffer_load_dwordx4 v[184:187], v2, s[8:11], s87 offen offset:1024 sc1
  buffer_load_dwordx4 v[188:191], v2, s[8:11], s87 offen offset:2048 sc1
  buffer_load_dwordx4 v[192:195], v2, s[8:11], s87 offen offset:3072 sc1
  s_add_u32 s12, s87, 4096
  buffer_load_dwordx4 v[196:199], v2, s[8:11], s12 offen sc1
  s_add_u32 s87, s87, 5120
  buffer_load_dwordx4 v[176:179], v2, s[8:11], s21 offen sc1
  s_add_u32 s21, s21, 1024
  s_waitcnt vmcnt(30)
  v_mfma_f32_32x32x16_bf16 v[96:111], v[204:207], v[200:203], v[96:111]
  v_mfma_f32_32x32x16_bf16 v[112:127], v[208:211], v[200:203], v[112:127]
  v_mfma_f32_32x32x16_bf16 v[128:143], v[212:215], v[200:203], v[128:143]
  v_mfma_f32_32x32x16_bf16 v[144:159], v[216:219], v[200:203], v[144:159]
  v_mfma_f32_32x32x16_bf16 v[160:175], v[220:223], v[200:203], v[160:175]
  buffer_load_dwordx4 v[204:207], v2, s[8:11], s87 offen offset:0 sc1
  buffer_load_dwordx4 v[208:211], v2, s[8:11], s87 offen offset:1024 sc1
  buffer_load_dwordx4 v[212:215], v2, s[8:11], s87 offen offset:2048 sc1
  buffer_load_dwordx4 v[216:219], v2, s[8:11], s87 offen offset:3072 sc1
  s_add_u32 s12, s87, 4096
  buffer_load_dwordx4 v[220:223], v2, s[8:11], s12 offen sc1
  s_add_u32 s87, s87, 5120
  buffer_load_dwordx4 v[200:203], v2, s[8:11], s21 offen sc1
  s_add_u32 s21, s21, 1024
  s_waitcnt vmcnt(30)
  v_mfma_f32_32x32x16_bf16 v[96:111], v[228:231], v[224:227], v[96:111]
  v_mfma_f32_32x32x16_bf16 v[112:127], v[232:235], v[224:227], v[112:127]
  v_mfma_f32_32x32x16_bf16 v[128:143], v[236:239], v[224:227], v[128:143]
  v_mfma_f32_32x32x16_bf16 v[144:159], v[240:243], v[224:227], v[144:159]
  v_mfma_f32_32x32x16_bf16 v[160:175], v[244:247], v[224:227], v[160:175]
  buffer_load_dwordx4 v[228:231], v2, s[8:11], s87 offen offset:0 sc1
  buffer_load_dwordx4 v[232:235], v2, s[8:11], s87 offen offset:1024 sc1
  buffer_load_dwordx4 v[236:239], v2, s[8:11], s87 offen offset:2048 sc1
  buffer_load_dwordx4 v[240:243], v2, s[8:11], s87 offen offset:3072 sc1
  s_add_u32 s12, s87, 4096
  buffer_load_dwordx4 v[244:247], v2, s[8:11], s12 offen sc1
  s_add_u32 s87, s87, 5120
  buffer_load_dwordx4 v[224:227], v2, s[8:11], s21 offen sc1
  s_add_u32 s21, s21, 1024
  s_waitcnt vmcnt(30)
  v_mfma_f32_32x32x16_bf16 v[96:111], v[20:23], v[16:19], v[96:111]
  v_mfma_f32_32x32x16_bf16 v[112:127], v[24:27], v[16:19], v[112:127]
  v_mfma_f32_32x32x16_bf16 v[128:143], v[28:31], v[16:19], v[128:143]
  v_mfma_f32_32x32x16_bf16 v[144:159], v[32:35], v[16:19], v[144:159]
  v_mfma_f32_32x32x16_bf16 v[160:175], v[36:39], v[16:19], v[160:175]
  buffer_load_dwordx4 v[20:23], v2, s[8:11], s87 offen offset:0 sc1
  buffer_load_dwordx4 v[24:27], v2, s[8:11], s87 offen offset:1024 sc1
  buffer_load_dwordx4 v[28:31], v2, s[8:11], s87 offen offset:2048 sc1
  buffer_load_dwordx4 v[32:35], v2, s[8:11], s87 offen offset:3072 sc1
  s_add_u32 s12, s87, 4096
  buffer_load_dwordx4 v[36:39], v2, s[8:11], s12 offen sc1
  s_add_u32 s87, s87, 5120
  buffer_load_dwordx4 v[16:19], v2, s[8:11], s21 offen sc1
  s_add_u32 s21, s21, 1024
  s_waitcnt vmcnt(30)
  v_mfma_f32_32x32x16_bf16 v[96:111], v[44:47], v[40:43], v[96:111]
  v_mfma_f32_32x32x16_bf16 v[112:127], v[48:51], v[40:43], v[112:127]
  v_mfma_f32_32x32x16_bf16 v[128:143], v[52:55], v[40:43], v[128:143]
  v_mfma_f32_32x32x16_bf16 v[144:159], v[56:59], v[40:43], v[144:159]
  v_mfma_f32_32x32x16_bf16 v[160:175], v[60:63], v[40:43], v[160:175]
  buffer_load_dwordx4 v[44:47], v2, s[8:11], s87 offen offset:0 sc1
  buffer_load_dwordx4 v[48:51], v2, s[8:11], s87 offen offset:1024 sc1
  buffer_load_dwordx4 v[52:55], v2, s[8:11], s87 offen offset:2048 sc1
  buffer_load_dwordx4 v[56:59], v2, s[8:11], s87 offen offset:3072 sc1
  s_add_u32 s12, s87, 4096
  buffer_load_dwordx4 v[60:63], v2, s[8:11], s12 offen sc1
  s_add_u32 s87, s87, 5120
  buffer_load_dwordx4 v[40:43], v2, s[8:11], s21 offen sc1
  s_add_u32 s21, s21, 1024
  s_waitcnt vmcnt(30)
  v_mfma_f32_32x32x16_bf16 v[96:111], v[68:71], v[64:67], v[96:111]
  v_mfma_f32_32x32x16_bf16 v[112:127], v[72:75], v[64:67], v[112:127]
  v_mfma_f32_32x32x16_bf16 v[128:143], v[76:79], v[64:67], v[128:143]
  v_mfma_f32_32x32x16_bf16 v[144:159], v[80:83], v[64:67], v[144:159]
  v_mfma_f32_32x32x16_bf16 v[160:175], v[84:87], v[64:67], v[160:175]
  buffer_load_dwordx4 v[68:71], v2, s[8:11], s87 offen offset:0 sc1
  buffer_load_dwordx4 v[72:75], v2, s[8:11], s87 offen offset:1024 sc1
  buffer_load_dwordx4 v[76:79], v2, s[8:11], s87 offen offset:2048 sc1
  buffer_load_dwordx4 v[80:83], v2, s[8:11], s87 offen offset:3072 sc1
  s_add_u32 s12, s87, 4096
  buffer_load_dwordx4 v[84:87], v2, s[8:11], s12 offen sc1
  s_add_u32 s87, s87, 5120
  buffer_load_dwordx4 v[64:67], v2, s[8:11], s21 offen sc1
  s_add_u32 s21, s21, 1024
  s_waitcnt vmcnt(30)
  v_mfma_f32_32x32x16_bf16 v[96:111], v[180:183], v[176:179], v[96:111]
  v_mfma_f32_32x32x16_bf16 v[112:127], v[184:187], v[176:179], v[112:127]
  v_mfma_f32_32x32x16_bf16 v[128:143], v[188:191], v[176:179], v[128:143]
  v_mfma_f32_32x32x16_bf16 v[144:159], v[192:195], v[176:179], v[144:159]
  v_mfma_f32_32x32x16_bf16 v[160:175], v[196:199], v[176:179], v[160:175]
  buffer_load_dwordx4 v[180:183], v2, s[8:11], s87 offen offset:0 sc1
  buffer_load_dwordx4 v[184:187], v2, s[8:11], s87 offen offset:1024 sc1
  buffer_load_dwordx4 v[188:191], v2, s[8:11], s87 offen offset:2048 sc1
  buffer_load_dwordx4 v[192:195], v2, s[8:11], s87 offen offset:3072 sc1
  s_add_u32 s12, s87, 4096
  buffer_load_dwordx4 v[196:199], v2, s[8:11], s12 offen sc1
  s_add_u32 s87, s87, 5120
  buffer_load_dwordx4 v[176:179], v2, s[8:11], s21 offen sc1
  s_add_u32 s21, s21, 1024
  s_waitcnt vmcnt(30)
  v_mfma_f32_32x32x16_bf16 v[96:111], v[204:207], v[200:203], v[96:111]
  v_mfma_f32_32x32x16_bf16 v[112:127], v[208:211], v[200:203], v[112:127]
  v_mfma_f32_32x32x16_bf16 v[128:143], v[212:215], v[200:203], v[128:143]
  v_mfma_f32_32x32x16_bf16 v[144:159], v[216:219], v[200:203], v[144:159]
  v_mfma_f32_32x32x16_bf16 v[160:175], v[220:223], v[200:203], v[160:175]
  buffer_load_dwordx4 v[204:207], v2, s[8:11], s87 offen offset:0 sc1
  buffer_load_dwordx4 v[208:211], v2, s[8:11], s87 offen offset:1024 sc1
  buffer_load_dwordx4 v[212:215], v2, s[8:11], s87 offen offset:2048 sc1
  buffer_load_dwordx4 v[216:219], v2, s[8:11], s87 offen offset:3072 sc1
  s_add_u32 s12, s87, 4096
  buffer_load_dwordx4 v[220:223], v2, s[8:11], s12 offen sc1
  s_add_u32 s87, s87, 5120
  buffer_load_dwordx4 v[200:203], v2, s[8:11], s21 offen sc1
  s_add_u32 s21, s21, 1024
  s_waitcnt vmcnt(30)
  v_mfma_f32_32x32x16_bf16 v[96:111], v[228:231], v[224:227], v[96:111]
  v_mfma_f32_32x32x16_bf16 v[112:127], v[232:235], v[224:227], v[112:127]
  v_mfma_f32_32x32x16_bf16 v[128:143], v[236:239], v[224:227], v[128:143]
  v_mfma_f32_32x32x16_bf16 v[144:159], v[240:243], v[224:227], v[144:159]
  v_mfma_f32_32x32x16_bf16 v[160:175], v[244:247], v[224:227], v[160:175]
  buffer_load_dwordx4 v[228:231], v2, s[8:11], s87 offen offset:0 sc1
  buffer_load_dwordx4 v[232:235], v2, s[8:11], s87 offen offset:1024 sc1
  buffer_load_dwordx4 v[236:239], v2, s[8:11], s87 offen offset:2048 sc1
  buffer_load_dwordx4 v[240:243], v2, s[8:11], s87 offen offset:3072 sc1
  s_add_u32 s12, s87, 4096
  buffer_load_dwordx4 v[244:247], v2, s[8:11], s12 offen sc1
  s_add_u32 s87, s87, 5120
  buffer_load_dwordx4 v[224:227], v2, s[8:11], s21 offen sc1
  s_add_u32 s21, s21, 1024
  s_waitcnt vmcnt(30)
  v_mfma_f32_32x32x16_bf16 v[96:111], v[20:23], v[16:19], v[96:111]
  v_mfma_f32_32x32x16_bf16 v[112:127], v[24:27], v[16:19], v[112:127]
  v_mfma_f32_32x32x16_bf16 v[128:143], v[28:31], v[16:19], v[128:143]
  v_mfma_f32_32x32x16_bf16 v[144:159], v[32:35], v[16:19], v[144:159]
  v_mfma_f32_32x32x16_bf16 v[160:175], v[36:39], v[16:19], v[160:175]
  buffer_load_dwordx4 v[20:23], v2, s[8:11], s87 offen offset:0 sc1
  buffer_load_dwordx4 v[24:27], v2, s[8:11], s87 offen offset:1024 sc1
  buffer_load_dwordx4 v[28:31], v2, s[8:11], s87 offen offset:2048 sc1
  buffer_load_dwordx4 v[32:35], v2, s[8:11], s87 offen offset:3072 sc1
  s_add_u32 s12, s87, 4096
  buffer_load_dwordx4 v[36:39], v2, s[8:11], s12 offen sc1
  s_add_u32 s87, s87, 5120
  buffer_load_dwordx4 v[16:19], v2, s[8:11], s21 offen sc1
  s_add_u32 s21, s21, 1024
  s_waitcnt vmcnt(30)
  v_mfma_f32_32x32x16_bf16 v[96:111], v[44:47], v[40:43], v[96:111]
  v_mfma_f32_32x32x16_bf16 v[112:127], v[48:51], v[40:43], v[112:127]
  v_mfma_f32_32x32x16_bf16 v[128:143], v[52:55], v[40:43], v[128:143]
  v_mfma_f32_32x32x16_bf16 v[144:159], v[56:59], v[40:43], v[144:159]
  v_mfma_f32_32x32x16_bf16 v[160:175], v[60:63], v[40:43], v[160:175]
  buffer_load_dwordx4 v[44:47], v2, s[8:11], s87 offen offset:0 sc1
  buffer_load_dwordx4 v[48:51], v2, s[8:11], s87 offen offset:1024 sc1
  buffer_load_dwordx4 v[52:55], v2, s[8:11], s87 offen offset:2048 sc1
  buffer_load_dwordx4 v[56:59], v2, s[8:11], s87 offen offset:3072 sc1
  s_add_u32 s12, s87, 4096
  buffer_load_dwordx4 v[60:63], v2, s[8:11], s12 offen sc1
  s_add_u32 s87, s87, 5120
  buffer_load_dwordx4 v[40:43], v2, s[8:11], s21 offen sc1
  s_add_u32 s21, s21, 1024
  s_waitcnt vmcnt(30)
  v_mfma_f32_32x32x16_bf16 v[96:111], v[68:71], v[64:67], v[96:111]
  v_mfma_f32_32x32x16_bf16 v[112:127], v[72:75], v[64:67], v[112:127]
  v_mfma_f32_32x32x16_bf16 v[128:143], v[76:79], v[64:67], v[128:143]
  v_mfma_f32_32x32x16_bf16 v[144:159], v[80:83], v[64:67], v[144:159]
  v_mfma_f32_32x32x16_bf16 v[160:175], v[84:87], v[64:67], v[160:175]
  buffer_load_dwordx4 v[68:71], v2, s[8:11], s87 offen offset:0 sc1
  buffer_load_dwordx4 v[72:75], v2, s[8:11], s87 offen offset:1024 sc1
  buffer_load_dwordx4 v[76:79], v2, s[8:11], s87 offen offset:2048 sc1
  buffer_load_dwordx4 v[80:83], v2, s[8:11], s87 offen offset:3072 sc1
  s_add_u32 s12, s87, 4096
  buffer_load_dwordx4 v[84:87], v2, s[8:11], s12 offen sc1
  s_add_u32 s87, s87, 5120
  buffer_load_dwordx4 v[64:67], v2, s[8:11], s21 offen sc1
  s_add_u32 s21, s21, 1024
  s_waitcnt vmcnt(30)
  v_mfma_f32_32x32x16_bf16 v[96:111], v[180:183], v[176:179], v[96:111]
  v_mfma_f32_32x32x16_bf16 v[112:127], v[184:187], v[176:179], v[112:127]
  v_mfma_f32_32x32x16_bf16 v[128:143], v[188:191], v[176:179], v[128:143]
  v_mfma_f32_32x32x16_bf16 v[144:159], v[192:195], v[176:179], v[144:159]
  v_mfma_f32_32x32x16_bf16 v[160:175], v[196:199], v[176:179], v[160:175]
  buffer_load_dwordx4 v[180:183], v2, s[8:11], s90 offen offset:0 sc1
  buffer_load_dwordx4 v[184:187], v2, s[8:11], s90 offen offset:1024 sc1
  buffer_load_dwordx4 v[188:191], v2, s[8:11], s90 offen offset:2048 sc1
  buffer_load_dwordx4 v[192:195], v2, s[8:11], s90 offen offset:3072 sc1
  s_add_u32 s12, s90, 4096
  buffer_load_dwordx4 v[196:199], v2, s[8:11], s12 offen sc1
  s_add_u32 s90, s90, 5120
  s_waitcnt vmcnt(29)
  v_mfma_f32_32x32x16_bf16 v[96:111], v[204:207], v[200:203], v[96:111]
  v_mfma_f32_32x32x16_bf16 v[112:127], v[208:211], v[200:203], v[112:127]
  v_mfma_f32_32x32x16_bf16 v[128:143], v[212:215], v[200:203], v[128:143]
  v_mfma_f32_32x32x16_bf16 v[144:159], v[216:219], v[200:203], v[144:159]
  v_mfma_f32_32x32x16_bf16 v[160:175], v[220:223], v[200:203], v[160:175]
  buffer_load_dwordx4 v[204:207], v2, s[8:11], s90 offen offset:0 sc1
  buffer_load_dwordx4 v[208:211], v2, s[8:11], s90 offen offset:1024 sc1
  buffer_load_dwordx4 v[212:215], v2, s[8:11], s90 offen offset:2048 sc1
  buffer_load_dwordx4 v[216:219], v2, s[8:11], s90 offen offset:3072 sc1
  s_add_u32 s12, s90, 4096
  buffer_load_dwordx4 v[220:223], v2, s[8:11], s12 offen sc1
  s_add_u32 s90, s90, 5120
  s_waitcnt vmcnt(28)
  v_mfma_f32_32x32x16_bf16 v[96:111], v[228:231], v[224:227], v[96:111]
  v_mfma_f32_32x32x16_bf16 v[112:127], v[232:235], v[224:227], v[112:127]
  v_mfma_f32_32x32x16_bf16 v[128:143], v[236:239], v[224:227], v[128:143]
  v_mfma_f32_32x32x16_bf16 v[144:159], v[240:243], v[224:227], v[144:159]
  v_mfma_f32_32x32x16_bf16 v[160:175], v[244:247], v[224:227], v[160:175]
  buffer_load_dwordx4 v[228:231], v2, s[8:11], s90 offen offset:0 sc1
  buffer_load_dwordx4 v[232:235], v2, s[8:11], s90 offen offset:1024 sc1
  buffer_load_dwordx4 v[236:239], v2, s[8:11], s90 offen offset:2048 sc1
  buffer_load_dwordx4 v[240:243], v2, s[8:11], s90 offen offset:3072 sc1
  s_add_u32 s12, s90, 4096
  buffer_load_dwordx4 v[244:247], v2, s[8:11], s12 offen sc1
  s_add_u32 s90, s90, 5120
  s_waitcnt vmcnt(27)
  v_mfma_f32_32x32x16_bf16 v[96:111], v[20:23], v[16:19], v[96:111]
  v_mfma_f32_32x32x16_bf16 v[112:127], v[24:27], v[16:19], v[112:127]
  v_mfma_f32_32x32x16_bf16 v[128:143], v[28:31], v[16:19], v[128:143]
  v_mfma_f32_32x32x16_bf16 v[144:159], v[32:35], v[16:19], v[144:159]
  v_mfma_f32_32x32x16_bf16 v[160:175], v[36:39], v[16:19], v[160:175]
  buffer_load_dwordx4 v[20:23], v2, s[8:11], s90 offen offset:0 sc1
  buffer_load_dwordx4 v[24:27], v2, s[8:11], s90 offen offset:1024 sc1
  buffer_load_dwordx4 v[28:31], v2, s[8:11], s90 offen offset:2048 sc1
  buffer_load_dwordx4 v[32:35], v2, s[8:11], s90 offen offset:3072 sc1
  s_add_u32 s12, s90, 4096
  buffer_load_dwordx4 v[36:39], v2, s[8:11], s12 offen sc1
  s_add_u32 s90, s90, 5120
  s_waitcnt vmcnt(26)
  v_mfma_f32_32x32x16_bf16 v[96:111], v[44:47], v[40:43], v[96:111]
  v_mfma_f32_32x32x16_bf16 v[112:127], v[48:51], v[40:43], v[112:127]
  v_mfma_f32_32x32x16_bf16 v[128:143], v[52:55], v[40:43], v[128:143]
  v_mfma_f32_32x32x16_bf16 v[144:159], v[56:59], v[40:43], v[144:159]
  v_mfma_f32_32x32x16_bf16 v[160:175], v[60:63], v[40:43], v[160:175]
  buffer_load_dwordx4 v[44:47], v2, s[8:11], s90 offen offset:0 sc1
  buffer_load_dwordx4 v[48:51], v2, s[8:11], s90 offen offset:1024 sc1
  buffer_load_dwordx4 v[52:55], v2, s[8:11], s90 offen offset:2048 sc1
  buffer_load_dwordx4 v[56:59], v2, s[8:11], s90 offen offset:3072 sc1
  s_add_u32 s12, s90, 4096
  buffer_load_dwordx4 v[60:63], v2, s[8:11], s12 offen sc1
  s_add_u32 s90, s90, 5120
  s_waitcnt vmcnt(25)
  v_mfma_f32_32x32x16_bf16 v[96:111], v[68:71], v[64:67], v[96:111]
  v_mfma_f32_32x32x16_bf16 v[112:127], v[72:75], v[64:67], v[112:127]
  v_mfma_f32_32x32x16_bf16 v[128:143], v[76:79], v[64:67], v[128:143]
  v_mfma_f32_32x32x16_bf16 v[144:159], v[80:83], v[64:67], v[144:159]
  v_mfma_f32_32x32x16_bf16 v[160:175], v[84:87], v[64:67], v[160:175]
  buffer_load_dwordx4 v[68:71], v2, s[8:11], s90 offen offset:0 sc1
  buffer_load_dwordx4 v[72:75], v2, s[8:11], s90 offen offset:1024 sc1
  buffer_load_dwordx4 v[76:79], v2, s[8:11], s90 offen offset:2048 sc1
  buffer_load_dwordx4 v[80:83], v2, s[8:11], s90 offen offset:3072 sc1
  s_add_u32 s12, s90, 4096
  buffer_load_dwordx4 v[84:87], v2, s[8:11], s12 offen sc1
  s_add_u32 s90, s90, 5120
  s_setprio 3
  v_sub_f32 v6, 1.0, v6
  v_mov_b32 v7, v6
  v_pk_mul_f32 v[96:97], v[96:97], v[6:7]
  v_pk_mul_f32 v[98:99], v[98:99], v[6:7]
  v_pk_mul_f32 v[100:101], v[100:101], v[6:7]
  v_pk_mul_f32 v[102:103], v[102:103], v[6:7]
  v_pk_mul_f32 v[104:105], v[104:105], v[6:7]
  v_pk_mul_f32 v[106:107], v[106:107], v[6:7]
  v_pk_mul_f32 v[108:109], v[108:109], v[6:7]
  v_pk_mul_f32 v[110:111], v[110:111], v[6:7]
  v_pk_mul_f32 v[112:113], v[112:113], v[6:7]
  v_pk_mul_f32 v[114:115], v[114:115], v[6:7]
  v_pk_mul_f32 v[116:117], v[116:117], v[6:7]
  v_pk_mul_f32 v[118:119], v[118:119], v[6:7]
  v_pk_mul_f32 v[120:121], v[120:121], v[6:7]
  v_pk_mul_f32 v[122:123], v[122:123], v[6:7]
  v_pk_mul_f32 v[124:125], v[124:125], v[6:7]
  v_pk_mul_f32 v[126:127], v[126:127], v[6:7]
  v_pk_mul_f32 v[128:129], v[128:129], v[6:7]
  v_pk_mul_f32 v[130:131], v[130:131], v[6:7]
  v_pk_mul_f32 v[132:133], v[132:133], v[6:7]
  v_pk_mul_f32 v[134:135], v[134:135], v[6:7]
  v_pk_mul_f32 v[136:137], v[136:137], v[6:7]
  v_pk_mul_f32 v[138:139], v[138:139], v[6:7]
  v_pk_mul_f32 v[140:141], v[140:141], v[6:7]
  v_pk_mul_f32 v[142:143], v[142:143], v[6:7]
  v_pk_mul_f32 v[144:145], v[144:145], v[6:7]
  v_pk_mul_f32 v[146:147], v[146:147], v[6:7]
  v_pk_mul_f32 v[148:149], v[148:149], v[6:7]
  v_pk_mul_f32 v[150:151], v[150:151], v[6:7]
  v_pk_mul_f32 v[152:153], v[152:153], v[6:7]
  v_pk_mul_f32 v[154:155], v[154:155], v[6:7]
  v_pk_mul_f32 v[156:157], v[156:157], v[6:7]
  v_pk_mul_f32 v[158:159], v[158:159], v[6:7]
  v_pk_mul_f32 v[160:161], v[160:161], v[6:7]
  v_pk_mul_f32 v[162:163], v[162:163], v[6:7]
  v_pk_mul_f32 v[164:165], v[164:165], v[6:7]
  v_pk_mul_f32 v[166:167], v[166:167], v[6:7]
  v_pk_mul_f32 v[168:169], v[168:169], v[6:7]
  v_pk_mul_f32 v[170:171], v[170:171], v[6:7]
  v_pk_mul_f32 v[172:173], v[172:173], v[6:7]
  v_pk_mul_f32 v[174:175], v[174:175], v[6:7]
  v_and_b32 v10, 3, v1
  v_lshlrev_b32 v10, 2, v10
  v_add_u32 v10, 163776, v10
  v_mov_b32 v12, 148736
gated_mix__grouped_kv_mqa__geglu_ffn__prompt_kernel_pw_58:
  ds_read_b32 v11, v10
  s_waitcnt lgkmcnt(0)
  v_cmp_lt_u32 vcc, v11, v12
  s_nop 4
  s_cbranch_vccz gated_mix__grouped_kv_mqa__geglu_ffn__prompt_kernel_pw_58_d
  s_sleep 8
  s_sub_u32 s28, s28, 1
  s_cbranch_scc0 gated_mix__grouped_kv_mqa__geglu_ffn__prompt_kernel_pw_58
gated_mix__grouped_kv_mqa__geglu_ffn__prompt_kernel_pw_58_d:
  s_andn2_b32 s13, s2, 0x18
  s_lshl_b32 s12, s19, 3
  s_or_b32 s13, s13, s12
  s_lshl_b32 s13, s13, 7
  s_add_u32 s13, s13, 20773120
  v_and_b32 v10, 3, v1
  v_lshlrev_b32 v10, 2, v10
  s_waitcnt vmcnt(0)
gated_mix__grouped_kv_mqa__geglu_ffn__prompt_kernel_g5:
  buffer_load_dword v11, v10, s[8:11], s13 offen sc1
  s_waitcnt vmcnt(0)
  v_cmp_ne_u32 vcc, s29, v11
  s_nop 4
  s_cbranch_vccz gated_mix__grouped_kv_mqa__geglu_ffn__prompt_kernel_g5d
  s_sleep 1
  s_sub_u32 s28, s28, 1
  s_cbranch_scc0 gated_mix__grouped_kv_mqa__geglu_ffn__prompt_kernel_g5
gated_mix__grouped_kv_mqa__geglu_ffn__prompt_kernel_g5d:
  s_add_u32 s13, s91, 4096
  s_add_u32 s14, s91, 8192
  buffer_load_dwordx4 v[176:179], v2, s[8:11], s91 offen offset:0 sc1
  buffer_load_dwordx4 v[200:203], v2, s[8:11], s91 offen offset:1024 sc1
  buffer_load_dwordx4 v[224:227], v2, s[8:11], s91 offen offset:2048 sc1
  buffer_load_dwordx4 v[16:19], v2, s[8:11], s91 offen offset:3072 sc1
  buffer_load_dwordx4 v[40:43], v2, s[8:11], s13 offen offset:0 sc1
  buffer_load_dwordx4 v[64:67], v2, s[8:11], s13 offen offset:1024 sc1
  buffer_load_dwordx4 v[248:251], v2, s[8:11], s13 offen offset:2048 sc1
  buffer_load_dwordx4 v[252:255], v2, s[8:11], s13 offen offset:3072 sc1
  buffer_load_dwordx4 v[88:91], v2, s[8:11], s14 offen offset:0 sc1
  buffer_load_dwordx4 v[92:95], v2, s[8:11], s14 offen offset:1024 sc1
  s_waitcnt vmcnt(9)
  v_mfma_f32_32x32x16_bf16 v[96:111], v[180:183], v[176:179], v[96:111]
  v_mfma_f32_32x32x16_bf16 v[112:127], v[184:187], v[176:179], v[112:127]
  v_mfma_f32_32x32x16_bf16 v[128:143], v[188:191], v[176:179], v[128:143]
  v_mfma_f32_32x32x16_bf16 v[144:159], v[192:195], v[176:179], v[144:159]
  v_mfma_f32_32x32x16_bf16 v[160:175], v[196:199], v[176:179], v[160:175]
  ds_read_b128 v[180:183], v13 offset:0
  ds_read_b128 v[184:187], v13 offset:1024
  ds_read_b128 v[188:191], v13 offset:2048
  ds_read_b128 v[192:195], v13 offset:3072
  ds_read_b128 v[196:199], v13 offset:4096
  s_waitcnt vmcnt(8)
  v_mfma_f32_32x32x16_bf16 v[96:111], v[204:207], v[200:203], v[96:111]
  v_mfma_f32_32x32x16_bf16 v[112:127], v[208:211], v[200:203], v[112:127]
  v_mfma_f32_32x32x16_bf16 v[128:143], v[212:215], v[200:203], v[128:143]
  v_mfma_f32_32x32x16_bf16 v[144:159], v[216:219], v[200:203], v[144:159]
  v_mfma_f32_32x32x16_bf16 v[160:175], v[220:223], v[200:203], v[160:175]
  ds_read_b128 v[204:207], v13 offset:5120
  ds_read_b128 v[208:211], v13 offset:6144
  ds_read_b128 v[212:215], v13 offset:7168
  ds_read_b128 v[216:219], v13 offset:8192
  ds_read_b128 v[220:223], v13 offset:9216
  s_waitcnt vmcnt(7)
  v_mfma_f32_32x32x16_bf16 v[96:111], v[228:231], v[224:227], v[96:111]
  v_mfma_f32_32x32x16_bf16 v[112:127], v[232:235], v[224:227], v[112:127]
  v_mfma_f32_32x32x16_bf16 v[128:143], v[236:239], v[224:227], v[128:143]
  v_mfma_f32_32x32x16_bf16 v[144:159], v[240:243], v[224:227], v[144:159]
  v_mfma_f32_32x32x16_bf16 v[160:175], v[244:247], v[224:227], v[160:175]
  ds_read_b128 v[228:231], v13 offset:10240
  ds_read_b128 v[232:235], v13 offset:11264
  ds_read_b128 v[236:239], v13 offset:12288
  ds_read_b128 v[240:243], v13 offset:13312
  ds_read_b128 v[244:247], v13 offset:14336
  s_waitcnt vmcnt(6)
  v_mfma_f32_32x32x16_bf16 v[96:111], v[20:23], v[16:19], v[96:111]
  v_mfma_f32_32x32x16_bf16 v[112:127], v[24:27], v[16:19], v[112:127]
  v_mfma_f32_32x32x16_bf16 v[128:143], v[28:31], v[16:19], v[128:143]
  v_mfma_f32_32x32x16_bf16 v[144:159], v[32:35], v[16:19], v[144:159]
  v_mfma_f32_32x32x16_bf16 v[160:175], v[36:39], v[16:19], v[160:175]
  ds_read_b128 v[20:23], v13 offset:15360
  ds_read_b128 v[24:27], v13 offset:16384
  ds_read_b128 v[28:31], v13 offset:17408
  ds_read_b128 v[32:35], v13 offset:18432
  ds_read_b128 v[36:39], v13 offset:19456
  s_waitcnt vmcnt(5)
  v_mfma_f32_32x32x16_bf16 v[96:111], v[44:47], v[40:43], v[96:111]
  v_mfma_f32_32x32x16_bf16 v[112:127], v[48:51], v[40:43], v[112:127]
  v_mfma_f32_32x32x16_bf16 v[128:143], v[52:55], v[40:43], v[128:143]
  v_mfma_f32_32x32x16_bf16 v[144:159], v[56:59], v[40:43], v[144:159]
  v_mfma_f32_32x32x16_bf16 v[160:175], v[60:63], v[40:43], v[160:175]
  s_waitcnt vmcnt(4)
  v_mfma_f32_32x32x16_bf16 v[96:111], v[68:71], v[64:67], v[96:111]
  v_mfma_f32_32x32x16_bf16 v[112:127], v[72:75], v[64:67], v[112:127]
  v_mfma_f32_32x32x16_bf16 v[128:143], v[76:79], v[64:67], v[128:143]
  v_mfma_f32_32x32x16_bf16 v[144:159], v[80:83], v[64:67], v[144:159]
  v_mfma_f32_32x32x16_bf16 v[160:175], v[84:87], v[64:67], v[160:175]
  s_waitcnt vmcnt(3)
  s_waitcnt lgkmcnt(15)
  v_mfma_f32_32x32x16_bf16 v[96:111], v[180:183], v[248:251], v[96:111]
  v_mfma_f32_32x32x16_bf16 v[112:127], v[184:187], v[248:251], v[112:127]
  v_mfma_f32_32x32x16_bf16 v[128:143], v[188:191], v[248:251], v[128:143]
  v_mfma_f32_32x32x16_bf16 v[144:159], v[192:195], v[248:251], v[144:159]
  v_mfma_f32_32x32x16_bf16 v[160:175], v[196:199], v[248:251], v[160:175]
  s_waitcnt vmcnt(2)
  s_waitcnt lgkmcnt(10)
  v_mfma_f32_32x32x16_bf16 v[96:111], v[204:207], v[252:255], v[96:111]
  v_mfma_f32_32x32x16_bf16 v[112:127], v[208:211], v[252:255], v[112:127]
  v_mfma_f32_32x32x16_bf16 v[128:143], v[212:215], v[252:255], v[128:143]
  v_mfma_f32_32x32x16_bf16 v[144:159], v[216:219], v[252:255], v[144:159]
  v_mfma_f32_32x32x16_bf16 v[160:175], v[220:223], v[252:255], v[160:175]
  s_waitcnt vmcnt(1)
  s_waitcnt lgkmcnt(5)
  v_mfma_f32_32x32x16_bf16 v[96:111], v[228:231], v[88:91], v[96:111]
  v_mfma_f32_32x32x16_bf16 v[112:127], v[232:235], v[88:91], v[112:127]
  v_mfma_f32_32x32x16_bf16 v[128:143], v[236:239], v[88:91], v[128:143]
  v_mfma_f32_32x32x16_bf16 v[144:159], v[240:243], v[88:91], v[144:159]
  v_mfma_f32_32x32x16_bf16 v[160:175], v[244:247], v[88:91], v[160:175]
  s_waitcnt vmcnt(0)
  s_waitcnt lgkmcnt(0)
  v_mfma_f32_32x32x16_bf16 v[96:111], v[20:23], v[92:95], v[96:111]
  v_mfma_f32_32x32x16_bf16 v[112:127], v[24:27], v[92:95], v[112:127]
  v_mfma_f32_32x32x16_bf16 v[128:143], v[28:31], v[92:95], v[128:143]
  v_mfma_f32_32x32x16_bf16 v[144:159], v[32:35], v[92:95], v[144:159]
  v_mfma_f32_32x32x16_bf16 v[160:175], v[36:39], v[92:95], v[160:175]
  v_mov_b32 v92, 163712
  v_mov_b32 v90, 1
  v_mul_u32_u24 v12, 1280, v4
  v_lshrrev_b32 v14, 5, v1
  v_lshl_add_u32 v12, v14, 3, v12
  s_mul_i32 s13, s4, 40960
  s_mul_i32 s14, s22, 320
  s_add_u32 s13, s13, s14
  s_mul_i32 s14, s19, 80
  s_add_u32 s13, s13, s14
  v_add_u32 v15, 40960, v2
  s_cmp_eq_u32 s19, 1
  s_cbranch_scc1 gated_mix__grouped_kv_mqa__geglu_ffn__prompt_kernel_rd1
  s_cmp_eq_u32 s19, 2
  s_cbranch_scc1 gated_mix__grouped_kv_mqa__geglu_ffn__prompt_kernel_rd2
  s_cmp_eq_u32 s19, 3
  s_cbranch_scc1 gated_mix__grouped_kv_mqa__geglu_ffn__prompt_kernel_rd3
  ds_write_b128 v13, v[116:119] offset:5120
  ds_write_b128 v13, v[120:123] offset:6144
  ds_write_b128 v13, v[124:127] offset:7168
  ds_write_b128 v13, v[128:131] offset:8192
  ds_write_b128 v13, v[132:135] offset:9216
  ds_write_b128 v13, v[136:139] offset:10240
  ds_write_b128 v13, v[140:143] offset:11264
  ds_write_b128 v13, v[144:147] offset:12288
  ds_write_b128 v13, v[148:151] offset:13312
  ds_write_b128 v13, v[152:155] offset:14336
  ds_write_b128 v13, v[156:159] offset:15360
  ds_write_b128 v13, v[160:163] offset:16384
  ds_write_b128 v13, v[164:167] offset:17408
  ds_write_b128 v13, v[168:171] offset:18432
  ds_write_b128 v13, v[172:175] offset:19456
  s_waitcnt lgkmcnt(0)
  s_mov_b64 exec, 1
  ds_add_u32 v92, v90 offset:36
  s_mov_b64 exec, -1
gated_mix__grouped_kv_mqa__geglu_ffn__prompt_kernel_sp_59:
  ds_read_b32 v9, v92 offset:36
  s_waitcnt lgkmcnt(0)
  v_readfirstlane_b32 s12, v9
  s_nop 0
  s_cmp_ge_u32 s12, 4
  s_cbranch_scc1 gated_mix__grouped_kv_mqa__geglu_ffn__prompt_kernel_sp_59_d
  s_sub_u32 s28, s28, 1
  s_cbranch_scc0 gated_mix__grouped_kv_mqa__geglu_ffn__prompt_kernel_sp_59
gated_mix__grouped_kv_mqa__geglu_ffn__prompt_kernel_sp_59_d:
  ds_read_b128 v[176:179], v2 offset:20480
  ds_read_b128 v[180:183], v2 offset:21504
  ds_read_b128 v[184:187], v2 offset:22528
  ds_read_b128 v[188:191], v2 offset:23552
  ds_read_b128 v[192:195], v2 offset:24576
  ds_read_b128 v[196:199], v15 offset:0
  ds_read_b128 v[200:203], v15 offset:1024
  ds_read_b128 v[204:207], v15 offset:2048
  ds_read_b128 v[208:211], v15 offset:3072
  ds_read_b128 v[212:215], v15 offset:4096
  ds_read_b128 v[216:219], v15 offset:20480
  ds_read_b128 v[220:223], v15 offset:21504
  ds_read_b128 v[224:227], v15 offset:22528
  ds_read_b128 v[228:231], v15 offset:23552
  ds_read_b128 v[232:235], v15 offset:24576
  s_waitcnt lgkmcnt(5)
  v_pk_add_f32 v[176:177], v[176:177], v[196:197]
  v_pk_add_f32 v[178:179], v[178:179], v[198:199]
  v_pk_add_f32 v[180:181], v[180:181], v[200:201]
  v_pk_add_f32 v[182:183], v[182:183], v[202:203]
  v_pk_add_f32 v[184:185], v[184:185], v[204:205]
  v_pk_add_f32 v[186:187], v[186:187], v[206:207]
  v_pk_add_f32 v[188:189], v[188:189], v[208:209]
  v_pk_add_f32 v[190:191], v[190:191], v[210:211]
  v_pk_add_f32 v[192:193], v[192:193], v[212:213]
  v_pk_add_f32 v[194:195], v[194:195], v[214:215]
  s_waitcnt lgkmcnt(0)
  v_pk_add_f32 v[96:97], v[96:97], v[216:217]
  v_pk_add_f32 v[98:99], v[98:99], v[218:219]
  v_pk_add_f32 v[100:101], v[100:101], v[220:221]
  v_pk_add_f32 v[102:103], v[102:103], v[222:223]
  v_pk_add_f32 v[104:105], v[104:105], v[224:225]
  v_pk_add_f32 v[106:107], v[106:107], v[226:227]
  v_pk_add_f32 v[108:109], v[108:109], v[228:229]
  v_pk_add_f32 v[110:111], v[110:111], v[230:231]
  v_pk_add_f32 v[112:113], v[112:113], v[232:233]
  v_pk_add_f32 v[114:115], v[114:115], v[234:235]
  v_pk_add_f32 v[96:97], v[96:97], v[176:177]
  v_pk_add_f32 v[98:99], v[98:99], v[178:179]
  v_pk_add_f32 v[100:101], v[100:101], v[180:181]
  v_pk_add_f32 v[102:103], v[102:103], v[182:183]
  v_pk_add_f32 v[104:105], v[104:105], v[184:185]
  v_pk_add_f32 v[106:107], v[106:107], v[186:187]
  v_pk_add_f32 v[108:109], v[108:109], v[188:189]
  v_pk_add_f32 v[110:111], v[110:111], v[190:191]
  v_pk_add_f32 v[112:113], v[112:113], v[192:193]
  v_pk_add_f32 v[114:115], v[114:115], v[194:195]
  v_cvt_pk_bf16_f32 v16, v96, v97
  v_cvt_pk_bf16_f32 v17, v98, v99
  v_cvt_pk_bf16_f32 v18, v100, v101
  v_cvt_pk_bf16_f32 v19, v102, v103
  v_cvt_pk_bf16_f32 v20, v104, v105
  v_cvt_pk_bf16_f32 v21, v106, v107
  v_cvt_pk_bf16_f32 v22, v108, v109
  v_cvt_pk_bf16_f32 v23, v110, v111
  v_cvt_pk_bf16_f32 v24, v112, v113
  v_cvt_pk_bf16_f32 v25, v114, v115
  buffer_store_dwordx2 v[16:17], v12, s[32:35], s13 offen offset:0
  buffer_store_dwordx2 v[18:19], v12, s[32:35], s13 offen offset:16
  buffer_store_dwordx2 v[20:21], v12, s[32:35], s13 offen offset:32
  buffer_store_dwordx2 v[22:23], v12, s[32:35], s13 offen offset:48
  buffer_store_dwordx2 v[24:25], v12, s[32:35], s13 offen offset:64
  s_branch gated_mix__grouped_kv_mqa__geglu_ffn__prompt_kernel_rde
gated_mix__grouped_kv_mqa__geglu_ffn__prompt_kernel_rd1:
  s_nop 4
  ds_write_b128 v13, v[96:99] offset:0
  ds_write_b128 v13, v[100:103] offset:1024
  ds_write_b128 v13, v[104:107] offset:2048
  ds_write_b128 v13, v[108:111] offset:3072
  ds_write_b128 v13, v[112:115] offset:4096
  ds_write_b128 v13, v[136:139] offset:10240
  ds_write_b128 v13, v[140:143] offset:11264
  ds_write_b128 v13, v[144:147] offset:12288
  ds_write_b128 v13, v[148:151] offset:13312
  ds_write_b128 v13, v[152:155] offset:14336
  ds_write_b128 v13, v[156:159] offset:15360
  ds_write_b128 v13, v[160:163] offset:16384
  ds_write_b128 v13, v[164:167] offset:17408
  ds_write_b128 v13, v[168:171] offset:18432
  ds_write_b128 v13, v[172:175] offset:19456
  s_waitcnt lgkmcnt(0)
  s_mov_b64 exec, 1
  ds_add_u32 v92, v90 offset:36
  s_mov_b64 exec, -1
gated_mix__grouped_kv_mqa__geglu_ffn__prompt_kernel_sp_60:
  ds_read_b32 v9, v92 offset:36
  s_waitcnt lgkmcnt(0)
  v_readfirstlane_b32 s12, v9
  s_nop 0
  s_cmp_ge_u32 s12, 4
  s_cbranch_scc1 gated_mix__grouped_kv_mqa__geglu_ffn__prompt_kernel_sp_60_d
  s_sub_u32 s28, s28, 1
  s_cbranch_scc0 gated_mix__grouped_kv_mqa__geglu_ffn__prompt_kernel_sp_60
gated_mix__grouped_kv_mqa__geglu_ffn__prompt_kernel_sp_60_d:
  ds_read_b128 v[176:179], v2 offset:5120
  ds_read_b128 v[180:183], v2 offset:6144
  ds_read_b128 v[184:187], v2 offset:7168
  ds_read_b128 v[188:191], v2 offset:8192
  ds_read_b128 v[192:195], v2 offset:9216
  ds_read_b128 v[196:199], v15 offset:5120
  ds_read_b128 v[200:203], v15 offset:6144
  ds_read_b128 v[204:207], v15 offset:7168
  ds_read_b128 v[208:211], v15 offset:8192
  ds_read_b128 v[212:215], v15 offset:9216
  ds_read_b128 v[216:219], v15 offset:25600
  ds_read_b128 v[220:223], v15 offset:26624
  ds_read_b128 v[224:227], v15 offset:27648
  ds_read_b128 v[228:231], v15 offset:28672
  ds_read_b128 v[232:235], v15 offset:29696
  s_waitcnt lgkmcnt(5)
  v_pk_add_f32 v[176:177], v[176:177], v[196:197]
  v_pk_add_f32 v[178:179], v[178:179], v[198:199]
  v_pk_add_f32 v[180:181], v[180:181], v[200:201]
  v_pk_add_f32 v[182:183], v[182:183], v[202:203]
  v_pk_add_f32 v[184:185], v[184:185], v[204:205]
  v_pk_add_f32 v[186:187], v[186:187], v[206:207]
  v_pk_add_f32 v[188:189], v[188:189], v[208:209]
  v_pk_add_f32 v[190:191], v[190:191], v[210:211]
  v_pk_add_f32 v[192:193], v[192:193], v[212:213]
  v_pk_add_f32 v[194:195], v[194:195], v[214:215]
  s_waitcnt lgkmcnt(0)
  v_pk_add_f32 v[116:117], v[116:117], v[216:217]
  v_pk_add_f32 v[118:119], v[118:119], v[218:219]
  v_pk_add_f32 v[120:121], v[120:121], v[220:221]
  v_pk_add_f32 v[122:123], v[122:123], v[222:223]
  v_pk_add_f32 v[124:125], v[124:125], v[224:225]
  v_pk_add_f32 v[126:127], v[126:127], v[226:227]
  v_pk_add_f32 v[128:129], v[128:129], v[228:229]
  v_pk_add_f32 v[130:131], v[130:131], v[230:231]
  v_pk_add_f32 v[132:133], v[132:133], v[232:233]
  v_pk_add_f32 v[134:135], v[134:135], v[234:235]
  v_pk_add_f32 v[116:117], v[116:117], v[176:177]
  v_pk_add_f32 v[118:119], v[118:119], v[178:179]
  v_pk_add_f32 v[120:121], v[120:121], v[180:181]
  v_pk_add_f32 v[122:123], v[122:123], v[182:183]
  v_pk_add_f32 v[124:125], v[124:125], v[184:185]
  v_pk_add_f32 v[126:127], v[126:127], v[186:187]
  v_pk_add_f32 v[128:129], v[128:129], v[188:189]
  v_pk_add_f32 v[130:131], v[130:131], v[190:191]
  v_pk_add_f32 v[132:133], v[132:133], v[192:193]
  v_pk_add_f32 v[134:135], v[134:135], v[194:195]
  v_cvt_pk_bf16_f32 v16, v116, v117
  v_cvt_pk_bf16_f32 v17, v118, v119
  v_cvt_pk_bf16_f32 v18, v120, v121
  v_cvt_pk_bf16_f32 v19, v122, v123
  v_cvt_pk_bf16_f32 v20, v124, v125
  v_cvt_pk_bf16_f32 v21, v126, v127
  v_cvt_pk_bf16_f32 v22, v128, v129
  v_cvt_pk_bf16_f32 v23, v130, v131
  v_cvt_pk_bf16_f32 v24, v132, v133
  v_cvt_pk_bf16_f32 v25, v134, v135
  buffer_store_dwordx2 v[16:17], v12, s[32:35], s13 offen offset:0
  buffer_store_dwordx2 v[18:19], v12, s[32:35], s13 offen offset:16
  buffer_store_dwordx2 v[20:21], v12, s[32:35], s13 offen offset:32
  buffer_store_dwordx2 v[22:23], v12, s[32:35], s13 offen offset:48
  buffer_store_dwordx2 v[24:25], v12, s[32:35], s13 offen offset:64
  s_branch gated_mix__grouped_kv_mqa__geglu_ffn__prompt_kernel_rde
gated_mix__grouped_kv_mqa__geglu_ffn__prompt_kernel_rd2:
  s_nop 4
  ds_write_b128 v13, v[96:99] offset:0
  ds_write_b128 v13, v[100:103] offset:1024
  ds_write_b128 v13, v[104:107] offset:2048
  ds_write_b128 v13, v[108:111] offset:3072
  ds_write_b128 v13, v[112:115] offset:4096
  ds_write_b128 v13, v[116:119] offset:5120
  ds_write_b128 v13, v[120:123] offset:6144
  ds_write_b128 v13, v[124:127] offset:7168
  ds_write_b128 v13, v[128:131] offset:8192
  ds_write_b128 v13, v[132:135] offset:9216
  ds_write_b128 v13, v[156:159] offset:15360
  ds_write_b128 v13, v[160:163] offset:16384
  ds_write_b128 v13, v[164:167] offset:17408
  ds_write_b128 v13, v[168:171] offset:18432
  ds_write_b128 v13, v[172:175] offset:19456
  s_waitcnt lgkmcnt(0)
  s_mov_b64 exec, 1
  ds_add_u32 v92, v90 offset:36
  s_mov_b64 exec, -1
gated_mix__grouped_kv_mqa__geglu_ffn__prompt_kernel_sp_61:
  ds_read_b32 v9, v92 offset:36
  s_waitcnt lgkmcnt(0)
  v_readfirstlane_b32 s12, v9
  s_nop 0
  s_cmp_ge_u32 s12, 4
  s_cbranch_scc1 gated_mix__grouped_kv_mqa__geglu_ffn__prompt_kernel_sp_61_d
  s_sub_u32 s28, s28, 1
  s_cbranch_scc0 gated_mix__grouped_kv_mqa__geglu_ffn__prompt_kernel_sp_61
gated_mix__grouped_kv_mqa__geglu_ffn__prompt_kernel_sp_61_d:
  ds_read_b128 v[176:179], v2 offset:10240
  ds_read_b128 v[180:183], v2 offset:11264
  ds_read_b128 v[184:187], v2 offset:12288
  ds_read_b128 v[188:191], v2 offset:13312
  ds_read_b128 v[192:195], v2 offset:14336
  ds_read_b128 v[196:199], v2 offset:30720
  ds_read_b128 v[200:203], v2 offset:31744
  ds_read_b128 v[204:207], v2 offset:32768
  ds_read_b128 v[208:211], v2 offset:33792
  ds_read_b128 v[212:215], v2 offset:34816
  ds_read_b128 v[216:219], v15 offset:30720
  ds_read_b128 v[220:223], v15 offset:31744
  ds_read_b128 v[224:227], v15 offset:32768
  ds_read_b128 v[228:231], v15 offset:33792
  ds_read_b128 v[232:235], v15 offset:34816
  s_waitcnt lgkmcnt(5)
  v_pk_add_f32 v[176:177], v[176:177], v[196:197]
  v_pk_add_f32 v[178:179], v[178:179], v[198:199]
  v_pk_add_f32 v[180:181], v[180:181], v[200:201]
  v_pk_add_f32 v[182:183], v[182:183], v[202:203]
  v_pk_add_f32 v[184:185], v[184:185], v[204:205]
  v_pk_add_f32 v[186:187], v[186:187], v[206:207]
  v_pk_add_f32 v[188:189], v[188:189], v[208:209]
  v_pk_add_f32 v[190:191], v[190:191], v[210:211]
  v_pk_add_f32 v[192:193], v[192:193], v[212:213]
  v_pk_add_f32 v[194:195], v[194:195], v[214:215]
  s_waitcnt lgkmcnt(0)
  v_pk_add_f32 v[136:137], v[136:137], v[216:217]
  v_pk_add_f32 v[138:139], v[138:139], v[218:219]
  v_pk_add_f32 v[140:141], v[140:141], v[220:221]
  v_pk_add_f32 v[142:143], v[142:143], v[222:223]
  v_pk_add_f32 v[144:145], v[144:145], v[224:225]
  v_pk_add_f32 v[146:147], v[146:147], v[226:227]
  v_pk_add_f32 v[148:149], v[148:149], v[228:229]
  v_pk_add_f32 v[150:151], v[150:151], v[230:231]
  v_pk_add_f32 v[152:153], v[152:153], v[232:233]
  v_pk_add_f32 v[154:155], v[154:155], v[234:235]
  v_pk_add_f32 v[136:137], v[136:137], v[176:177]
  v_pk_add_f32 v[138:139], v[138:139], v[178:179]
  v_pk_add_f32 v[140:141], v[140:141], v[180:181]
  v_pk_add_f32 v[142:143], v[142:143], v[182:183]
  v_pk_add_f32 v[144:145], v[144:145], v[184:185]
  v_pk_add_f32 v[146:147], v[146:147], v[186:187]
  v_pk_add_f32 v[148:149], v[148:149], v[188:189]
  v_pk_add_f32 v[150:151], v[150:151], v[190:191]
  v_pk_add_f32 v[152:153], v[152:153], v[192:193]
  v_pk_add_f32 v[154:155], v[154:155], v[194:195]
  v_cvt_pk_bf16_f32 v16, v136, v137
  v_cvt_pk_bf16_f32 v17, v138, v139
  v_cvt_pk_bf16_f32 v18, v140, v141
  v_cvt_pk_bf16_f32 v19, v142, v143
  v_cvt_pk_bf16_f32 v20, v144, v145
  v_cvt_pk_bf16_f32 v21, v146, v147
  v_cvt_pk_bf16_f32 v22, v148, v149
  v_cvt_pk_bf16_f32 v23, v150, v151
  v_cvt_pk_bf16_f32 v24, v152, v153
  v_cvt_pk_bf16_f32 v25, v154, v155
  buffer_store_dwordx2 v[16:17], v12, s[32:35], s13 offen offset:0
  buffer_store_dwordx2 v[18:19], v12, s[32:35], s13 offen offset:16
  buffer_store_dwordx2 v[20:21], v12, s[32:35], s13 offen offset:32
  buffer_store_dwordx2 v[22:23], v12, s[32:35], s13 offen offset:48
  buffer_store_dwordx2 v[24:25], v12, s[32:35], s13 offen offset:64
  s_branch gated_mix__grouped_kv_mqa__geglu_ffn__prompt_kernel_rde
gated_mix__grouped_kv_mqa__geglu_ffn__prompt_kernel_rd3:
  s_nop 4
  ds_write_b128 v13, v[96:99] offset:0
  ds_write_b128 v13, v[100:103] offset:1024
  ds_write_b128 v13, v[104:107] offset:2048
  ds_write_b128 v13, v[108:111] offset:3072
  ds_write_b128 v13, v[112:115] offset:4096
  ds_write_b128 v13, v[116:119] offset:5120
  ds_write_b128 v13, v[120:123] offset:6144
  ds_write_b128 v13, v[124:127] offset:7168
  ds_write_b128 v13, v[128:131] offset:8192
  ds_write_b128 v13, v[132:135] offset:9216
  ds_write_b128 v13, v[136:139] offset:10240
  ds_write_b128 v13, v[140:143] offset:11264
  ds_write_b128 v13, v[144:147] offset:12288
  ds_write_b128 v13, v[148:151] offset:13312
  ds_write_b128 v13, v[152:155] offset:14336
  s_waitcnt lgkmcnt(0)
  s_mov_b64 exec, 1
  ds_add_u32 v92, v90 offset:36
  s_mov_b64 exec, -1
gated_mix__grouped_kv_mqa__geglu_ffn__prompt_kernel_sp_62:
  ds_read_b32 v9, v92 offset:36
  s_waitcnt lgkmcnt(0)
  v_readfirstlane_b32 s12, v9
  s_nop 0
  s_cmp_ge_u32 s12, 4
  s_cbranch_scc1 gated_mix__grouped_kv_mqa__geglu_ffn__prompt_kernel_sp_62_d
  s_sub_u32 s28, s28, 1
  s_cbranch_scc0 gated_mix__grouped_kv_mqa__geglu_ffn__prompt_kernel_sp_62
gated_mix__grouped_kv_mqa__geglu_ffn__prompt_kernel_sp_62_d:
  ds_read_b128 v[176:179], v2 offset:15360
  ds_read_b128 v[180:183], v2 offset:16384
  ds_read_b128 v[184:187], v2 offset:17408
  ds_read_b128 v[188:191], v2 offset:18432
  ds_read_b128 v[192:195], v2 offset:19456
  ds_read_b128 v[196:199], v2 offset:35840
  ds_read_b128 v[200:203], v2 offset:36864
  ds_read_b128 v[204:207], v2 offset:37888
  ds_read_b128 v[208:211], v2 offset:38912
  ds_read_b128 v[212:215], v2 offset:39936
  ds_read_b128 v[216:219], v15 offset:15360
  ds_read_b128 v[220:223], v15 offset:16384
  ds_read_b128 v[224:227], v15 offset:17408
  ds_read_b128 v[228:231], v15 offset:18432
  ds_read_b128 v[232:235], v15 offset:19456
  s_waitcnt lgkmcnt(5)
  v_pk_add_f32 v[176:177], v[176:177], v[196:197]
  v_pk_add_f32 v[178:179], v[178:179], v[198:199]
  v_pk_add_f32 v[180:181], v[180:181], v[200:201]
  v_pk_add_f32 v[182:183], v[182:183], v[202:203]
  v_pk_add_f32 v[184:185], v[184:185], v[204:205]
  v_pk_add_f32 v[186:187], v[186:187], v[206:207]
  v_pk_add_f32 v[188:189], v[188:189], v[208:209]
  v_pk_add_f32 v[190:191], v[190:191], v[210:211]
  v_pk_add_f32 v[192:193], v[192:193], v[212:213]
  v_pk_add_f32 v[194:195], v[194:195], v[214:215]
  s_waitcnt lgkmcnt(0)
  v_pk_add_f32 v[156:157], v[156:157], v[216:217]
  v_pk_add_f32 v[158:159], v[158:159], v[218:219]
  v_pk_add_f32 v[160:161], v[160:161], v[220:221]
  v_pk_add_f32 v[162:163], v[162:163], v[222:223]
  v_pk_add_f32 v[164:165], v[164:165], v[224:225]
  v_pk_add_f32 v[166:167], v[166:167], v[226:227]
  v_pk_add_f32 v[168:169], v[168:169], v[228:229]
  v_pk_add_f32 v[170:171], v[170:171], v[230:231]
  v_pk_add_f32 v[172:173], v[172:173], v[232:233]
  v_pk_add_f32 v[174:175], v[174:175], v[234:235]
  v_pk_add_f32 v[156:157], v[156:157], v[176:177]
  v_pk_add_f32 v[158:159], v[158:159], v[178:179]
  v_pk_add_f32 v[160:161], v[160:161], v[180:181]
  v_pk_add_f32 v[162:163], v[162:163], v[182:183]
  v_pk_add_f32 v[164:165], v[164:165], v[184:185]
  v_pk_add_f32 v[166:167], v[166:167], v[186:187]
  v_pk_add_f32 v[168:169], v[168:169], v[188:189]
  v_pk_add_f32 v[170:171], v[170:171], v[190:191]
  v_pk_add_f32 v[172:173], v[172:173], v[192:193]
  v_pk_add_f32 v[174:175], v[174:175], v[194:195]
  v_cvt_pk_bf16_f32 v16, v156, v157
  v_cvt_pk_bf16_f32 v17, v158, v159
  v_cvt_pk_bf16_f32 v18, v160, v161
  v_cvt_pk_bf16_f32 v19, v162, v163
  v_cvt_pk_bf16_f32 v20, v164, v165
  v_cvt_pk_bf16_f32 v21, v166, v167
  v_cvt_pk_bf16_f32 v22, v168, v169
  v_cvt_pk_bf16_f32 v23, v170, v171
  v_cvt_pk_bf16_f32 v24, v172, v173
  v_cvt_pk_bf16_f32 v25, v174, v175
  buffer_store_dwordx2 v[16:17], v12, s[32:35], s13 offen offset:0
  buffer_store_dwordx2 v[18:19], v12, s[32:35], s13 offen offset:16
  buffer_store_dwordx2 v[20:21], v12, s[32:35], s13 offen offset:32
  buffer_store_dwordx2 v[22:23], v12, s[32:35], s13 offen offset:48
  buffer_store_dwordx2 v[24:25], v12, s[32:35], s13 offen offset:64
gated_mix__grouped_kv_mqa__geglu_ffn__prompt_kernel_rde:
gated_mix__grouped_kv_mqa__geglu_ffn__prompt_kernel_end:
  s_endpgm
.set CODE_MAX, gated_mix__grouped_kv_mqa__geglu_ffn__prompt_kernel_end - gated_mix__grouped_kv_mqa__geglu_ffn__prompt_kernel - 256
.section .rodata,"a"
.p2align 6
.amdhsa_kernel gated_mix__grouped_kv_mqa__geglu_ffn__prompt_kernel
  .amdhsa_next_free_vgpr 256
  .amdhsa_next_free_sgpr 102
  .amdhsa_accum_offset 256
  .amdhsa_group_segment_fixed_size 0
  .amdhsa_kernarg_size 104
  .amdhsa_user_sgpr_count 2
  .amdhsa_user_sgpr_kernarg_segment_ptr 1
  .amdhsa_system_sgpr_workgroup_id_x 1
.end_amdhsa_kernel
```
